```python
import torch

def _softmax(x, axis=-1):
    return torch.softmax(x, dim=axis)
def _gelu(x):
    return torch.nn.functional.gelu(x, approximate="tanh")
def _silu(x):
    return torch.nn.functional.silu(x)
def _sigmoid(x):
    return torch.sigmoid(x)
def _layernorm(x, axis=-1, eps=1e-5):
    m = x.mean(dim=axis, keepdim=True)
    v = x.var(dim=axis, keepdim=True, unbiased=False)
    return (x - m) / torch.sqrt(v + eps)
def _scatter_add(tgt, idx, src, axis=0):
    return tgt.clone().index_add_(axis, idx, src)
def _segment_sum(src, seg, n):
    out = torch.zeros((n,) + src.shape[1:], dtype=src.dtype)
    return out.index_add_(0, seg, src)
def _pad(x, pw):
    flat = tuple(v for pair in reversed(pw) for v in pair)
    return torch.nn.functional.pad(x, flat)

kernel_name = 'standalone__gqa_softmax__near_ridge'

def setup_inputs():

    _w = (lambda a: (lambda t: t.to(torch.bfloat16) if t.is_floating_point() else t)(torch.as_tensor(a)))
    B, Hq, Hkv, Sq, Sk, D = 8, 32, 8, 384, 384, 128
    return {
        "q": _w((lambda *s: torch.randn(*s, dtype=torch.bfloat16) * 0.8)(B, Hq, Sq, D)),
        "k": _w((lambda *s: torch.randn(*s, dtype=torch.bfloat16) * 0.8)(B, Hkv, Sk, D)),
        "v": _w((lambda *s: torch.randn(*s, dtype=torch.bfloat16) * 0.05)(B, Hkv, Sk, D)),
    }

def reference(q, k, v):
    B, Hq, Sq, D = q.shape
    Hkv = k.shape[1]
    rep = Hq // Hkv
    k = (lambda x, n, axis: torch.repeat_interleave(x, n, dim=axis))(k, rep, axis=1)
    v = (lambda x, n, axis: torch.repeat_interleave(x, n, dim=axis))(v, rep, axis=1)
    scale = D ** -0.5
    scores = torch.einsum("bhqd,bhkd->bhqk", q, k) * scale
    p = _softmax(scores, axis=-1)
    return torch.einsum("bhqk,bhkd->bhqd", p, v)
```

```asm
; @launch grid=(256,1,1) block=(256,1,1) lds=163840
.amdgcn_target "amdgcn-amd-amdhsa--gfx950"
.text
.globl standalone__gqa_softmax__near_ridge_kernel
.p2align 8
.type standalone__gqa_softmax__near_ridge_kernel,@function
standalone__gqa_softmax__near_ridge_kernel:
  s_cmp_ge_u32 s2, 0x100
  s_cbranch_scc1 L_END
  s_load_dwordx8 s[24:31], s[0:1], 0
  v_lshrrev_b32 v100, 6, v0
  v_and_b32 v101, 63, v0
  s_and_b32 s3, s2, 7
  v_readfirstlane_b32 s22, v100
  s_lshr_b32 s34, s2, 5
  s_lshl_b32 s34, s34, 3
  s_or_b32 s3, s3, s34
  s_bfe_u32 s34, s2, 0x20003
  s_lshl_b32 s35, s3, 2
  s_or_b32 s34, s34, s35
  s_mul_i32 s3, s3, 0x18000
  s_mul_i32 s34, s34, 0x18000
  v_lshrrev_b32 v102, 4, v101
  v_and_b32 v103, 15, v101
  v_and_b32 v104, 1, v100
  v_lshl_or_b32 v104, v104, 3, v102
  v_xor_b32 v105, v103, v104
  v_lshlrev_b32 v106, 8, v102
  v_lshl_or_b32 v22, v105, 4, v106
  v_xor_b32 v23, 64, v22
  s_lshl_b32 s21, s22, 11
  s_mov_b32 s10, 0x18000
  s_mov_b32 s11, 0x20000
  s_mov_b32 m0, s21
  s_lshl_b32 s42, s22, 13
  s_mov_b32 s6, 0x18000
  s_mov_b32 s7, 0x20000
  v_and_b32 v104, 31, v101
  v_lshl_or_b32 v104, v100, 5, v104
  v_lshrrev_b32 v107, 5, v101
  v_lshlrev_b32 v105, 4, v107
  v_lshl_or_b32 v25, v104, 8, v105
  v_lshlrev_b32 v104, 2, v102
  v_xor_b32 v105, v103, v104
  v_lshl_or_b32 v24, v105, 4, v106
  s_mov_b32 s14, 0x30000
  s_mov_b32 s15, 0x20000
  s_waitcnt lgkmcnt(0)
  s_add_u32 s8, s26, s3
  s_addc_u32 s9, s27, 0
  s_add_u32 s4, s24, s34
  s_addc_u32 s5, s25, 0
  buffer_load_dwordx4 v22, s[8:11], m0 offen lds
  buffer_load_dwordx4 v23, s[8:11], m0 offen offset:1024 lds
  s_add_u32 m0, s21, 0x2000
  s_nop 0
  buffer_load_dwordx4 v22, s[8:11], m0 offen lds
  buffer_load_dwordx4 v23, s[8:11], m0 offen offset:1024 lds
  s_add_u32 m0, s21, 0x10000
  s_nop 0
  buffer_load_dwordx4 v22, s[4:7], s42 offen lds
  buffer_load_dwordx4 v23, s[4:7], s42 offen offset:1024 lds
  s_add_u32 m0, s21, 0x12000
  s_add_u32 s42, s42, 0x800
  buffer_load_dwordx4 v22, s[4:7], s42 offen lds
  buffer_load_dwordx4 v23, s[4:7], s42 offen offset:1024 lds
  s_add_u32 m0, s21, 0x14000
  s_add_u32 s42, s42, 0x800
  buffer_load_dwordx4 v22, s[4:7], s42 offen lds
  buffer_load_dwordx4 v23, s[4:7], s42 offen offset:1024 lds
  s_add_u32 m0, s21, 0x16000
  s_add_u32 s42, s42, 0x800
  buffer_load_dwordx4 v22, s[4:7], s42 offen lds
  buffer_load_dwordx4 v23, s[4:7], s42 offen offset:1024 lds
  s_add_u32 s36, s28, s3
  s_addc_u32 s37, s29, 0
  s_sub_u32 s12, s36, 0x18000
  s_subb_u32 s13, s37, 0
  s_add_u32 m0, s21, 0x18000
  s_nop 0
  buffer_load_dwordx4 v24, s[12:15], m0 offen lds
  buffer_load_dwordx4 v24, s[12:15], m0 offen offset:1024 lds
  s_add_u32 m0, s21, 0x4000
  s_nop 0
  buffer_load_dwordx4 v22, s[8:11], m0 offen lds
  buffer_load_dwordx4 v23, s[8:11], m0 offen offset:1024 lds
  s_add_u32 m0, s21, 0x1a000
  s_nop 0
  buffer_load_dwordx4 v24, s[12:15], m0 offen lds
  buffer_load_dwordx4 v24, s[12:15], m0 offen offset:1024 lds
  s_add_u32 m0, s21, 0x6000
  s_nop 0
  buffer_load_dwordx4 v22, s[8:11], m0 offen lds
  buffer_load_dwordx4 v23, s[8:11], m0 offen offset:1024 lds
  s_getpc_b64 s[56:57]
  v_lshlrev_b32 v43, 7, v0
  v_min_u32 v43, 0x6800, v43
  global_load_dword v42, v43, s[56:57]
  s_sub_u32 s36, s36, 0x8000
  s_subb_u32 s37, s37, 0
  s_mov_b32 s38, 0x20000
  s_mov_b32 s39, 0x20000
  s_add_u32 s16, s30, s34
  s_addc_u32 s17, s31, 0
  s_mov_b32 s18, 0x18000
  s_mov_b32 s19, 0x20000
  s_mov_b32 s20, 0x3e0293ee
  s_mov_b32 s23, 0xbe0293ee
  s_mov_b32 s40, 0x8000
  s_mov_b32 s41, 0x10000
  s_mov_b32 s44, 0x1000
  s_mov_b32 s45, 0x9000
  s_mov_b32 s46, 0x11000
  v_and_b32 v104, 31, v101
  v_xor_b32 v105, v107, v103
  v_lshlrev_b32 v105, 4, v105
  v_lshl_or_b32 v1, v104, 8, v105
  v_xor_b32 v2, 0x20, v1
  v_xor_b32 v3, 0x40, v1
  v_xor_b32 v4, 0x60, v1
  v_xor_b32 v5, 0x80, v1
  v_xor_b32 v6, 0xa0, v1
  v_xor_b32 v7, 0xc0, v1
  v_xor_b32 v8, 0xe0, v1
  v_and_b32 v105, 7, v101
  v_bfe_u32 v106, v101, 3, 2
  v_lshlrev_b32 v106, 13, v106
  v_lshl_or_b32 v106, v100, 11, v106
  v_lshl_or_b32 v106, v105, 8, v106
  v_xor_b32 v105, v105, v107
  v_and_b32 v112, 1, v100
  v_lshl_or_b32 v105, v112, 3, v105
  v_lshl_or_b32 v106, v105, 4, v106
  v_add_u32 v112, 0x10000, v106
  v_xor_b32 v113, 0x20, v112
  v_xor_b32 v114, 0x40, v112
  v_xor_b32 v115, 0x60, v112
  v_xor_b32 v116, 0x80, v112
  v_xor_b32 v117, 0xa0, v112
  v_xor_b32 v118, 0xc0, v112
  v_xor_b32 v119, 0xe0, v112
  v_add_u32 v9, 0x10000, v1
  v_add_u32 v10, 0x10000, v2
  v_add_u32 v11, 0x10000, v3
  v_add_u32 v12, 0x10000, v4
  v_add_u32 v13, 0x10000, v5
  v_add_u32 v14, 0x10000, v6
  v_add_u32 v15, 0x10000, v7
  v_add_u32 v16, 0x10000, v8
  v_bfe_u32 v105, v101, 2, 2
  v_lshl_or_b32 v106, v107, 2, v105
  v_lshlrev_b32 v106, 8, v106
  v_lshl_or_b32 v106, v105, 6, v106
  v_bfe_u32 v105, v101, 4, 1
  v_lshl_or_b32 v106, v105, 5, v106
  v_and_b32 v105, 1, v101
  v_lshl_or_b32 v106, v105, 4, v106
  v_bfe_u32 v105, v101, 1, 1
  v_lshl_or_b32 v106, v105, 3, v106
  v_add_u32 v17, 0x18000, v106
  v_bfe_u32 v0, v100, 1, 1
  v_lshlrev_b32 v0, 7, v0
  v_xor_b32 v17, v17, v0
  v_xor_b32 v18, 0x40, v17
  v_xor_b32 v19, 0x80, v17
  v_xor_b32 v20, 0xc0, v17
  v_bfe_u32 v105, v101, 1, 3
  v_xor_b32 v105, v105, v107
  v_lshlrev_b32 v105, 4, v105
  v_lshl_or_b32 v105, v104, 7, v105
  v_lshl_or_b32 v105, v100, 12, v105
  v_add_u32 v34, 0x20000, v105
  v_xor_b32 v35, 0x20, v34
  v_xor_b32 v36, 0x40, v34
  v_xor_b32 v37, 0x60, v34
  v_and_b32 v105, 7, v101
  v_lshrrev_b32 v106, 3, v101
  v_lshlrev_b32 v21, 4, v105
  v_lshl_or_b32 v21, v106, 8, v21
  v_lshl_or_b32 v21, v100, 13, v21
  v_or_b32 v21, v21, v0
  v_xor_b32 v0, 0x80, v21
  v_xor_b32 v105, v105, v102
  v_lshlrev_b32 v105, 4, v105
  v_lshl_or_b32 v105, v106, 7, v105
  v_lshl_or_b32 v105, v100, 12, v105
  v_add_u32 v38, 0x20000, v105
  v_xor_b32 v39, 64, v38
  v_mov_b32 v43, v25
  v_lshrrev_b32 v106, 2, v101
  v_lshrrev_b32 v105, 4, v101
  v_xor_b32 v105, v105, v106
  v_and_b32 v105, 1, v105
  v_add_u32 v105, -1, v105
  v_and_b32 v44, 0x3f803f80, v105
  v_and_b32 v45, 0x3f803f80, v105
  v_and_b32 v46, 0x3f803f80, v105
  v_and_b32 v47, 0x3f803f80, v105
  s_waitcnt vmcnt(17)
  s_barrier
  ds_read_b128 v[48:51], v1
  ds_read_b128 v[52:55], v2
  ds_read_b128 v[56:59], v3
  ds_read_b128 v[60:63], v4
  ds_read_b128 v[64:67], v5
  ds_read_b128 v[68:71], v6
  ds_read_b128 v[72:75], v7
  ds_read_b128 v[76:79], v8
  s_waitcnt vmcnt(9)
  ds_read_b128 a[192:195], v112
  ds_read_b128 a[196:199], v113
  ds_read_b128 a[200:203], v114
  ds_read_b128 a[204:207], v115
  ds_read_b128 a[208:211], v116
  ds_read_b128 a[212:215], v117
  ds_read_b128 a[216:219], v118
  ds_read_b128 a[220:223], v119
  s_waitcnt lgkmcnt(7)
  v_mfma_f32_32x32x16_bf16 v[96:111], v[48:51], a[192:195], 0
  s_waitcnt lgkmcnt(6)
  ds_read_b128 v[48:51], v1 offset:8192
  v_mfma_f32_32x32x16_bf16 v[96:111], v[52:55], a[196:199], v[96:111]
  s_waitcnt lgkmcnt(6)
  ds_read_b128 v[52:55], v2 offset:8192
  v_mfma_f32_32x32x16_bf16 v[96:111], v[56:59], a[200:203], v[96:111]
  s_waitcnt lgkmcnt(6)
  ds_read_b128 v[56:59], v3 offset:8192
  v_mfma_f32_32x32x16_bf16 v[96:111], v[60:63], a[204:207], v[96:111]
  s_waitcnt lgkmcnt(6)
  ds_read_b128 v[60:63], v4 offset:8192
  v_mfma_f32_32x32x16_bf16 v[96:111], v[64:67], a[208:211], v[96:111]
  s_waitcnt lgkmcnt(6)
  ds_read_b128 v[64:67], v5 offset:8192
  v_mfma_f32_32x32x16_bf16 v[96:111], v[68:71], a[212:215], v[96:111]
  s_waitcnt lgkmcnt(6)
  ds_read_b128 v[68:71], v6 offset:8192
  v_mfma_f32_32x32x16_bf16 v[96:111], v[72:75], a[216:219], v[96:111]
  s_waitcnt lgkmcnt(6)
  ds_read_b128 v[72:75], v7 offset:8192
  v_mfma_f32_32x32x16_bf16 v[96:111], v[76:79], a[220:223], v[96:111]
  s_waitcnt vmcnt(5) lgkmcnt(5)
  s_barrier
  ds_read_b128 v[76:79], v8 offset:8192
  v_mfma_f32_32x32x16_bf16 v[112:127], v[48:51], a[192:195], 0
  s_add_u32 m0, s21, 0x1c000
  ds_read_b64_tr_b16 a[0:1], v17
  ds_read_b64_tr_b16 a[2:3], v17 offset:2048
  v_mfma_f32_32x32x16_bf16 v[112:127], v[52:55], a[196:199], v[112:127]
  s_waitcnt lgkmcnt(6)
  ds_read_b64_tr_b16 a[4:5], v18
  ds_read_b64_tr_b16 a[6:7], v18 offset:2048
  buffer_load_dwordx4 v24, s[12:15], m0 offen lds
  v_max3_f32 v32, v96, v97, v98
  v_max3_f32 v33, v99, v100, v101
  v_max3_f32 v32, v32, v102, v103
  v_max3_f32 v33, v33, v104, v105
  v_mfma_f32_32x32x16_bf16 v[112:127], v[56:59], a[200:203], v[112:127]
  ds_read_b64_tr_b16 a[8:9], v19
  ds_read_b64_tr_b16 a[10:11], v19 offset:2048
  buffer_load_dwordx4 v24, s[12:15], m0 offen offset:1024 lds
  v_max3_f32 v32, v32, v106, v107
  v_max3_f32 v33, v33, v108, v109
  v_max3_f32 v32, v32, v110, v111
  v_max_f32 v32, v32, v33
  v_max_f32 v33, v32, v33
  v_mfma_f32_32x32x16_bf16 v[112:127], v[60:63], a[204:207], v[112:127]
  s_waitcnt lgkmcnt(8)
  ds_read_b64_tr_b16 a[12:13], v20
  ds_read_b64_tr_b16 a[14:15], v20 offset:2048
  v_permlane32_swap_b32 v32, v33
  v_max_f32 v32, v32, v33
  v_mul_f32 v30, s23, v32
  v_fma_f32 v96, v96, s20, v30
  v_fma_f32 v97, v97, s20, v30
  v_mfma_f32_32x32x16_bf16 v[112:127], v[64:67], a[208:211], v[112:127]
  s_add_u32 m0, s21, 0x8000
  ds_read_b64_tr_b16 a[16:17], v17 offset:4096
  ds_read_b64_tr_b16 a[18:19], v17 offset:6144
  v_exp_f32 v96, v96
  v_exp_f32 v97, v97
  v_fma_f32 v98, v98, s20, v30
  v_fma_f32 v99, v99, s20, v30
  v_mfma_f32_32x32x16_bf16 v[112:127], v[68:71], a[212:215], v[112:127]
  s_waitcnt lgkmcnt(10)
  ds_read_b64_tr_b16 a[20:21], v18 offset:4096
  ds_read_b64_tr_b16 a[22:23], v18 offset:6144
  buffer_load_dwordx4 v22, s[8:11], m0 offen lds
  v_cvt_pk_bf16_f32 v80, v96, v97
  v_exp_f32 v98, v98
  v_exp_f32 v99, v99
  v_fma_f32 v100, v100, s20, v30
  v_fma_f32 v101, v101, s20, v30
  v_mfma_f32_32x32x16_bf16 v[112:127], v[72:75], a[216:219], v[112:127]
  ds_read_b64_tr_b16 a[24:25], v19 offset:4096
  ds_read_b64_tr_b16 a[26:27], v19 offset:6144
  buffer_load_dwordx4 v23, s[8:11], m0 offen offset:1024 lds
  v_mov_b32 v26, v96
  v_mov_b32 v27, v97
  v_cvt_pk_bf16_f32 v81, v98, v99
  v_exp_f32 v100, v100
  v_exp_f32 v101, v101
  v_fma_f32 v102, v102, s20, v30
  v_fma_f32 v103, v103, s20, v30
  v_mfma_f32_32x32x16_bf16 v[112:127], v[76:79], a[220:223], v[112:127]
  ds_read_b64_tr_b16 a[28:29], v20 offset:4096
  ds_read_b64_tr_b16 a[30:31], v20 offset:6144
  v_add_f32 v26, v26, v98
  v_add_f32 v27, v27, v99
  v_cvt_pk_bf16_f32 v82, v100, v101
  v_exp_f32 v102, v102
  v_exp_f32 v103, v103
  s_add_u32 m0, s21, 0x1e000
  v_add_f32 v26, v26, v100
  v_add_f32 v27, v27, v101
  v_cvt_pk_bf16_f32 v83, v102, v103
  v_add_f32 v26, v26, v102
  v_add_f32 v27, v27, v103
  v_fma_f32 v104, v104, s20, v30
  v_fma_f32 v105, v105, s20, v30
  v_fma_f32 v106, v106, s20, v30
  buffer_load_dwordx4 v24, s[12:15], m0 offen lds
  v_exp_f32 v104, v104
  v_exp_f32 v105, v105
  v_fma_f32 v107, v107, s20, v30
  v_exp_f32 v106, v106
  buffer_load_dwordx4 v24, s[12:15], m0 offen offset:1024 lds
  v_cvt_pk_bf16_f32 v84, v104, v105
  v_exp_f32 v107, v107
  v_fma_f32 v108, v108, s20, v30
  v_fma_f32 v109, v109, s20, v30
  v_add_f32 v26, v26, v104
  v_add_f32 v27, v27, v105
  v_cvt_pk_bf16_f32 v85, v106, v107
  v_exp_f32 v108, v108
  v_exp_f32 v109, v109
  v_fma_f32 v110, v110, s20, v30
  v_fma_f32 v111, v111, s20, v30
  v_add_f32 v26, v26, v106
  s_add_u32 m0, s21, 0xa000
  v_add_f32 v27, v27, v107
  v_cvt_pk_bf16_f32 v86, v108, v109
  v_exp_f32 v110, v110
  v_exp_f32 v111, v111
  v_add_f32 v26, v26, v108
  v_add_f32 v27, v27, v109
  buffer_load_dwordx4 v22, s[8:11], m0 offen lds
  v_cvt_pk_bf16_f32 v87, v110, v111
  v_add_f32 v26, v26, v110
  v_add_f32 v27, v27, v111
  buffer_load_dwordx4 v23, s[8:11], m0 offen offset:1024 lds
  s_waitcnt lgkmcnt(12)
  v_mfma_f32_32x32x16_bf16 v[128:143], a[0:3], v[80:83], 0
  s_add_u32 m0, s21, 0x20000
  ds_read_b128 v[48:51], v1 offset:16384
  v_mfma_f32_32x32x16_bf16 v[144:159], a[4:7], v[80:83], 0
  s_waitcnt lgkmcnt(9)
  ds_read_b128 v[52:55], v2 offset:16384
  buffer_load_dwordx4 v24, s[12:15], m0 offen lds
  v_fma_f32 v112, v112, s20, v30
  v_exp_f32 v112, v112
  v_fma_f32 v113, v113, s20, v30
  v_mfma_f32_32x32x16_bf16 v[160:175], a[8:11], v[80:83], 0
  ds_read_b128 v[56:59], v3 offset:16384
  buffer_load_dwordx4 v24, s[12:15], m0 offen offset:1024 lds
  v_exp_f32 v113, v113
  v_fma_f32 v114, v114, s20, v30
  v_add_f32 v26, v26, v112
  v_mfma_f32_32x32x16_bf16 v[176:191], a[12:15], v[80:83], 0
  s_waitcnt lgkmcnt(7)
  ds_read_b128 v[60:63], v4 offset:16384
  v_cvt_pk_bf16_f32 v88, v112, v113
  v_exp_f32 v114, v114
  v_fma_f32 v115, v115, s20, v30
  v_add_f32 v27, v27, v113
  v_mfma_f32_32x32x16_bf16 v[128:143], a[16:19], v[84:87], v[128:143]
  s_add_u32 m0, s21, 0xc000
  ds_read_b128 v[64:67], v5 offset:16384
  v_exp_f32 v115, v115
  v_fma_f32 v116, v116, s20, v30
  v_add_f32 v26, v26, v114
  v_fma_f32 v117, v117, s20, v30
  v_mfma_f32_32x32x16_bf16 v[144:159], a[20:23], v[84:87], v[144:159]
  s_waitcnt lgkmcnt(5)
  ds_read_b128 v[68:71], v6 offset:16384
  buffer_load_dwordx4 v22, s[8:11], m0 offen lds
  v_cvt_pk_bf16_f32 v89, v114, v115
  v_exp_f32 v116, v116
  v_add_f32 v27, v27, v115
  v_mfma_f32_32x32x16_bf16 v[160:175], a[24:27], v[84:87], v[160:175]
  ds_read_b128 v[72:75], v7 offset:16384
  buffer_load_dwordx4 v23, s[8:11], m0 offen offset:1024 lds
  v_exp_f32 v117, v117
  v_fma_f32 v118, v118, s20, v30
  v_add_f32 v26, v26, v116
  v_mfma_f32_32x32x16_bf16 v[176:191], a[28:31], v[84:87], v[176:191]
  s_waitcnt vmcnt(13) lgkmcnt(5)
  s_barrier
  ds_read_b128 v[76:79], v8 offset:16384
  v_cvt_pk_bf16_f32 v90, v116, v117
  v_exp_f32 v118, v118
  v_fma_f32 v119, v119, s20, v30
  v_mfma_f32_32x32x16_bf16 v[96:111], v[48:51], a[192:195], 0
  s_add_u32 m0, s21, 0x22000
  ds_read_b64_tr_b16 a[32:33], v17 offset:8192
  ds_read_b64_tr_b16 a[34:35], v17 offset:10240
  v_add_f32 v27, v27, v117
  v_exp_f32 v119, v119
  v_fma_f32 v120, v120, s20, v30
  v_mfma_f32_32x32x16_bf16 v[96:111], v[52:55], a[196:199], v[96:111]
  s_waitcnt lgkmcnt(6)
  ds_read_b64_tr_b16 a[36:37], v18 offset:8192
  ds_read_b64_tr_b16 a[38:39], v18 offset:10240
  buffer_load_dwordx4 v24, s[12:15], m0 offen lds
  v_add_f32 v26, v26, v118
  v_cvt_pk_bf16_f32 v91, v118, v119
  v_fma_f32 v121, v121, s20, v30
  v_mfma_f32_32x32x16_bf16 v[96:111], v[56:59], a[200:203], v[96:111]
  ds_read_b64_tr_b16 a[40:41], v19 offset:8192
  ds_read_b64_tr_b16 a[42:43], v19 offset:10240
  buffer_load_dwordx4 v24, s[12:15], m0 offen offset:1024 lds
  v_exp_f32 v120, v120
  v_add_f32 v27, v27, v119
  v_mfma_f32_32x32x16_bf16 v[96:111], v[60:63], a[204:207], v[96:111]
  s_waitcnt lgkmcnt(8)
  ds_read_b64_tr_b16 a[44:45], v20 offset:8192
  ds_read_b64_tr_b16 a[46:47], v20 offset:10240
  v_exp_f32 v121, v121
  v_fma_f32 v122, v122, s20, v30
  v_add_f32 v26, v26, v120
  v_mfma_f32_32x32x16_bf16 v[96:111], v[64:67], a[208:211], v[96:111]
  s_add_u32 m0, s21, 0xe000
  ds_read_b64_tr_b16 a[48:49], v17 offset:12288
  ds_read_b64_tr_b16 a[50:51], v17 offset:14336
  v_cvt_pk_bf16_f32 v92, v120, v121
  v_exp_f32 v122, v122
  v_fma_f32 v123, v123, s20, v30
  v_mfma_f32_32x32x16_bf16 v[96:111], v[68:71], a[212:215], v[96:111]
  s_waitcnt lgkmcnt(10)
  ds_read_b64_tr_b16 a[52:53], v18 offset:12288
  ds_read_b64_tr_b16 a[54:55], v18 offset:14336
  buffer_load_dwordx4 v22, s[8:11], m0 offen lds
  v_add_f32 v27, v27, v121
  v_exp_f32 v123, v123
  v_fma_f32 v124, v124, s20, v30
  v_mfma_f32_32x32x16_bf16 v[96:111], v[72:75], a[216:219], v[96:111]
  ds_read_b64_tr_b16 a[56:57], v19 offset:12288
  ds_read_b64_tr_b16 a[58:59], v19 offset:14336
  buffer_load_dwordx4 v23, s[8:11], m0 offen offset:1024 lds
  v_add_f32 v26, v26, v122
  v_cvt_pk_bf16_f32 v93, v122, v123
  v_exp_f32 v124, v124
  v_fma_f32 v125, v125, s20, v30
  v_mfma_f32_32x32x16_bf16 v[96:111], v[76:79], a[220:223], v[96:111]
  s_waitcnt lgkmcnt(10)
  ds_read_b64_tr_b16 a[60:61], v20 offset:12288
  ds_read_b64_tr_b16 a[62:63], v20 offset:14336
  v_add_f32 v27, v27, v123
  v_exp_f32 v125, v125
  v_fma_f32 v126, v126, s20, v30
  v_mfma_f32_32x32x16_bf16 v[128:143], a[32:35], v[88:91], v[128:143]
  s_add_u32 m0, s21, 0x24000
  ds_read_b128 v[48:51], v1 offset:24576
  v_add_f32 v26, v26, v124
  v_cvt_pk_bf16_f32 v94, v124, v125
  v_exp_f32 v126, v126
  v_fma_f32 v127, v127, s20, v30
  v_mfma_f32_32x32x16_bf16 v[144:159], a[36:39], v[88:91], v[144:159]
  s_waitcnt lgkmcnt(9)
  ds_read_b128 v[52:55], v2 offset:24576
  buffer_load_dwordx4 v24, s[12:15], m0 offen lds
  v_add_f32 v27, v27, v125
  v_exp_f32 v127, v127
  v_fma_f32 v96, v96, s20, v30
  v_mfma_f32_32x32x16_bf16 v[160:175], a[40:43], v[88:91], v[160:175]
  ds_read_b128 v[56:59], v3 offset:24576
  buffer_load_dwordx4 v24, s[12:15], m0 offen offset:1024 lds
  v_add_f32 v26, v26, v126
  v_cvt_pk_bf16_f32 v95, v126, v127
  v_exp_f32 v96, v96
  v_fma_f32 v97, v97, s20, v30
  v_mfma_f32_32x32x16_bf16 v[176:191], a[44:47], v[88:91], v[176:191]
  s_waitcnt lgkmcnt(7)
  ds_read_b128 v[60:63], v4 offset:24576
  v_add_f32 v27, v27, v127
  v_exp_f32 v97, v97
  v_fma_f32 v98, v98, s20, v30
  v_add_f32 v26, v26, v96
  v_mfma_f32_32x32x16_bf16 v[128:143], a[48:51], v[92:95], v[128:143]
  s_add_u32 m0, s21, 0x10000
  ds_read_b128 v[64:67], v5 offset:24576
  v_cvt_pk_bf16_f32 v80, v96, v97
  v_exp_f32 v98, v98
  v_fma_f32 v99, v99, s20, v30
  v_add_f32 v27, v27, v97
  v_mfma_f32_32x32x16_bf16 v[144:159], a[52:55], v[92:95], v[144:159]
  s_waitcnt lgkmcnt(5)
  ds_read_b128 v[68:71], v6 offset:24576
  buffer_load_dwordx4 v22, s[8:11], m0 offen lds
  v_exp_f32 v99, v99
  v_fma_f32 v100, v100, s20, v30
  v_add_f32 v26, v26, v98
  v_mfma_f32_32x32x16_bf16 v[160:175], a[56:59], v[92:95], v[160:175]
  ds_read_b128 v[72:75], v7 offset:24576
  buffer_load_dwordx4 v23, s[8:11], m0 offen offset:1024 lds
  v_cvt_pk_bf16_f32 v81, v98, v99
  v_exp_f32 v100, v100
  v_fma_f32 v101, v101, s20, v30
  v_mfma_f32_32x32x16_bf16 v[176:191], a[60:63], v[92:95], v[176:191]
  s_waitcnt vmcnt(16) lgkmcnt(5)
  s_barrier
  ds_read_b128 v[76:79], v8 offset:24576
  v_add_f32 v27, v27, v99
  v_exp_f32 v101, v101
  v_fma_f32 v102, v102, s20, v30
  v_mfma_f32_32x32x16_bf16 v[112:127], v[48:51], a[192:195], 0
  s_add_u32 m0, s21, 0x26000
  ds_read_b64_tr_b16 a[64:65], v17 offset:16384
  ds_read_b64_tr_b16 a[66:67], v17 offset:18432
  v_add_f32 v26, v26, v100
  v_cvt_pk_bf16_f32 v82, v100, v101
  v_exp_f32 v102, v102
  v_fma_f32 v103, v103, s20, v30
  v_mfma_f32_32x32x16_bf16 v[112:127], v[52:55], a[196:199], v[112:127]
  s_waitcnt lgkmcnt(6)
  ds_read_b64_tr_b16 a[68:69], v18 offset:16384
  ds_read_b64_tr_b16 a[70:71], v18 offset:18432
  buffer_load_dwordx4 v24, s[12:15], m0 offen lds
  v_add_f32 v27, v27, v101
  v_exp_f32 v103, v103
  v_fma_f32 v104, v104, s20, v30
  v_mfma_f32_32x32x16_bf16 v[112:127], v[56:59], a[200:203], v[112:127]
  ds_read_b64_tr_b16 a[72:73], v19 offset:16384
  ds_read_b64_tr_b16 a[74:75], v19 offset:18432
  buffer_load_dwordx4 v24, s[12:15], m0 offen offset:1024 lds
  v_add_f32 v26, v26, v102
  v_cvt_pk_bf16_f32 v83, v102, v103
  v_exp_f32 v104, v104
  v_fma_f32 v105, v105, s20, v30
  v_mfma_f32_32x32x16_bf16 v[112:127], v[60:63], a[204:207], v[112:127]
  s_waitcnt lgkmcnt(8)
  ds_read_b64_tr_b16 a[76:77], v20 offset:16384
  ds_read_b64_tr_b16 a[78:79], v20 offset:18432
  v_add_f32 v27, v27, v103
  v_exp_f32 v105, v105
  v_fma_f32 v106, v106, s20, v30
  v_mfma_f32_32x32x16_bf16 v[112:127], v[64:67], a[208:211], v[112:127]
  s_add_u32 m0, s21, 0x12000
  ds_read_b64_tr_b16 a[80:81], v17 offset:20480
  ds_read_b64_tr_b16 a[82:83], v17 offset:22528
  v_add_f32 v26, v26, v104
  v_cvt_pk_bf16_f32 v84, v104, v105
  v_exp_f32 v106, v106
  v_fma_f32 v107, v107, s20, v30
  v_mfma_f32_32x32x16_bf16 v[112:127], v[68:71], a[212:215], v[112:127]
  s_waitcnt lgkmcnt(10)
  ds_read_b64_tr_b16 a[84:85], v18 offset:20480
  ds_read_b64_tr_b16 a[86:87], v18 offset:22528
  buffer_load_dwordx4 v22, s[8:11], m0 offen lds
  v_add_f32 v27, v27, v105
  v_exp_f32 v107, v107
  v_fma_f32 v108, v108, s20, v30
  v_mfma_f32_32x32x16_bf16 v[112:127], v[72:75], a[216:219], v[112:127]
  ds_read_b64_tr_b16 a[88:89], v19 offset:20480
  ds_read_b64_tr_b16 a[90:91], v19 offset:22528
  buffer_load_dwordx4 v23, s[8:11], m0 offen offset:1024 lds
  v_add_f32 v26, v26, v106
  v_cvt_pk_bf16_f32 v85, v106, v107
  v_exp_f32 v108, v108
  v_fma_f32 v109, v109, s20, v30
  v_mfma_f32_32x32x16_bf16 v[112:127], v[76:79], a[220:223], v[112:127]
  s_waitcnt lgkmcnt(10)
  ds_read_b64_tr_b16 a[92:93], v20 offset:20480
  ds_read_b64_tr_b16 a[94:95], v20 offset:22528
  v_add_f32 v27, v27, v107
  v_exp_f32 v109, v109
  v_fma_f32 v110, v110, s20, v30
  v_mfma_f32_32x32x16_bf16 v[128:143], a[64:67], v[80:83], v[128:143]
  s_add_u32 m0, s21, 0x18000
  ds_read_b128 v[48:51], v1 offset:32768
  v_add_f32 v26, v26, v108
  v_cvt_pk_bf16_f32 v86, v108, v109
  v_exp_f32 v110, v110
  v_fma_f32 v111, v111, s20, v30
  v_mfma_f32_32x32x16_bf16 v[144:159], a[68:71], v[80:83], v[144:159]
  s_waitcnt lgkmcnt(9)
  ds_read_b128 v[52:55], v2 offset:32768
  buffer_load_dwordx4 v24, s[36:39], m0 offen lds
  v_add_f32 v27, v27, v109
  v_exp_f32 v111, v111
  v_fma_f32 v112, v112, s20, v30
  v_mfma_f32_32x32x16_bf16 v[160:175], a[72:75], v[80:83], v[160:175]
  ds_read_b128 v[56:59], v3 offset:32768
  buffer_load_dwordx4 v24, s[36:39], m0 offen offset:1024 lds
  v_add_f32 v26, v26, v110
  v_cvt_pk_bf16_f32 v87, v110, v111
  v_exp_f32 v112, v112
  v_fma_f32 v113, v113, s20, v30
  v_mfma_f32_32x32x16_bf16 v[176:191], a[76:79], v[80:83], v[176:191]
  s_waitcnt lgkmcnt(7)
  ds_read_b128 v[60:63], v4 offset:32768
  v_add_f32 v27, v27, v111
  v_exp_f32 v113, v113
  v_fma_f32 v114, v114, s20, v30
  v_add_f32 v26, v26, v112
  v_mfma_f32_32x32x16_bf16 v[128:143], a[80:83], v[84:87], v[128:143]
  s_add_u32 m0, s21, 0x14000
  ds_read_b128 v[64:67], v5 offset:32768
  v_cvt_pk_bf16_f32 v88, v112, v113
  v_exp_f32 v114, v114
  v_fma_f32 v115, v115, s20, v30
  v_add_f32 v27, v27, v113
  v_mfma_f32_32x32x16_bf16 v[144:159], a[84:87], v[84:87], v[144:159]
  s_waitcnt lgkmcnt(5)
  ds_read_b128 v[68:71], v6 offset:32768
  buffer_load_dwordx4 v22, s[8:11], m0 offen lds
  v_exp_f32 v115, v115
  v_fma_f32 v116, v116, s20, v30
  v_add_f32 v26, v26, v114
  v_mfma_f32_32x32x16_bf16 v[160:175], a[88:91], v[84:87], v[160:175]
  ds_read_b128 v[72:75], v7 offset:32768
  buffer_load_dwordx4 v23, s[8:11], m0 offen offset:1024 lds
  v_cvt_pk_bf16_f32 v89, v114, v115
  v_exp_f32 v116, v116
  v_fma_f32 v117, v117, s20, v30
  v_mfma_f32_32x32x16_bf16 v[176:191], a[92:95], v[84:87], v[176:191]
  s_waitcnt vmcnt(20) lgkmcnt(5)
  s_barrier
  ds_read_b128 v[76:79], v8 offset:32768
  v_add_f32 v27, v27, v115
  v_exp_f32 v117, v117
  v_fma_f32 v118, v118, s20, v30
  v_mfma_f32_32x32x16_bf16 v[96:111], v[48:51], a[192:195], 0
  s_add_u32 m0, s21, 0x1a000
  ds_read_b64_tr_b16 a[96:97], v17 offset:24576
  ds_read_b64_tr_b16 a[98:99], v17 offset:26624
  v_add_f32 v26, v26, v116
  v_cvt_pk_bf16_f32 v90, v116, v117
  v_exp_f32 v118, v118
  v_fma_f32 v119, v119, s20, v30
  v_mfma_f32_32x32x16_bf16 v[96:111], v[52:55], a[196:199], v[96:111]
  s_waitcnt lgkmcnt(6)
  ds_read_b64_tr_b16 a[100:101], v18 offset:24576
  ds_read_b64_tr_b16 a[102:103], v18 offset:26624
  buffer_load_dwordx4 v24, s[36:39], m0 offen lds
  v_add_f32 v27, v27, v117
  v_exp_f32 v119, v119
  v_fma_f32 v120, v120, s20, v30
  v_mfma_f32_32x32x16_bf16 v[96:111], v[56:59], a[200:203], v[96:111]
  ds_read_b64_tr_b16 a[104:105], v19 offset:24576
  ds_read_b64_tr_b16 a[106:107], v19 offset:26624
  buffer_load_dwordx4 v24, s[36:39], m0 offen offset:1024 lds
  v_add_f32 v26, v26, v118
  v_cvt_pk_bf16_f32 v91, v118, v119
  v_exp_f32 v120, v120
  v_fma_f32 v121, v121, s20, v30
  v_mfma_f32_32x32x16_bf16 v[96:111], v[60:63], a[204:207], v[96:111]
  s_waitcnt lgkmcnt(8)
  ds_read_b64_tr_b16 a[108:109], v20 offset:24576
  ds_read_b64_tr_b16 a[110:111], v20 offset:26624
  v_add_f32 v27, v27, v119
  v_exp_f32 v121, v121
  v_fma_f32 v122, v122, s20, v30
  v_mfma_f32_32x32x16_bf16 v[96:111], v[64:67], a[208:211], v[96:111]
  s_add_u32 m0, s21, 0x16000
  ds_read_b64_tr_b16 a[112:113], v17 offset:28672
  ds_read_b64_tr_b16 a[114:115], v17 offset:30720
  v_add_f32 v26, v26, v120
  v_cvt_pk_bf16_f32 v92, v120, v121
  v_exp_f32 v122, v122
  v_fma_f32 v123, v123, s20, v30
  v_mfma_f32_32x32x16_bf16 v[96:111], v[68:71], a[212:215], v[96:111]
  s_waitcnt lgkmcnt(10)
  ds_read_b64_tr_b16 a[116:117], v18 offset:28672
  ds_read_b64_tr_b16 a[118:119], v18 offset:30720
  buffer_load_dwordx4 v22, s[8:11], m0 offen lds
  v_add_f32 v27, v27, v121
  v_exp_f32 v123, v123
  v_fma_f32 v124, v124, s20, v30
  v_mfma_f32_32x32x16_bf16 v[96:111], v[72:75], a[216:219], v[96:111]
  ds_read_b64_tr_b16 a[120:121], v19 offset:28672
  ds_read_b64_tr_b16 a[122:123], v19 offset:30720
  buffer_load_dwordx4 v23, s[8:11], m0 offen offset:1024 lds
  v_add_f32 v26, v26, v122
  v_cvt_pk_bf16_f32 v93, v122, v123
  v_exp_f32 v124, v124
  v_fma_f32 v125, v125, s20, v30
  v_mfma_f32_32x32x16_bf16 v[96:111], v[76:79], a[220:223], v[96:111]
  s_waitcnt lgkmcnt(10)
  ds_read_b64_tr_b16 a[124:125], v20 offset:28672
  ds_read_b64_tr_b16 a[126:127], v20 offset:30720
  v_add_f32 v27, v27, v123
  v_exp_f32 v125, v125
  v_fma_f32 v126, v126, s20, v30
  v_mfma_f32_32x32x16_bf16 v[128:143], a[96:99], v[88:91], v[128:143]
  s_add_u32 m0, s21, 0x1c000
  ds_read_b128 v[48:51], v1 offset:40960
  v_add_f32 v26, v26, v124
  v_cvt_pk_bf16_f32 v94, v124, v125
  v_exp_f32 v126, v126
  v_fma_f32 v127, v127, s20, v30
  v_mfma_f32_32x32x16_bf16 v[144:159], a[100:103], v[88:91], v[144:159]
  s_waitcnt lgkmcnt(9)
  ds_read_b128 v[52:55], v2 offset:40960
  buffer_load_dwordx4 v24, s[36:39], m0 offen lds
  v_add_f32 v27, v27, v125
  v_exp_f32 v127, v127
  v_fma_f32 v96, v96, s20, v30
  v_mfma_f32_32x32x16_bf16 v[160:175], a[104:107], v[88:91], v[160:175]
  ds_read_b128 v[56:59], v3 offset:40960
  buffer_load_dwordx4 v24, s[36:39], m0 offen offset:1024 lds
  v_add_f32 v26, v26, v126
  v_cvt_pk_bf16_f32 v95, v126, v127
  v_exp_f32 v96, v96
  v_fma_f32 v97, v97, s20, v30
  v_mfma_f32_32x32x16_bf16 v[176:191], a[108:111], v[88:91], v[176:191]
  s_waitcnt lgkmcnt(7)
  ds_read_b128 v[60:63], v4 offset:40960
  v_add_f32 v27, v27, v127
  v_exp_f32 v97, v97
  v_fma_f32 v98, v98, s20, v30
  v_add_f32 v26, v26, v96
  v_mfma_f32_32x32x16_bf16 v[128:143], a[112:115], v[92:95], v[128:143]
  ds_read_b128 v[64:67], v5 offset:40960
  v_cvt_pk_bf16_f32 v80, v96, v97
  v_exp_f32 v98, v98
  v_fma_f32 v99, v99, s20, v30
  v_add_f32 v27, v27, v97
  v_mfma_f32_32x32x16_bf16 v[144:159], a[116:119], v[92:95], v[144:159]
  s_waitcnt lgkmcnt(5)
  ds_read_b128 v[68:71], v6 offset:40960
  v_exp_f32 v99, v99
  v_fma_f32 v100, v100, s20, v30
  v_add_f32 v26, v26, v98
  v_fma_f32 v101, v101, s20, v30
  v_mfma_f32_32x32x16_bf16 v[160:175], a[120:123], v[92:95], v[160:175]
  ds_read_b128 v[72:75], v7 offset:40960
  v_cvt_pk_bf16_f32 v81, v98, v99
  v_exp_f32 v100, v100
  v_add_f32 v27, v27, v99
  v_fma_f32 v102, v102, s20, v30
  v_mfma_f32_32x32x16_bf16 v[176:191], a[124:127], v[92:95], v[176:191]
  s_waitcnt vmcnt(22) lgkmcnt(5)
  s_barrier
  ds_read_b128 v[76:79], v8 offset:40960
  v_exp_f32 v101, v101
  v_add_f32 v26, v26, v100
  v_fma_f32 v103, v103, s20, v30
  v_mfma_f32_32x32x16_bf16 v[112:127], v[48:51], a[192:195], 0
  s_add_u32 m0, s21, 0x1e000
  ds_read_b64_tr_b16 a[128:129], v17 offset:32768
  ds_read_b64_tr_b16 a[130:131], v17 offset:34816
  v_cvt_pk_bf16_f32 v82, v100, v101
  v_exp_f32 v102, v102
  v_add_f32 v27, v27, v101
  v_mfma_f32_32x32x16_bf16 v[112:127], v[52:55], a[196:199], v[112:127]
  s_waitcnt lgkmcnt(6)
  ds_read_b64_tr_b16 a[132:133], v18 offset:32768
  ds_read_b64_tr_b16 a[134:135], v18 offset:34816
  buffer_load_dwordx4 v24, s[36:39], m0 offen lds
  v_exp_f32 v103, v103
  v_fma_f32 v104, v104, s20, v30
  v_mfma_f32_32x32x16_bf16 v[112:127], v[56:59], a[200:203], v[112:127]
  ds_read_b64_tr_b16 a[136:137], v19 offset:32768
  ds_read_b64_tr_b16 a[138:139], v19 offset:34816
  buffer_load_dwordx4 v24, s[36:39], m0 offen offset:1024 lds
  v_add_f32 v26, v26, v102
  v_cvt_pk_bf16_f32 v83, v102, v103
  v_exp_f32 v104, v104
  v_fma_f32 v105, v105, s20, v30
  v_mfma_f32_32x32x16_bf16 v[112:127], v[60:63], a[204:207], v[112:127]
  s_waitcnt lgkmcnt(8)
  ds_read_b64_tr_b16 a[140:141], v20 offset:32768
  ds_read_b64_tr_b16 a[142:143], v20 offset:34816
  v_add_f32 v27, v27, v103
  v_exp_f32 v105, v105
  v_fma_f32 v106, v106, s20, v30
  v_mfma_f32_32x32x16_bf16 v[112:127], v[64:67], a[208:211], v[112:127]
  ds_read_b64_tr_b16 a[144:145], v17 offset:36864
  ds_read_b64_tr_b16 a[146:147], v17 offset:38912
  v_add_f32 v26, v26, v104
  v_cvt_pk_bf16_f32 v84, v104, v105
  v_exp_f32 v106, v106
  v_fma_f32 v107, v107, s20, v30
  v_mfma_f32_32x32x16_bf16 v[112:127], v[68:71], a[212:215], v[112:127]
  s_waitcnt lgkmcnt(10)
  ds_read_b64_tr_b16 a[148:149], v18 offset:36864
  ds_read_b64_tr_b16 a[150:151], v18 offset:38912
  v_add_f32 v27, v27, v105
  v_exp_f32 v107, v107
  v_fma_f32 v108, v108, s20, v30
  v_mfma_f32_32x32x16_bf16 v[112:127], v[72:75], a[216:219], v[112:127]
  ds_read_b64_tr_b16 a[152:153], v19 offset:36864
  ds_read_b64_tr_b16 a[154:155], v19 offset:38912
  v_add_f32 v26, v26, v106
  v_cvt_pk_bf16_f32 v85, v106, v107
  v_exp_f32 v108, v108
  v_fma_f32 v109, v109, s20, v30
  v_mfma_f32_32x32x16_bf16 v[112:127], v[76:79], a[220:223], v[112:127]
  s_waitcnt lgkmcnt(10)
  ds_read_b64_tr_b16 a[156:157], v20 offset:36864
  ds_read_b64_tr_b16 a[158:159], v20 offset:38912
  v_add_f32 v27, v27, v107
  v_exp_f32 v109, v109
  v_fma_f32 v110, v110, s20, v30
  v_mfma_f32_32x32x16_bf16 v[128:143], a[128:131], v[80:83], v[128:143]
  ds_read_b128 v[48:51], v1 offset:49152
  v_add_f32 v26, v26, v108
  v_cvt_pk_bf16_f32 v86, v108, v109
  v_exp_f32 v110, v110
  v_fma_f32 v111, v111, s20, v30
  v_mfma_f32_32x32x16_bf16 v[144:159], a[132:135], v[80:83], v[144:159]
  s_waitcnt lgkmcnt(9)
  ds_read_b128 v[52:55], v2 offset:49152
  v_add_f32 v27, v27, v109
  v_exp_f32 v111, v111
  v_fma_f32 v112, v112, s20, v30
  v_add_f32 v26, v26, v110
  v_mfma_f32_32x32x16_bf16 v[160:175], a[136:139], v[80:83], v[160:175]
  ds_read_b128 v[56:59], v3 offset:49152
  v_cvt_pk_bf16_f32 v87, v110, v111
  v_exp_f32 v112, v112
  v_fma_f32 v113, v113, s20, v30
  v_add_f32 v27, v27, v111
  v_mfma_f32_32x32x16_bf16 v[176:191], a[140:143], v[80:83], v[176:191]
  s_waitcnt lgkmcnt(7)
  ds_read_b128 v[60:63], v4 offset:49152
  v_exp_f32 v113, v113
  v_fma_f32 v114, v114, s20, v30
  v_add_f32 v26, v26, v112
  v_fma_f32 v115, v115, s20, v30
  v_mfma_f32_32x32x16_bf16 v[128:143], a[144:147], v[84:87], v[128:143]
  ds_read_b128 v[64:67], v5 offset:49152
  v_cvt_pk_bf16_f32 v88, v112, v113
  v_exp_f32 v114, v114
  v_add_f32 v27, v27, v113
  v_fma_f32 v116, v116, s20, v30
  v_mfma_f32_32x32x16_bf16 v[144:159], a[148:151], v[84:87], v[144:159]
  s_waitcnt lgkmcnt(5)
  ds_read_b128 v[68:71], v6 offset:49152
  v_exp_f32 v115, v115
  v_add_f32 v26, v26, v114
  v_exp_f32 v116, v116
  v_mfma_f32_32x32x16_bf16 v[160:175], a[152:155], v[84:87], v[160:175]
  ds_read_b128 v[72:75], v7 offset:49152
  v_cvt_pk_bf16_f32 v89, v114, v115
  v_fma_f32 v117, v117, s20, v30
  v_add_f32 v27, v27, v115
  v_exp_f32 v117, v117
  v_mfma_f32_32x32x16_bf16 v[176:191], a[156:159], v[84:87], v[176:191]
  s_waitcnt vmcnt(20) lgkmcnt(5)
  s_barrier
  ds_read_b128 v[76:79], v8 offset:49152
  v_fma_f32 v118, v118, s20, v30
  v_add_f32 v26, v26, v116
  v_cvt_pk_bf16_f32 v90, v116, v117
  v_fma_f32 v119, v119, s20, v30
  v_mfma_f32_32x32x16_bf16 v[96:111], v[48:51], a[192:195], 0
  ds_read_b64_tr_b16 a[160:161], v17 offset:40960
  ds_read_b64_tr_b16 a[162:163], v17 offset:43008
  v_exp_f32 v118, v118
  v_add_f32 v27, v27, v117
  v_fma_f32 v120, v120, s20, v30
  v_mfma_f32_32x32x16_bf16 v[96:111], v[52:55], a[196:199], v[96:111]
  s_waitcnt lgkmcnt(6)
  ds_read_b64_tr_b16 a[164:165], v18 offset:40960
  ds_read_b64_tr_b16 a[166:167], v18 offset:43008
  v_exp_f32 v119, v119
  v_add_f32 v26, v26, v118
  v_fma_f32 v121, v121, s20, v30
  v_mfma_f32_32x32x16_bf16 v[96:111], v[56:59], a[200:203], v[96:111]
  ds_read_b64_tr_b16 a[168:169], v19 offset:40960
  ds_read_b64_tr_b16 a[170:171], v19 offset:43008
  v_cvt_pk_bf16_f32 v91, v118, v119
  v_exp_f32 v120, v120
  v_add_f32 v27, v27, v119
  v_mfma_f32_32x32x16_bf16 v[96:111], v[60:63], a[204:207], v[96:111]
  s_waitcnt lgkmcnt(8)
  ds_read_b64_tr_b16 a[172:173], v20 offset:40960
  ds_read_b64_tr_b16 a[174:175], v20 offset:43008
  v_exp_f32 v121, v121
  v_fma_f32 v122, v122, s20, v30
  v_add_f32 v26, v26, v120
  v_mfma_f32_32x32x16_bf16 v[96:111], v[64:67], a[208:211], v[96:111]
  ds_read_b64_tr_b16 a[176:177], v17 offset:45056
  ds_read_b64_tr_b16 a[178:179], v17 offset:47104
  v_cvt_pk_bf16_f32 v92, v120, v121
  v_exp_f32 v122, v122
  v_fma_f32 v123, v123, s20, v30
  v_mfma_f32_32x32x16_bf16 v[96:111], v[68:71], a[212:215], v[96:111]
  s_waitcnt lgkmcnt(10)
  ds_read_b64_tr_b16 a[180:181], v18 offset:45056
  ds_read_b64_tr_b16 a[182:183], v18 offset:47104
  v_add_f32 v27, v27, v121
  v_exp_f32 v123, v123
  v_fma_f32 v124, v124, s20, v30
  v_mfma_f32_32x32x16_bf16 v[96:111], v[72:75], a[216:219], v[96:111]
  ds_read_b64_tr_b16 a[184:185], v19 offset:45056
  ds_read_b64_tr_b16 a[186:187], v19 offset:47104
  v_add_f32 v26, v26, v122
  v_cvt_pk_bf16_f32 v93, v122, v123
  v_exp_f32 v124, v124
  v_fma_f32 v125, v125, s20, v30
  v_mfma_f32_32x32x16_bf16 v[96:111], v[76:79], a[220:223], v[96:111]
  s_waitcnt lgkmcnt(10)
  ds_read_b64_tr_b16 a[188:189], v20 offset:45056
  ds_read_b64_tr_b16 a[190:191], v20 offset:47104
  v_add_f32 v27, v27, v123
  v_exp_f32 v125, v125
  v_fma_f32 v126, v126, s20, v30
  v_mfma_f32_32x32x16_bf16 v[128:143], a[160:163], v[88:91], v[128:143]
  ds_read_b128 v[48:51], v1 offset:57344
  v_add_f32 v26, v26, v124
  v_cvt_pk_bf16_f32 v94, v124, v125
  v_exp_f32 v126, v126
  v_fma_f32 v127, v127, s20, v30
  v_mfma_f32_32x32x16_bf16 v[144:159], a[164:167], v[88:91], v[144:159]
  s_waitcnt lgkmcnt(9)
  ds_read_b128 v[52:55], v2 offset:57344
  v_add_f32 v27, v27, v125
  v_exp_f32 v127, v127
  v_fma_f32 v96, v96, s20, v30
  v_add_f32 v26, v26, v126
  v_mfma_f32_32x32x16_bf16 v[160:175], a[168:171], v[88:91], v[160:175]
  ds_read_b128 v[56:59], v3 offset:57344
  v_cvt_pk_bf16_f32 v95, v126, v127
  v_exp_f32 v96, v96
  v_fma_f32 v97, v97, s20, v30
  v_add_f32 v27, v27, v127
  v_mfma_f32_32x32x16_bf16 v[176:191], a[172:175], v[88:91], v[176:191]
  s_waitcnt lgkmcnt(7)
  ds_read_b128 v[60:63], v4 offset:57344
  v_exp_f32 v97, v97
  v_fma_f32 v98, v98, s20, v30
  v_add_f32 v26, v26, v96
  v_fma_f32 v99, v99, s20, v30
  v_mfma_f32_32x32x16_bf16 v[128:143], a[176:179], v[92:95], v[128:143]
  ds_read_b128 v[64:67], v5 offset:57344
  v_cvt_pk_bf16_f32 v80, v96, v97
  v_exp_f32 v98, v98
  v_add_f32 v27, v27, v97
  v_fma_f32 v100, v100, s20, v30
  v_mfma_f32_32x32x16_bf16 v[144:159], a[180:183], v[92:95], v[144:159]
  s_waitcnt lgkmcnt(5)
  ds_read_b128 v[68:71], v6 offset:57344
  v_exp_f32 v99, v99
  v_add_f32 v26, v26, v98
  v_exp_f32 v100, v100
  v_mfma_f32_32x32x16_bf16 v[160:175], a[184:187], v[92:95], v[160:175]
  ds_read_b128 v[72:75], v7 offset:57344
  buffer_load_dwordx4 a[224:227], v43, s[4:7], s40 offen
  v_cvt_pk_bf16_f32 v81, v98, v99
  v_fma_f32 v101, v101, s20, v30
  v_add_f32 v27, v27, v99
  v_fma_f32 v102, v102, s20, v30
  v_mfma_f32_32x32x16_bf16 v[176:191], a[188:191], v[92:95], v[176:191]
  s_waitcnt vmcnt(17) lgkmcnt(5)
  s_barrier
  ds_read_b128 v[76:79], v8 offset:57344
  v_exp_f32 v101, v101
  v_add_f32 v26, v26, v100
  v_fma_f32 v103, v103, s20, v30
  v_mfma_f32_32x32x16_bf16 v[112:127], v[48:51], a[192:195], 0
  ds_read_b64_tr_b16 v[48:49], v17 offset:49152
  ds_read_b64_tr_b16 v[50:51], v17 offset:51200
  v_cvt_pk_bf16_f32 v82, v100, v101
  v_exp_f32 v102, v102
  v_add_f32 v27, v27, v101
  v_mfma_f32_32x32x16_bf16 v[112:127], v[52:55], a[196:199], v[112:127]
  s_waitcnt lgkmcnt(6)
  ds_read_b64_tr_b16 v[52:53], v18 offset:49152
  ds_read_b64_tr_b16 v[54:55], v18 offset:51200
  v_exp_f32 v103, v103
  v_fma_f32 v104, v104, s20, v30
  v_add_f32 v26, v26, v102
  v_mfma_f32_32x32x16_bf16 v[112:127], v[56:59], a[200:203], v[112:127]
  ds_read_b64_tr_b16 v[56:57], v19 offset:49152
  ds_read_b64_tr_b16 v[58:59], v19 offset:51200
  v_cvt_pk_bf16_f32 v83, v102, v103
  v_exp_f32 v104, v104
  v_fma_f32 v105, v105, s20, v30
  v_mfma_f32_32x32x16_bf16 v[112:127], v[60:63], a[204:207], v[112:127]
  s_waitcnt lgkmcnt(8)
  ds_read_b64_tr_b16 v[60:61], v20 offset:49152
  ds_read_b64_tr_b16 v[62:63], v20 offset:51200
  v_add_f32 v27, v27, v103
  v_exp_f32 v105, v105
  v_fma_f32 v106, v106, s20, v30
  v_mfma_f32_32x32x16_bf16 v[112:127], v[64:67], a[208:211], v[112:127]
  ds_read_b64_tr_b16 v[64:65], v17 offset:53248
  ds_read_b64_tr_b16 v[66:67], v17 offset:55296
  v_add_f32 v26, v26, v104
  v_cvt_pk_bf16_f32 v84, v104, v105
  v_exp_f32 v106, v106
  v_fma_f32 v107, v107, s20, v30
  v_mfma_f32_32x32x16_bf16 v[112:127], v[68:71], a[212:215], v[112:127]
  s_waitcnt lgkmcnt(10)
  ds_read_b64_tr_b16 v[68:69], v18 offset:53248
  ds_read_b64_tr_b16 v[70:71], v18 offset:55296
  v_add_f32 v27, v27, v105
  v_exp_f32 v107, v107
  v_fma_f32 v108, v108, s20, v30
  v_mfma_f32_32x32x16_bf16 v[112:127], v[72:75], a[216:219], v[112:127]
  ds_read_b64_tr_b16 v[72:73], v19 offset:53248
  ds_read_b64_tr_b16 v[74:75], v19 offset:55296
  buffer_load_dwordx4 a[228:231], v43, s[4:7], s40 offen offset:32
  v_add_f32 v26, v26, v106
  v_cvt_pk_bf16_f32 v85, v106, v107
  v_exp_f32 v108, v108
  v_fma_f32 v109, v109, s20, v30
  v_mfma_f32_32x32x16_bf16 v[112:127], v[76:79], a[220:223], v[112:127]
  s_waitcnt lgkmcnt(10)
  ds_read_b64_tr_b16 v[76:77], v20 offset:53248
  ds_read_b64_tr_b16 v[78:79], v20 offset:55296
  v_add_f32 v27, v27, v107
  v_exp_f32 v109, v109
  v_fma_f32 v110, v110, s20, v30
  v_mfma_f32_32x32x16_bf16 v[128:143], v[48:51], v[80:83], v[128:143]
  ds_read_b128 v[48:51], v9
  v_add_f32 v26, v26, v108
  v_cvt_pk_bf16_f32 v86, v108, v109
  v_exp_f32 v110, v110
  v_fma_f32 v111, v111, s20, v30
  v_mfma_f32_32x32x16_bf16 v[144:159], v[52:55], v[80:83], v[144:159]
  s_waitcnt lgkmcnt(9)
  ds_read_b128 v[52:55], v10
  v_add_f32 v27, v27, v109
  v_exp_f32 v111, v111
  v_fma_f32 v112, v112, s20, v30
  v_add_f32 v26, v26, v110
  v_mfma_f32_32x32x16_bf16 v[160:175], v[56:59], v[80:83], v[160:175]
  ds_read_b128 v[56:59], v11
  v_cvt_pk_bf16_f32 v87, v110, v111
  v_exp_f32 v112, v112
  v_fma_f32 v113, v113, s20, v30
  v_add_f32 v27, v27, v111
  v_mfma_f32_32x32x16_bf16 v[176:191], v[60:63], v[80:83], v[176:191]
  s_waitcnt lgkmcnt(7)
  ds_read_b128 v[60:63], v12
  v_exp_f32 v113, v113
  v_fma_f32 v114, v114, s20, v30
  v_add_f32 v26, v26, v112
  v_fma_f32 v115, v115, s20, v30
  v_mfma_f32_32x32x16_bf16 v[128:143], v[64:67], v[84:87], v[128:143]
  ds_read_b128 v[64:67], v13
  v_cvt_pk_bf16_f32 v88, v112, v113
  v_exp_f32 v114, v114
  v_add_f32 v27, v27, v113
  v_fma_f32 v116, v116, s20, v30
  v_mfma_f32_32x32x16_bf16 v[144:159], v[68:71], v[84:87], v[144:159]
  s_waitcnt lgkmcnt(5)
  ds_read_b128 v[68:71], v14
  v_exp_f32 v115, v115
  v_add_f32 v26, v26, v114
  v_exp_f32 v116, v116
  v_mfma_f32_32x32x16_bf16 v[160:175], v[72:75], v[84:87], v[160:175]
  ds_read_b128 v[72:75], v15
  buffer_load_dwordx4 a[232:235], v43, s[4:7], s40 offen offset:64
  v_cvt_pk_bf16_f32 v89, v114, v115
  v_fma_f32 v117, v117, s20, v30
  v_add_f32 v27, v27, v115
  v_fma_f32 v118, v118, s20, v30
  v_mfma_f32_32x32x16_bf16 v[176:191], v[76:79], v[84:87], v[176:191]
  s_waitcnt vmcnt(15) lgkmcnt(5)
  s_barrier
  ds_read_b128 v[76:79], v16
  v_exp_f32 v117, v117
  v_add_f32 v26, v26, v116
  v_fma_f32 v119, v119, s20, v30
  v_mfma_f32_32x32x16_bf16 v[96:111], v[48:51], a[192:195], 0
  ds_read_b64_tr_b16 v[48:49], v17 offset:57344
  ds_read_b64_tr_b16 v[50:51], v17 offset:59392
  v_cvt_pk_bf16_f32 v90, v116, v117
  v_exp_f32 v118, v118
  v_add_f32 v27, v27, v117
  v_mfma_f32_32x32x16_bf16 v[96:111], v[52:55], a[196:199], v[96:111]
  s_waitcnt lgkmcnt(6)
  ds_read_b64_tr_b16 v[52:53], v18 offset:57344
  ds_read_b64_tr_b16 v[54:55], v18 offset:59392
  v_exp_f32 v119, v119
  v_fma_f32 v120, v120, s20, v30
  v_add_f32 v26, v26, v118
  v_mfma_f32_32x32x16_bf16 v[96:111], v[56:59], a[200:203], v[96:111]
  ds_read_b64_tr_b16 v[56:57], v19 offset:57344
  ds_read_b64_tr_b16 v[58:59], v19 offset:59392
  v_cvt_pk_bf16_f32 v91, v118, v119
  v_exp_f32 v120, v120
  v_fma_f32 v121, v121, s20, v30
  v_mfma_f32_32x32x16_bf16 v[96:111], v[60:63], a[204:207], v[96:111]
  s_waitcnt lgkmcnt(8)
  ds_read_b64_tr_b16 v[60:61], v20 offset:57344
  ds_read_b64_tr_b16 v[62:63], v20 offset:59392
  v_add_f32 v27, v27, v119
  v_exp_f32 v121, v121
  v_fma_f32 v122, v122, s20, v30
  v_mfma_f32_32x32x16_bf16 v[96:111], v[64:67], a[208:211], v[96:111]
  ds_read_b64_tr_b16 v[64:65], v17 offset:61440
  ds_read_b64_tr_b16 v[66:67], v17 offset:63488
  v_add_f32 v26, v26, v120
  v_cvt_pk_bf16_f32 v92, v120, v121
  v_exp_f32 v122, v122
  v_fma_f32 v123, v123, s20, v30
  v_mfma_f32_32x32x16_bf16 v[96:111], v[68:71], a[212:215], v[96:111]
  s_waitcnt lgkmcnt(10)
  ds_read_b64_tr_b16 v[68:69], v18 offset:61440
  ds_read_b64_tr_b16 v[70:71], v18 offset:63488
  v_add_f32 v27, v27, v121
  v_exp_f32 v123, v123
  v_fma_f32 v124, v124, s20, v30
  v_mfma_f32_32x32x16_bf16 v[96:111], v[72:75], a[216:219], v[96:111]
  ds_read_b64_tr_b16 v[72:73], v19 offset:61440
  ds_read_b64_tr_b16 v[74:75], v19 offset:63488
  buffer_load_dwordx4 a[236:239], v43, s[4:7], s40 offen offset:96
  v_add_f32 v26, v26, v122
  v_cvt_pk_bf16_f32 v93, v122, v123
  v_exp_f32 v124, v124
  v_fma_f32 v125, v125, s20, v30
  v_mfma_f32_32x32x16_bf16 v[96:111], v[76:79], a[220:223], v[96:111]
  s_waitcnt lgkmcnt(10)
  ds_read_b64_tr_b16 v[76:77], v20 offset:61440
  ds_read_b64_tr_b16 v[78:79], v20 offset:63488
  v_add_f32 v27, v27, v123
  v_exp_f32 v125, v125
  v_fma_f32 v126, v126, s20, v30
  v_mfma_f32_32x32x16_bf16 v[128:143], v[48:51], v[88:91], v[128:143]
  ds_read_b128 v[48:51], v9 offset:8192
  v_add_f32 v26, v26, v124
  v_cvt_pk_bf16_f32 v94, v124, v125
  v_exp_f32 v126, v126
  v_fma_f32 v127, v127, s20, v30
  v_mfma_f32_32x32x16_bf16 v[144:159], v[52:55], v[88:91], v[144:159]
  s_waitcnt lgkmcnt(9)
  ds_read_b128 v[52:55], v10 offset:8192
  v_add_f32 v27, v27, v125
  v_exp_f32 v127, v127
  v_fma_f32 v96, v96, s20, v30
  v_add_f32 v26, v26, v126
  v_mfma_f32_32x32x16_bf16 v[160:175], v[56:59], v[88:91], v[160:175]
  ds_read_b128 v[56:59], v11 offset:8192
  v_cvt_pk_bf16_f32 v95, v126, v127
  v_exp_f32 v96, v96
  v_fma_f32 v97, v97, s20, v30
  v_add_f32 v27, v27, v127
  v_mfma_f32_32x32x16_bf16 v[176:191], v[60:63], v[88:91], v[176:191]
  s_waitcnt lgkmcnt(7)
  ds_read_b128 v[60:63], v12 offset:8192
  v_exp_f32 v97, v97
  v_fma_f32 v98, v98, s20, v30
  v_add_f32 v26, v26, v96
  v_fma_f32 v99, v99, s20, v30
  v_mfma_f32_32x32x16_bf16 v[128:143], v[64:67], v[92:95], v[128:143]
  ds_read_b128 v[64:67], v13 offset:8192
  v_cvt_pk_bf16_f32 v80, v96, v97
  v_exp_f32 v98, v98
  v_add_f32 v27, v27, v97
  v_fma_f32 v100, v100, s20, v30
  v_mfma_f32_32x32x16_bf16 v[144:159], v[68:71], v[92:95], v[144:159]
  s_waitcnt lgkmcnt(5)
  ds_read_b128 v[68:71], v14 offset:8192
  v_exp_f32 v99, v99
  v_add_f32 v26, v26, v98
  v_exp_f32 v100, v100
  v_mfma_f32_32x32x16_bf16 v[160:175], v[72:75], v[92:95], v[160:175]
  ds_read_b128 v[72:75], v15 offset:8192
  buffer_load_dwordx4 a[240:243], v43, s[4:7], s40 offen offset:128
  v_cvt_pk_bf16_f32 v81, v98, v99
  v_fma_f32 v101, v101, s20, v30
  v_add_f32 v27, v27, v99
  v_fma_f32 v102, v102, s20, v30
  v_mfma_f32_32x32x16_bf16 v[176:191], v[76:79], v[92:95], v[176:191]
  s_waitcnt vmcnt(13) lgkmcnt(5)
  s_barrier
  ds_read_b128 v[76:79], v16 offset:8192
  v_exp_f32 v101, v101
  v_add_f32 v26, v26, v100
  v_fma_f32 v103, v103, s20, v30
  v_mfma_f32_32x32x16_bf16 v[112:127], v[48:51], a[192:195], 0
  ds_read_b64_tr_b16 v[48:49], v17
  ds_read_b64_tr_b16 v[50:51], v17 offset:2048
  v_cvt_pk_bf16_f32 v82, v100, v101
  v_exp_f32 v102, v102
  v_add_f32 v27, v27, v101
  v_mfma_f32_32x32x16_bf16 v[112:127], v[52:55], a[196:199], v[112:127]
  s_waitcnt lgkmcnt(6)
  ds_read_b64_tr_b16 v[52:53], v18
  ds_read_b64_tr_b16 v[54:55], v18 offset:2048
  v_exp_f32 v103, v103
  v_fma_f32 v104, v104, s20, v30
  v_add_f32 v26, v26, v102
  v_mfma_f32_32x32x16_bf16 v[112:127], v[56:59], a[200:203], v[112:127]
  ds_read_b64_tr_b16 v[56:57], v19
  ds_read_b64_tr_b16 v[58:59], v19 offset:2048
  v_cvt_pk_bf16_f32 v83, v102, v103
  v_exp_f32 v104, v104
  v_fma_f32 v105, v105, s20, v30
  v_mfma_f32_32x32x16_bf16 v[112:127], v[60:63], a[204:207], v[112:127]
  s_waitcnt lgkmcnt(8)
  ds_read_b64_tr_b16 v[60:61], v20
  ds_read_b64_tr_b16 v[62:63], v20 offset:2048
  v_add_f32 v27, v27, v103
  v_exp_f32 v105, v105
  v_fma_f32 v106, v106, s20, v30
  v_mfma_f32_32x32x16_bf16 v[112:127], v[64:67], a[208:211], v[112:127]
  ds_read_b64_tr_b16 v[64:65], v17 offset:4096
  ds_read_b64_tr_b16 v[66:67], v17 offset:6144
  v_add_f32 v26, v26, v104
  v_cvt_pk_bf16_f32 v84, v104, v105
  v_exp_f32 v106, v106
  v_fma_f32 v107, v107, s20, v30
  v_mfma_f32_32x32x16_bf16 v[112:127], v[68:71], a[212:215], v[112:127]
  s_waitcnt lgkmcnt(10)
  ds_read_b64_tr_b16 v[68:69], v18 offset:4096
  ds_read_b64_tr_b16 v[70:71], v18 offset:6144
  v_add_f32 v27, v27, v105
  v_exp_f32 v107, v107
  v_fma_f32 v108, v108, s20, v30
  v_mfma_f32_32x32x16_bf16 v[112:127], v[72:75], a[216:219], v[112:127]
  ds_read_b64_tr_b16 v[72:73], v19 offset:4096
  ds_read_b64_tr_b16 v[74:75], v19 offset:6144
  buffer_load_dwordx4 a[244:247], v43, s[4:7], s40 offen offset:160
  v_add_f32 v26, v26, v106
  v_cvt_pk_bf16_f32 v85, v106, v107
  v_exp_f32 v108, v108
  v_fma_f32 v109, v109, s20, v30
  v_mfma_f32_32x32x16_bf16 v[112:127], v[76:79], a[220:223], v[112:127]
  s_waitcnt lgkmcnt(10)
  ds_read_b64_tr_b16 v[76:77], v20 offset:4096
  ds_read_b64_tr_b16 v[78:79], v20 offset:6144
  v_add_f32 v27, v27, v107
  v_exp_f32 v109, v109
  v_fma_f32 v110, v110, s20, v30
  v_mfma_f32_32x32x16_bf16 v[128:143], v[48:51], v[80:83], v[128:143]
  ds_read_b128 v[48:51], v9 offset:16384
  v_add_f32 v26, v26, v108
  v_cvt_pk_bf16_f32 v86, v108, v109
  v_exp_f32 v110, v110
  v_fma_f32 v111, v111, s20, v30
  v_mfma_f32_32x32x16_bf16 v[144:159], v[52:55], v[80:83], v[144:159]
  s_waitcnt lgkmcnt(9)
  ds_read_b128 v[52:55], v10 offset:16384
  v_add_f32 v27, v27, v109
  v_exp_f32 v111, v111
  v_fma_f32 v112, v112, s20, v30
  v_add_f32 v26, v26, v110
  v_mfma_f32_32x32x16_bf16 v[160:175], v[56:59], v[80:83], v[160:175]
  ds_read_b128 v[56:59], v11 offset:16384
  v_cvt_pk_bf16_f32 v87, v110, v111
  v_exp_f32 v112, v112
  v_fma_f32 v113, v113, s20, v30
  v_add_f32 v27, v27, v111
  v_mfma_f32_32x32x16_bf16 v[176:191], v[60:63], v[80:83], v[176:191]
  s_waitcnt lgkmcnt(7)
  ds_read_b128 v[60:63], v12 offset:16384
  v_exp_f32 v113, v113
  v_fma_f32 v114, v114, s20, v30
  v_add_f32 v26, v26, v112
  v_fma_f32 v115, v115, s20, v30
  v_mfma_f32_32x32x16_bf16 v[128:143], v[64:67], v[84:87], v[128:143]
  ds_read_b128 v[64:67], v13 offset:16384
  v_cvt_pk_bf16_f32 v88, v112, v113
  v_exp_f32 v114, v114
  v_add_f32 v27, v27, v113
  v_fma_f32 v116, v116, s20, v30
  v_mfma_f32_32x32x16_bf16 v[144:159], v[68:71], v[84:87], v[144:159]
  s_waitcnt lgkmcnt(5)
  ds_read_b128 v[68:71], v14 offset:16384
  v_exp_f32 v115, v115
  v_add_f32 v26, v26, v114
  v_exp_f32 v116, v116
  v_mfma_f32_32x32x16_bf16 v[160:175], v[72:75], v[84:87], v[160:175]
  ds_read_b128 v[72:75], v15 offset:16384
  buffer_load_dwordx4 a[248:251], v43, s[4:7], s40 offen offset:192
  v_cvt_pk_bf16_f32 v89, v114, v115
  v_fma_f32 v117, v117, s20, v30
  v_add_f32 v27, v27, v115
  v_fma_f32 v118, v118, s20, v30
  v_mfma_f32_32x32x16_bf16 v[176:191], v[76:79], v[84:87], v[176:191]
  s_waitcnt vmcnt(11) lgkmcnt(5)
  s_barrier
  ds_read_b128 v[76:79], v16 offset:16384
  v_exp_f32 v117, v117
  v_add_f32 v26, v26, v116
  v_fma_f32 v119, v119, s20, v30
  v_mfma_f32_32x32x16_bf16 v[96:111], v[48:51], a[192:195], 0
  ds_read_b64_tr_b16 v[48:49], v17 offset:8192
  ds_read_b64_tr_b16 v[50:51], v17 offset:10240
  v_cvt_pk_bf16_f32 v90, v116, v117
  v_exp_f32 v118, v118
  v_add_f32 v27, v27, v117
  v_mfma_f32_32x32x16_bf16 v[96:111], v[52:55], a[196:199], v[96:111]
  s_waitcnt lgkmcnt(6)
  ds_read_b64_tr_b16 v[52:53], v18 offset:8192
  ds_read_b64_tr_b16 v[54:55], v18 offset:10240
  v_exp_f32 v119, v119
  v_fma_f32 v120, v120, s20, v30
  v_add_f32 v26, v26, v118
  v_mfma_f32_32x32x16_bf16 v[96:111], v[56:59], a[200:203], v[96:111]
  ds_read_b64_tr_b16 v[56:57], v19 offset:8192
  ds_read_b64_tr_b16 v[58:59], v19 offset:10240
  v_cvt_pk_bf16_f32 v91, v118, v119
  v_exp_f32 v120, v120
  v_fma_f32 v121, v121, s20, v30
  v_mfma_f32_32x32x16_bf16 v[96:111], v[60:63], a[204:207], v[96:111]
  s_waitcnt lgkmcnt(8)
  ds_read_b64_tr_b16 v[60:61], v20 offset:8192
  ds_read_b64_tr_b16 v[62:63], v20 offset:10240
  v_add_f32 v27, v27, v119
  v_exp_f32 v121, v121
  v_fma_f32 v122, v122, s20, v30
  v_mfma_f32_32x32x16_bf16 v[96:111], v[64:67], a[208:211], v[96:111]
  ds_read_b64_tr_b16 v[64:65], v17 offset:12288
  ds_read_b64_tr_b16 v[66:67], v17 offset:14336
  v_add_f32 v26, v26, v120
  v_cvt_pk_bf16_f32 v92, v120, v121
  v_exp_f32 v122, v122
  v_fma_f32 v123, v123, s20, v30
  v_mfma_f32_32x32x16_bf16 v[96:111], v[68:71], a[212:215], v[96:111]
  s_waitcnt lgkmcnt(10)
  ds_read_b64_tr_b16 v[68:69], v18 offset:12288
  ds_read_b64_tr_b16 v[70:71], v18 offset:14336
  v_add_f32 v27, v27, v121
  v_exp_f32 v123, v123
  v_fma_f32 v124, v124, s20, v30
  v_mfma_f32_32x32x16_bf16 v[96:111], v[72:75], a[216:219], v[96:111]
  ds_read_b64_tr_b16 v[72:73], v19 offset:12288
  ds_read_b64_tr_b16 v[74:75], v19 offset:14336
  buffer_load_dwordx4 a[252:255], v43, s[4:7], s40 offen offset:224
  v_add_f32 v26, v26, v122
  v_cvt_pk_bf16_f32 v93, v122, v123
  v_exp_f32 v124, v124
  v_fma_f32 v125, v125, s20, v30
  v_mfma_f32_32x32x16_bf16 v[96:111], v[76:79], a[220:223], v[96:111]
  s_waitcnt lgkmcnt(10)
  ds_read_b64_tr_b16 v[76:77], v20 offset:12288
  ds_read_b64_tr_b16 v[78:79], v20 offset:14336
  v_add_f32 v27, v27, v123
  v_exp_f32 v125, v125
  v_fma_f32 v126, v126, s20, v30
  v_mfma_f32_32x32x16_bf16 v[128:143], v[48:51], v[88:91], v[128:143]
  ds_read_b128 v[48:51], v9 offset:24576
  v_add_f32 v26, v26, v124
  v_cvt_pk_bf16_f32 v94, v124, v125
  v_exp_f32 v126, v126
  v_fma_f32 v127, v127, s20, v30
  v_mfma_f32_32x32x16_bf16 v[144:159], v[52:55], v[88:91], v[144:159]
  s_waitcnt lgkmcnt(9)
  ds_read_b128 v[52:55], v10 offset:24576
  v_add_f32 v27, v27, v125
  v_exp_f32 v127, v127
  v_fma_f32 v96, v96, s20, v30
  v_add_f32 v26, v26, v126
  v_mfma_f32_32x32x16_bf16 v[160:175], v[56:59], v[88:91], v[160:175]
  ds_read_b128 v[56:59], v11 offset:24576
  v_cvt_pk_bf16_f32 v95, v126, v127
  v_exp_f32 v96, v96
  v_fma_f32 v97, v97, s20, v30
  v_add_f32 v27, v27, v127
  v_mfma_f32_32x32x16_bf16 v[176:191], v[60:63], v[88:91], v[176:191]
  s_waitcnt lgkmcnt(7)
  ds_read_b128 v[60:63], v12 offset:24576
  v_exp_f32 v97, v97
  v_fma_f32 v98, v98, s20, v30
  v_add_f32 v26, v26, v96
  v_fma_f32 v99, v99, s20, v30
  v_mfma_f32_32x32x16_bf16 v[128:143], v[64:67], v[92:95], v[128:143]
  ds_read_b128 v[64:67], v13 offset:24576
  v_cvt_pk_bf16_f32 v80, v96, v97
  v_exp_f32 v98, v98
  v_add_f32 v27, v27, v97
  v_fma_f32 v100, v100, s20, v30
  v_mfma_f32_32x32x16_bf16 v[144:159], v[68:71], v[92:95], v[144:159]
  s_waitcnt lgkmcnt(5)
  ds_read_b128 v[68:71], v14 offset:24576
  v_exp_f32 v99, v99
  v_add_f32 v26, v26, v98
  v_exp_f32 v100, v100
  v_mfma_f32_32x32x16_bf16 v[160:175], v[72:75], v[92:95], v[160:175]
  ds_read_b128 v[72:75], v15 offset:24576
  v_cvt_pk_bf16_f32 v81, v98, v99
  v_fma_f32 v101, v101, s20, v30
  v_add_f32 v27, v27, v99
  v_exp_f32 v101, v101
  v_mfma_f32_32x32x16_bf16 v[176:191], v[76:79], v[92:95], v[176:191]
  s_waitcnt vmcnt(10) lgkmcnt(5)
  s_barrier
  ds_read_b128 v[76:79], v16 offset:24576
  v_fma_f32 v102, v102, s20, v30
  v_add_f32 v26, v26, v100
  v_cvt_pk_bf16_f32 v82, v100, v101
  v_fma_f32 v103, v103, s20, v30
  v_mfma_f32_32x32x16_bf16 v[112:127], v[48:51], a[192:195], 0
  ds_read_b64_tr_b16 v[48:49], v17 offset:16384
  ds_read_b64_tr_b16 v[50:51], v17 offset:18432
  v_exp_f32 v102, v102
  v_add_f32 v27, v27, v101
  v_fma_f32 v104, v104, s20, v30
  v_mfma_f32_32x32x16_bf16 v[112:127], v[52:55], a[196:199], v[112:127]
  s_waitcnt lgkmcnt(6)
  ds_read_b64_tr_b16 v[52:53], v18 offset:16384
  ds_read_b64_tr_b16 v[54:55], v18 offset:18432
  v_exp_f32 v103, v103
  v_add_f32 v26, v26, v102
  v_fma_f32 v105, v105, s20, v30
  v_mfma_f32_32x32x16_bf16 v[112:127], v[56:59], a[200:203], v[112:127]
  ds_read_b64_tr_b16 v[56:57], v19 offset:16384
  ds_read_b64_tr_b16 v[58:59], v19 offset:18432
  v_cvt_pk_bf16_f32 v83, v102, v103
  v_exp_f32 v104, v104
  v_add_f32 v27, v27, v103
  v_mfma_f32_32x32x16_bf16 v[112:127], v[60:63], a[204:207], v[112:127]
  s_waitcnt lgkmcnt(8)
  ds_read_b64_tr_b16 v[60:61], v20 offset:16384
  ds_read_b64_tr_b16 v[62:63], v20 offset:18432
  v_exp_f32 v105, v105
  v_fma_f32 v106, v106, s20, v30
  v_add_f32 v26, v26, v104
  v_mfma_f32_32x32x16_bf16 v[112:127], v[64:67], a[208:211], v[112:127]
  ds_read_b64_tr_b16 v[64:65], v17 offset:20480
  ds_read_b64_tr_b16 v[66:67], v17 offset:22528
  v_cvt_pk_bf16_f32 v84, v104, v105
  v_exp_f32 v106, v106
  v_fma_f32 v107, v107, s20, v30
  v_mfma_f32_32x32x16_bf16 v[112:127], v[68:71], a[212:215], v[112:127]
  s_waitcnt lgkmcnt(10)
  ds_read_b64_tr_b16 v[68:69], v18 offset:20480
  ds_read_b64_tr_b16 v[70:71], v18 offset:22528
  v_add_f32 v27, v27, v105
  v_exp_f32 v107, v107
  v_fma_f32 v108, v108, s20, v30
  v_mfma_f32_32x32x16_bf16 v[112:127], v[72:75], a[216:219], v[112:127]
  ds_read_b64_tr_b16 v[72:73], v19 offset:20480
  ds_read_b64_tr_b16 v[74:75], v19 offset:22528
  v_add_f32 v26, v26, v106
  v_cvt_pk_bf16_f32 v85, v106, v107
  v_exp_f32 v108, v108
  v_fma_f32 v109, v109, s20, v30
  v_mfma_f32_32x32x16_bf16 v[112:127], v[76:79], a[220:223], v[112:127]
  s_waitcnt lgkmcnt(10)
  ds_read_b64_tr_b16 v[76:77], v20 offset:20480
  ds_read_b64_tr_b16 v[78:79], v20 offset:22528
  v_add_f32 v27, v27, v107
  v_exp_f32 v109, v109
  v_fma_f32 v110, v110, s20, v30
  v_mfma_f32_32x32x16_bf16 v[128:143], v[48:51], v[80:83], v[128:143]
  ds_read_b128 v[48:51], v1
  v_add_f32 v26, v26, v108
  v_cvt_pk_bf16_f32 v86, v108, v109
  v_exp_f32 v110, v110
  v_fma_f32 v111, v111, s20, v30
  v_mfma_f32_32x32x16_bf16 v[144:159], v[52:55], v[80:83], v[144:159]
  s_waitcnt lgkmcnt(9)
  ds_read_b128 v[52:55], v2
  v_add_f32 v27, v27, v109
  v_exp_f32 v111, v111
  v_fma_f32 v112, v112, s20, v30
  v_add_f32 v26, v26, v110
  v_mfma_f32_32x32x16_bf16 v[160:175], v[56:59], v[80:83], v[160:175]
  ds_read_b128 v[56:59], v3
  v_cvt_pk_bf16_f32 v87, v110, v111
  v_exp_f32 v112, v112
  v_fma_f32 v113, v113, s20, v30
  v_add_f32 v27, v27, v111
  v_mfma_f32_32x32x16_bf16 v[176:191], v[60:63], v[80:83], v[176:191]
  s_waitcnt lgkmcnt(7)
  ds_read_b128 v[60:63], v4
  v_exp_f32 v113, v113
  v_fma_f32 v114, v114, s20, v30
  v_add_f32 v26, v26, v112
  v_fma_f32 v115, v115, s20, v30
  v_mfma_f32_32x32x16_bf16 v[128:143], v[64:67], v[84:87], v[128:143]
  ds_read_b128 v[64:67], v5
  v_cvt_pk_bf16_f32 v88, v112, v113
  v_exp_f32 v114, v114
  v_add_f32 v27, v27, v113
  v_fma_f32 v116, v116, s20, v30
  v_mfma_f32_32x32x16_bf16 v[144:159], v[68:71], v[84:87], v[144:159]
  s_waitcnt lgkmcnt(5)
  ds_read_b128 v[68:71], v6
  v_exp_f32 v115, v115
  v_add_f32 v26, v26, v114
  v_exp_f32 v116, v116
  v_mfma_f32_32x32x16_bf16 v[160:175], v[72:75], v[84:87], v[160:175]
  ds_read_b128 v[72:75], v7
  v_cvt_pk_bf16_f32 v89, v114, v115
  v_fma_f32 v117, v117, s20, v30
  v_add_f32 v27, v27, v115
  v_exp_f32 v117, v117
  v_mfma_f32_32x32x16_bf16 v[176:191], v[76:79], v[84:87], v[176:191]
  s_waitcnt vmcnt(6) lgkmcnt(5)
  s_barrier
  ds_read_b128 v[76:79], v8
  v_fma_f32 v118, v118, s20, v30
  v_add_f32 v26, v26, v116
  v_cvt_pk_bf16_f32 v90, v116, v117
  v_fma_f32 v119, v119, s20, v30
  v_mfma_f32_32x32x16_bf16 v[96:111], v[48:51], a[224:227], 0
  ds_read_b64_tr_b16 v[48:49], v17 offset:24576
  ds_read_b64_tr_b16 v[50:51], v17 offset:26624
  v_exp_f32 v118, v118
  v_add_f32 v27, v27, v117
  v_fma_f32 v120, v120, s20, v30
  v_mfma_f32_32x32x16_bf16 v[96:111], v[52:55], a[228:231], v[96:111]
  s_waitcnt vmcnt(4) lgkmcnt(6)
  ds_read_b64_tr_b16 v[52:53], v18 offset:24576
  ds_read_b64_tr_b16 v[54:55], v18 offset:26624
  v_exp_f32 v119, v119
  v_add_f32 v26, v26, v118
  v_fma_f32 v121, v121, s20, v30
  v_mfma_f32_32x32x16_bf16 v[96:111], v[56:59], a[232:235], v[96:111]
  ds_read_b64_tr_b16 v[56:57], v19 offset:24576
  ds_read_b64_tr_b16 v[58:59], v19 offset:26624
  v_cvt_pk_bf16_f32 v91, v118, v119
  v_exp_f32 v120, v120
  v_add_f32 v27, v27, v119
  v_mfma_f32_32x32x16_bf16 v[96:111], v[60:63], a[236:239], v[96:111]
  s_waitcnt vmcnt(2) lgkmcnt(8)
  ds_read_b64_tr_b16 v[60:61], v20 offset:24576
  ds_read_b64_tr_b16 v[62:63], v20 offset:26624
  v_exp_f32 v121, v121
  v_fma_f32 v122, v122, s20, v30
  v_add_f32 v26, v26, v120
  v_mfma_f32_32x32x16_bf16 v[96:111], v[64:67], a[240:243], v[96:111]
  ds_read_b64_tr_b16 v[64:65], v17 offset:28672
  ds_read_b64_tr_b16 v[66:67], v17 offset:30720
  v_cvt_pk_bf16_f32 v92, v120, v121
  v_exp_f32 v122, v122
  v_fma_f32 v123, v123, s20, v30
  v_mfma_f32_32x32x16_bf16 v[96:111], v[68:71], a[244:247], v[96:111]
  s_waitcnt vmcnt(0) lgkmcnt(10)
  ds_read_b64_tr_b16 v[68:69], v18 offset:28672
  ds_read_b64_tr_b16 v[70:71], v18 offset:30720
  v_add_f32 v27, v27, v121
  v_exp_f32 v123, v123
  v_fma_f32 v124, v124, s20, v30
  v_mfma_f32_32x32x16_bf16 v[96:111], v[72:75], a[248:251], v[96:111]
  ds_read_b64_tr_b16 v[72:73], v19 offset:28672
  ds_read_b64_tr_b16 v[74:75], v19 offset:30720
  v_add_f32 v26, v26, v122
  v_cvt_pk_bf16_f32 v93, v122, v123
  v_exp_f32 v124, v124
  v_fma_f32 v125, v125, s20, v30
  v_mfma_f32_32x32x16_bf16 v[96:111], v[76:79], a[252:255], v[96:111]
  s_waitcnt lgkmcnt(10)
  ds_read_b64_tr_b16 v[76:77], v20 offset:28672
  ds_read_b64_tr_b16 v[78:79], v20 offset:30720
  v_add_f32 v27, v27, v123
  v_exp_f32 v125, v125
  v_fma_f32 v126, v126, s20, v30
  v_mfma_f32_32x32x16_bf16 v[128:143], v[48:51], v[88:91], v[128:143]
  ds_read_b128 v[48:51], v1 offset:8192
  v_add_f32 v26, v26, v124
  v_cvt_pk_bf16_f32 v94, v124, v125
  v_exp_f32 v126, v126
  v_fma_f32 v127, v127, s20, v30
  v_mfma_f32_32x32x16_bf16 v[144:159], v[52:55], v[88:91], v[144:159]
  s_waitcnt lgkmcnt(9)
  ds_read_b128 v[52:55], v2 offset:8192
  v_add_f32 v27, v27, v125
  v_exp_f32 v127, v127
  v_max3_f32 v32, v96, v97, v98
  v_max3_f32 v33, v99, v100, v101
  v_max3_f32 v32, v32, v102, v103
  v_max3_f32 v33, v33, v104, v105
  v_mfma_f32_32x32x16_bf16 v[160:175], v[56:59], v[88:91], v[160:175]
  ds_read_b128 v[56:59], v3 offset:8192
  v_add_f32 v26, v26, v126
  v_cvt_pk_bf16_f32 v95, v126, v127
  v_max3_f32 v32, v32, v106, v107
  v_max3_f32 v33, v33, v108, v109
  v_max3_f32 v32, v32, v110, v111
  v_max_f32 v32, v32, v33
  v_max_f32 v33, v32, v33
  v_mfma_f32_32x32x16_bf16 v[176:191], v[60:63], v[88:91], v[176:191]
  s_waitcnt lgkmcnt(7)
  ds_read_b128 v[60:63], v4 offset:8192
  v_add_f32 v27, v27, v127
  v_permlane32_swap_b32 v32, v33
  v_max_f32 v32, v32, v33
  v_mul_f32 v31, s23, v32
  v_fma_f32 v96, v96, s20, v31
  v_fma_f32 v97, v97, s20, v31
  v_mfma_f32_32x32x16_bf16 v[128:143], v[64:67], v[92:95], v[128:143]
  ds_read_b128 v[64:67], v5 offset:8192
  v_exp_f32 v96, v96
  v_exp_f32 v97, v97
  v_fma_f32 v98, v98, s20, v31
  v_mfma_f32_32x32x16_bf16 v[144:159], v[68:71], v[92:95], v[144:159]
  s_waitcnt lgkmcnt(5)
  ds_read_b128 v[68:71], v6 offset:8192
  v_cvt_pk_bf16_f32 v80, v96, v97
  v_exp_f32 v98, v98
  v_fma_f32 v99, v99, s20, v31
  v_mov_b32 v28, v96
  v_mfma_f32_32x32x16_bf16 v[160:175], v[72:75], v[92:95], v[160:175]
  ds_read_b128 v[72:75], v7 offset:8192
  v_mov_b32 v29, v97
  v_exp_f32 v99, v99
  v_fma_f32 v100, v100, s20, v31
  v_add_f32 v40, v26, v27
  v_add_f32 v41, v26, v27
  v_mfma_f32_32x32x16_bf16 v[176:191], v[76:79], v[92:95], v[176:191]
  s_waitcnt lgkmcnt(5)
  ds_read_b128 v[76:79], v8 offset:8192
  v_add_f32 v28, v28, v98
  v_cvt_pk_bf16_f32 v81, v98, v99
  v_exp_f32 v100, v100
  v_fma_f32 v101, v101, s20, v31
  v_permlane32_swap_b32 v40, v41
  v_mfma_f32_32x32x16_bf16 v[112:127], v[48:51], a[224:227], 0
  v_add_f32 v29, v29, v99
  v_exp_f32 v101, v101
  v_fma_f32 v102, v102, s20, v31
  v_add_f32 v40, v40, v41
  v_cmp_nge_f32 vcc, 0x47800000, v40
  v_rcp_f32 v40, v40
  v_mfma_f32_32x32x16_bf16 v[112:127], v[52:55], a[228:231], v[112:127]
  s_waitcnt lgkmcnt(4)
  v_add_f32 v28, v28, v100
  v_cvt_pk_bf16_f32 v82, v100, v101
  v_exp_f32 v102, v102
  v_fma_f32 v103, v103, s20, v31
  s_cbranch_vccz L_OK0
  s_call_b64 s[32:33], L_SLOW0
L_OK0:
  v_mfma_f32_32x32x16_bf16 v[112:127], v[56:59], a[232:235], v[112:127]
  v_add_f32 v29, v29, v101
  v_exp_f32 v103, v103
  v_fma_f32 v104, v104, s20, v31
  v_fma_f32 v105, v105, s20, v31
  v_mul_f32 v128, v128, v40
  v_mfma_f32_32x32x16_bf16 v[112:127], v[60:63], a[236:239], v[112:127]
  s_waitcnt lgkmcnt(2)
  v_add_f32 v28, v28, v102
  v_cvt_pk_bf16_f32 v83, v102, v103
  v_exp_f32 v104, v104
  v_exp_f32 v105, v105
  v_fma_f32 v106, v106, s20, v31
  v_mul_f32 v129, v129, v40
  v_mfma_f32_32x32x16_bf16 v[112:127], v[64:67], a[240:243], v[112:127]
  v_add_f32 v29, v29, v103
  v_cvt_pk_bf16_f32 v84, v104, v105
  v_exp_f32 v106, v106
  v_fma_f32 v107, v107, s20, v31
  v_mul_f32 v130, v130, v40
  v_mfma_f32_32x32x16_bf16 v[112:127], v[68:71], a[244:247], v[112:127]
  s_waitcnt lgkmcnt(0)
  v_add_f32 v28, v28, v104
  v_add_f32 v29, v29, v105
  v_exp_f32 v107, v107
  v_fma_f32 v108, v108, s20, v31
  v_mul_f32 v131, v131, v40
  v_mfma_f32_32x32x16_bf16 v[112:127], v[72:75], a[248:251], v[112:127]
  v_add_f32 v28, v28, v106
  v_cvt_pk_bf16_f32 v85, v106, v107
  v_exp_f32 v108, v108
  v_fma_f32 v109, v109, s20, v31
  v_mul_f32 v132, v132, v40
  v_mfma_f32_32x32x16_bf16 v[112:127], v[76:79], a[252:255], v[112:127]
  v_add_f32 v29, v29, v107
  v_exp_f32 v109, v109
  v_fma_f32 v110, v110, s20, v31
  v_mul_f32 v133, v133, v40
  v_add_f32 v28, v28, v108
  v_mfma_f32_32x32x16_bf16 v[192:207], a[0:3], v[80:83], 0
  ds_read_b128 v[48:51], v1 offset:16384
  v_cvt_pk_bf16_f32 v86, v108, v109
  v_exp_f32 v110, v110
  v_fma_f32 v111, v111, s20, v31
  v_mul_f32 v134, v134, v40
  v_mfma_f32_32x32x16_bf16 v[208:223], a[4:7], v[80:83], 0
  ds_read_b128 v[52:55], v2 offset:16384
  v_add_f32 v29, v29, v109
  v_exp_f32 v111, v111
  v_mul_f32 v135, v135, v40
  v_fma_f32 v112, v112, s20, v31
  v_mfma_f32_32x32x16_bf16 v[224:239], a[8:11], v[80:83], 0
  ds_read_b128 v[56:59], v3 offset:16384
  v_add_f32 v28, v28, v110
  v_cvt_pk_bf16_f32 v87, v110, v111
  v_cvt_pk_bf16_f32 v128, v128, v129
  v_exp_f32 v112, v112
  v_fma_f32 v113, v113, s20, v31
  v_mfma_f32_32x32x16_bf16 v[240:255], a[12:15], v[80:83], 0
  ds_read_b128 v[60:63], v4 offset:16384
  v_add_f32 v29, v29, v111
  v_cvt_pk_bf16_f32 v129, v130, v131
  v_exp_f32 v113, v113
  v_fma_f32 v114, v114, s20, v31
  v_mfma_f32_32x32x16_bf16 v[192:207], a[16:19], v[84:87], v[192:207]
  ds_read_b128 v[64:67], v5 offset:16384
  v_cvt_pk_bf16_f32 v130, v132, v133
  v_cvt_pk_bf16_f32 v88, v112, v113
  v_exp_f32 v114, v114
  v_fma_f32 v115, v115, s20, v31
  v_mfma_f32_32x32x16_bf16 v[208:223], a[20:23], v[84:87], v[208:223]
  ds_read_b128 v[68:71], v6 offset:16384
  v_cvt_pk_bf16_f32 v131, v134, v135
  v_exp_f32 v115, v115
  v_fma_f32 v116, v116, s20, v31
  v_mul_f32 v136, v136, v40
  v_mfma_f32_32x32x16_bf16 v[224:239], a[24:27], v[84:87], v[224:239]
  ds_read_b128 v[72:75], v7 offset:16384
  v_cvt_pk_bf16_f32 v89, v114, v115
  v_exp_f32 v116, v116
  v_fma_f32 v117, v117, s20, v31
  v_mul_f32 v137, v137, v40
  v_mfma_f32_32x32x16_bf16 v[240:255], a[28:31], v[84:87], v[240:255]
  s_waitcnt lgkmcnt(5)
  ds_read_b128 v[76:79], v8 offset:16384
  ds_write_b128 v34, v[128:131]
  v_exp_f32 v117, v117
  v_fma_f32 v118, v118, s20, v31
  v_mfma_f32_32x32x16_bf16 v[96:111], v[48:51], a[224:227], 0
  v_mul_f32 v138, v138, v40
  v_cvt_pk_bf16_f32 v90, v116, v117
  v_exp_f32 v118, v118
  v_fma_f32 v119, v119, s20, v31
  v_mul_f32 v139, v139, v40
  v_mfma_f32_32x32x16_bf16 v[96:111], v[52:55], a[228:231], v[96:111]
  s_waitcnt lgkmcnt(5)
  v_exp_f32 v119, v119
  v_fma_f32 v120, v120, s20, v31
  v_mul_f32 v140, v140, v40
  v_exp_f32 v120, v120
  v_mfma_f32_32x32x16_bf16 v[96:111], v[56:59], a[232:235], v[96:111]
  v_cvt_pk_bf16_f32 v91, v118, v119
  v_fma_f32 v121, v121, s20, v31
  v_mul_f32 v141, v141, v40
  v_exp_f32 v121, v121
  v_fma_f32 v122, v122, s20, v31
  v_mfma_f32_32x32x16_bf16 v[96:111], v[60:63], a[236:239], v[96:111]
  s_waitcnt lgkmcnt(3)
  v_mul_f32 v142, v142, v40
  v_cvt_pk_bf16_f32 v92, v120, v121
  v_exp_f32 v122, v122
  v_fma_f32 v123, v123, s20, v31
  v_mul_f32 v143, v143, v40
  v_mfma_f32_32x32x16_bf16 v[96:111], v[64:67], a[240:243], v[96:111]
  v_exp_f32 v123, v123
  v_fma_f32 v124, v124, s20, v31
  v_cvt_pk_bf16_f32 v136, v136, v137
  v_exp_f32 v124, v124
  v_mfma_f32_32x32x16_bf16 v[96:111], v[68:71], a[244:247], v[96:111]
  s_waitcnt lgkmcnt(1)
  v_cvt_pk_bf16_f32 v93, v122, v123
  v_fma_f32 v125, v125, s20, v31
  v_cvt_pk_bf16_f32 v137, v138, v139
  v_exp_f32 v125, v125
  v_fma_f32 v126, v126, s20, v31
  v_mfma_f32_32x32x16_bf16 v[96:111], v[72:75], a[248:251], v[96:111]
  v_cvt_pk_bf16_f32 v138, v140, v141
  v_cvt_pk_bf16_f32 v94, v124, v125
  v_exp_f32 v126, v126
  v_fma_f32 v127, v127, s20, v31
  v_cvt_pk_bf16_f32 v139, v142, v143
  v_mfma_f32_32x32x16_bf16 v[96:111], v[76:79], a[252:255], v[96:111]
  ds_write_b128 v35, v[136:139]
  v_exp_f32 v127, v127
  v_mul_f32 v144, v144, v40
  v_mul_f32 v145, v145, v40
  v_mfma_f32_32x32x16_bf16 v[192:207], a[32:35], v[88:91], v[192:207]
  ds_read_b128 v[48:51], v1 offset:24576
  v_cvt_pk_bf16_f32 v95, v126, v127
  v_mul_f32 v146, v146, v40
  v_mul_f32 v147, v147, v40
  v_mul_f32 v148, v148, v40
  v_mul_f32 v149, v149, v40
  v_mfma_f32_16x16x32_bf16 v[22:25], v[44:47], v[88:91], 0
  v_mul_f32 v150, v150, v40
  v_mul_f32 v151, v151, v40
  v_mfma_f32_32x32x16_bf16 v[208:223], a[36:39], v[88:91], v[208:223]
  ds_read_b128 v[52:55], v2 offset:24576
  v_fma_f32 v96, v96, s20, v31
  v_exp_f32 v96, v96
  v_fma_f32 v97, v97, s20, v31
  v_fma_f32 v98, v98, s20, v31
  v_mfma_f32_32x32x16_bf16 v[224:239], a[40:43], v[88:91], v[224:239]
  ds_read_b128 v[56:59], v3 offset:24576
  v_exp_f32 v97, v97
  v_add_f32 v28, v28, v96
  v_exp_f32 v98, v98
  v_mfma_f32_32x32x16_bf16 v[240:255], a[44:47], v[88:91], v[240:255]
  ds_read_b128 v[60:63], v4 offset:24576
  v_cvt_pk_bf16_f32 v80, v96, v97
  v_fma_f32 v99, v99, s20, v31
  v_add_f32 v29, v29, v97
  v_exp_f32 v99, v99
  v_mfma_f32_32x32x16_bf16 v[192:207], a[48:51], v[92:95], v[192:207]
  ds_read_b128 v[64:67], v5 offset:24576
  v_add_f32 v28, v28, v98
  v_cvt_pk_bf16_f32 v81, v98, v99
  v_fma_f32 v100, v100, s20, v31
  v_add_f32 v29, v29, v99
  v_fma_f32 v101, v101, s20, v31
  v_mfma_f32_16x16x32_bf16 v[22:25], v[44:47], v[92:95], v[22:25]
  v_exp_f32 v100, v100
  v_mfma_f32_32x32x16_bf16 v[208:223], a[52:55], v[92:95], v[208:223]
  ds_read_b128 v[68:71], v6 offset:24576
  v_exp_f32 v101, v101
  v_fma_f32 v102, v102, s20, v31
  v_add_f32 v28, v28, v100
  v_fma_f32 v103, v103, s20, v31
  v_mfma_f32_32x32x16_bf16 v[224:239], a[56:59], v[92:95], v[224:239]
  ds_read_b128 v[72:75], v7 offset:24576
  buffer_load_dwordx4 a[192:195], v43, s[4:7], s41 offen
  v_cvt_pk_bf16_f32 v82, v100, v101
  v_exp_f32 v102, v102
  v_cvt_pk_bf16_f32 v144, v144, v145
  v_mfma_f32_32x32x16_bf16 v[240:255], a[60:63], v[92:95], v[240:255]
  s_waitcnt lgkmcnt(5)
  ds_read_b128 v[76:79], v8 offset:24576
  v_add_f32 v29, v29, v101
  v_exp_f32 v103, v103
  v_fma_f32 v104, v104, s20, v31
  v_cvt_pk_bf16_f32 v145, v146, v147
  v_mfma_f32_32x32x16_bf16 v[112:127], v[48:51], a[224:227], 0
  v_add_f32 v28, v28, v102
  v_cvt_pk_bf16_f32 v83, v102, v103
  v_exp_f32 v104, v104
  v_fma_f32 v105, v105, s20, v31
  v_cvt_pk_bf16_f32 v146, v148, v149
  v_mfma_f32_32x32x16_bf16 v[112:127], v[52:55], a[228:231], v[112:127]
  s_waitcnt lgkmcnt(4)
  v_add_f32 v29, v29, v103
  v_exp_f32 v105, v105
  v_fma_f32 v106, v106, s20, v31
  v_cvt_pk_bf16_f32 v147, v150, v151
  v_add_f32 v28, v28, v104
  v_mfma_f32_32x32x16_bf16 v[112:127], v[56:59], a[232:235], v[112:127]
  v_cvt_pk_bf16_f32 v84, v104, v105
  v_exp_f32 v106, v106
  v_fma_f32 v107, v107, s20, v31
  v_mul_f32 v152, v152, v40
  v_add_f32 v29, v29, v105
  v_mfma_f32_32x32x16_bf16 v[112:127], v[60:63], a[236:239], v[112:127]
  s_waitcnt lgkmcnt(2)
  ds_write_b128 v36, v[144:147]
  v_exp_f32 v107, v107
  v_fma_f32 v108, v108, s20, v31
  v_mul_f32 v153, v153, v40
  v_mfma_f32_32x32x16_bf16 v[112:127], v[64:67], a[240:243], v[112:127]
  v_add_f32 v28, v28, v106
  v_cvt_pk_bf16_f32 v85, v106, v107
  v_exp_f32 v108, v108
  v_fma_f32 v109, v109, s20, v31
  v_mul_f32 v154, v154, v40
  v_mfma_f32_32x32x16_bf16 v[112:127], v[68:71], a[244:247], v[112:127]
  s_waitcnt lgkmcnt(1)
  v_add_f32 v29, v29, v107
  v_exp_f32 v109, v109
  v_fma_f32 v110, v110, s20, v31
  v_mul_f32 v155, v155, v40
  v_add_f32 v28, v28, v108
  v_mfma_f32_32x32x16_bf16 v[112:127], v[72:75], a[248:251], v[112:127]
  buffer_load_dwordx4 a[196:199], v43, s[4:7], s41 offen offset:32
  v_cvt_pk_bf16_f32 v86, v108, v109
  v_exp_f32 v110, v110
  v_fma_f32 v111, v111, s20, v31
  v_mul_f32 v156, v156, v40
  v_mfma_f32_32x32x16_bf16 v[112:127], v[76:79], a[252:255], v[112:127]
  v_add_f32 v29, v29, v109
  v_exp_f32 v111, v111
  v_mul_f32 v157, v157, v40
  v_add_f32 v28, v28, v110
  v_mul_f32 v158, v158, v40
  v_mfma_f32_32x32x16_bf16 v[192:207], a[64:67], v[80:83], v[192:207]
  ds_read_b128 v[48:51], v1 offset:32768
  v_cvt_pk_bf16_f32 v87, v110, v111
  v_add_f32 v29, v29, v111
  v_mul_f32 v159, v159, v40
  v_cvt_pk_bf16_f32 v152, v152, v153
  v_cvt_pk_bf16_f32 v153, v154, v155
  v_mfma_f32_32x32x16_bf16 v[208:223], a[68:71], v[80:83], v[208:223]
  ds_read_b128 v[52:55], v2 offset:32768
  v_fma_f32 v112, v112, s20, v31
  v_exp_f32 v112, v112
  v_fma_f32 v113, v113, s20, v31
  v_fma_f32 v114, v114, s20, v31
  v_mfma_f32_32x32x16_bf16 v[224:239], a[72:75], v[80:83], v[224:239]
  ds_read_b128 v[56:59], v3 offset:32768
  v_exp_f32 v113, v113
  v_exp_f32 v114, v114
  v_fma_f32 v115, v115, s20, v31
  v_mfma_f32_32x32x16_bf16 v[240:255], a[76:79], v[80:83], v[240:255]
  ds_read_b128 v[60:63], v4 offset:32768
  v_cvt_pk_bf16_f32 v88, v112, v113
  v_exp_f32 v115, v115
  v_fma_f32 v116, v116, s20, v31
  v_fma_f32 v117, v117, s20, v31
  v_mfma_f32_32x32x16_bf16 v[192:207], a[80:83], v[84:87], v[192:207]
  ds_read_b128 v[64:67], v5 offset:32768
  v_cvt_pk_bf16_f32 v89, v114, v115
  v_exp_f32 v116, v116
  v_cvt_pk_bf16_f32 v154, v156, v157
  v_fma_f32 v118, v118, s20, v31
  v_mfma_f32_32x32x16_bf16 v[208:223], a[84:87], v[84:87], v[208:223]
  ds_read_b128 v[68:71], v6 offset:32768
  v_exp_f32 v117, v117
  v_cvt_pk_bf16_f32 v155, v158, v159
  v_exp_f32 v118, v118
  v_mfma_f32_32x32x16_bf16 v[224:239], a[88:91], v[84:87], v[224:239]
  ds_read_b128 v[72:75], v7 offset:32768
  buffer_load_dwordx4 a[200:203], v43, s[4:7], s41 offen offset:64
  v_cvt_pk_bf16_f32 v90, v116, v117
  v_fma_f32 v119, v119, s20, v31
  v_exp_f32 v119, v119
  v_mfma_f32_32x32x16_bf16 v[240:255], a[92:95], v[84:87], v[240:255]
  s_waitcnt lgkmcnt(5)
  ds_read_b128 v[76:79], v8 offset:32768
  v_fma_f32 v120, v120, s20, v31
  v_mul_f32 v160, v160, v40
  v_cvt_pk_bf16_f32 v91, v118, v119
  v_exp_f32 v120, v120
  v_mfma_f32_32x32x16_bf16 v[96:111], v[48:51], a[224:227], 0
  ds_write_b128 v37, v[152:155]
  v_fma_f32 v121, v121, s20, v31
  v_mul_f32 v161, v161, v40
  v_exp_f32 v121, v121
  v_mfma_f32_32x32x16_bf16 v[96:111], v[52:55], a[228:231], v[96:111]
  s_waitcnt lgkmcnt(5)
  v_fma_f32 v122, v122, s20, v31
  v_mul_f32 v162, v162, v40
  v_cvt_pk_bf16_f32 v92, v120, v121
  v_exp_f32 v122, v122
  v_fma_f32 v123, v123, s20, v31
  v_mfma_f32_32x32x16_bf16 v[96:111], v[56:59], a[232:235], v[96:111]
  ds_read_b128 v[132:135], v38
  ds_read_b128 v[140:143], v39 offset:1024
  v_mul_f32 v163, v163, v40
  v_exp_f32 v123, v123
  v_fma_f32 v124, v124, s20, v31
  v_mfma_f32_32x32x16_bf16 v[96:111], v[60:63], a[236:239], v[96:111]
  s_waitcnt lgkmcnt(5)
  ds_read_b128 v[148:151], v38 offset:2048
  v_mul_f32 v164, v164, v40
  v_cvt_pk_bf16_f32 v93, v122, v123
  v_exp_f32 v124, v124
  v_fma_f32 v125, v125, s20, v31
  v_mfma_f32_32x32x16_bf16 v[96:111], v[64:67], a[240:243], v[96:111]
  ds_read_b128 v[156:159], v39 offset:3072
  v_mul_f32 v165, v165, v40
  v_exp_f32 v125, v125
  v_fma_f32 v126, v126, s20, v31
  v_mul_f32 v166, v166, v40
  v_mfma_f32_32x32x16_bf16 v[96:111], v[68:71], a[244:247], v[96:111]
  s_waitcnt lgkmcnt(3)
  v_cvt_pk_bf16_f32 v94, v124, v125
  v_exp_f32 v126, v126
  v_fma_f32 v127, v127, s20, v31
  v_mul_f32 v167, v167, v40
  v_cvt_pk_bf16_f32 v160, v160, v161
  v_mfma_f32_32x32x16_bf16 v[96:111], v[72:75], a[248:251], v[96:111]
  buffer_load_dwordx4 a[204:207], v43, s[4:7], s41 offen offset:96
  buffer_store_dwordx4 v[132:135], v21, s[16:19], 0 offen sc1
  v_exp_f32 v127, v127
  v_cvt_pk_bf16_f32 v161, v162, v163
  v_cvt_pk_bf16_f32 v162, v164, v165
  v_mfma_f32_32x32x16_bf16 v[96:111], v[76:79], a[252:255], v[96:111]
  s_waitcnt lgkmcnt(0)
  buffer_store_dwordx4 v[140:143], v21, s[16:19], 0 offen offset:2048 sc1
  buffer_store_dwordx4 v[148:151], v21, s[16:19], s44 offen sc1
  v_cvt_pk_bf16_f32 v95, v126, v127
  v_cvt_pk_bf16_f32 v163, v166, v167
  v_mul_f32 v168, v168, v40
  v_mul_f32 v169, v169, v40
  v_mfma_f32_32x32x16_bf16 v[192:207], a[96:99], v[88:91], v[192:207]
  ds_read_b128 v[48:51], v1 offset:40960
  buffer_store_dwordx4 v[156:159], v21, s[16:19], s44 offen offset:2048 sc1
  v_mul_f32 v170, v170, v40
  v_mul_f32 v171, v171, v40
  v_mul_f32 v172, v172, v40
  v_mul_f32 v173, v173, v40
  v_mfma_f32_16x16x32_bf16 v[22:25], v[44:47], v[88:91], v[22:25]
  ds_write_b128 v34, v[160:163]
  v_mfma_f32_32x32x16_bf16 v[208:223], a[100:103], v[88:91], v[208:223]
  ds_read_b128 v[52:55], v2 offset:40960
  v_fma_f32 v96, v96, s20, v31
  v_exp_f32 v96, v96
  v_fma_f32 v97, v97, s20, v31
  v_fma_f32 v98, v98, s20, v31
  v_mfma_f32_32x32x16_bf16 v[224:239], a[104:107], v[88:91], v[224:239]
  ds_read_b128 v[56:59], v3 offset:40960
  v_exp_f32 v97, v97
  v_add_f32 v28, v28, v96
  v_exp_f32 v98, v98
  v_mfma_f32_32x32x16_bf16 v[240:255], a[108:111], v[88:91], v[240:255]
  ds_read_b128 v[60:63], v4 offset:40960
  v_cvt_pk_bf16_f32 v80, v96, v97
  v_fma_f32 v99, v99, s20, v31
  v_add_f32 v29, v29, v97
  v_exp_f32 v99, v99
  v_mfma_f32_32x32x16_bf16 v[192:207], a[112:115], v[92:95], v[192:207]
  ds_read_b128 v[64:67], v5 offset:40960
  v_add_f32 v28, v28, v98
  v_cvt_pk_bf16_f32 v81, v98, v99
  v_fma_f32 v100, v100, s20, v31
  v_add_f32 v29, v29, v99
  v_fma_f32 v101, v101, s20, v31
  v_mfma_f32_16x16x32_bf16 v[22:25], v[44:47], v[92:95], v[22:25]
  v_exp_f32 v100, v100
  v_mfma_f32_32x32x16_bf16 v[208:223], a[116:119], v[92:95], v[208:223]
  ds_read_b128 v[68:71], v6 offset:40960
  v_exp_f32 v101, v101
  v_fma_f32 v102, v102, s20, v31
  v_add_f32 v28, v28, v100
  v_fma_f32 v103, v103, s20, v31
  v_mfma_f32_32x32x16_bf16 v[224:239], a[120:123], v[92:95], v[224:239]
  ds_read_b128 v[72:75], v7 offset:40960
  buffer_load_dwordx4 a[208:211], v43, s[4:7], s41 offen offset:128
  v_cvt_pk_bf16_f32 v82, v100, v101
  v_exp_f32 v102, v102
  v_add_f32 v29, v29, v101
  v_mfma_f32_32x32x16_bf16 v[240:255], a[124:127], v[92:95], v[240:255]
  s_waitcnt lgkmcnt(5)
  ds_read_b128 v[76:79], v8 offset:40960
  v_exp_f32 v103, v103
  v_fma_f32 v104, v104, s20, v31
  v_mul_f32 v174, v174, v40
  v_add_f32 v28, v28, v102
  v_mfma_f32_32x32x16_bf16 v[112:127], v[48:51], a[224:227], 0
  v_cvt_pk_bf16_f32 v83, v102, v103
  v_exp_f32 v104, v104
  v_fma_f32 v105, v105, s20, v31
  v_mul_f32 v175, v175, v40
  v_add_f32 v29, v29, v103
  v_mfma_f32_32x32x16_bf16 v[112:127], v[52:55], a[228:231], v[112:127]
  s_waitcnt lgkmcnt(4)
  v_exp_f32 v105, v105
  v_fma_f32 v106, v106, s20, v31
  v_cvt_pk_bf16_f32 v168, v168, v169
  v_add_f32 v28, v28, v104
  v_fma_f32 v107, v107, s20, v31
  v_mfma_f32_32x32x16_bf16 v[112:127], v[56:59], a[232:235], v[112:127]
  v_cvt_pk_bf16_f32 v84, v104, v105
  v_exp_f32 v106, v106
  v_cvt_pk_bf16_f32 v169, v170, v171
  v_add_f32 v29, v29, v105
  v_fma_f32 v108, v108, s20, v31
  v_mfma_f32_32x32x16_bf16 v[112:127], v[60:63], a[236:239], v[112:127]
  s_waitcnt lgkmcnt(2)
  v_exp_f32 v107, v107
  v_cvt_pk_bf16_f32 v170, v172, v173
  v_add_f32 v28, v28, v106
  v_exp_f32 v108, v108
  v_mfma_f32_32x32x16_bf16 v[112:127], v[64:67], a[240:243], v[112:127]
  v_cvt_pk_bf16_f32 v85, v106, v107
  v_fma_f32 v109, v109, s20, v31
  v_cvt_pk_bf16_f32 v171, v174, v175
  v_add_f32 v29, v29, v107
  v_exp_f32 v109, v109
  v_mfma_f32_32x32x16_bf16 v[112:127], v[68:71], a[244:247], v[112:127]
  s_waitcnt lgkmcnt(0)
  v_fma_f32 v110, v110, s20, v31
  v_add_f32 v28, v28, v108
  v_cvt_pk_bf16_f32 v86, v108, v109
  v_exp_f32 v110, v110
  v_fma_f32 v111, v111, s20, v31
  v_mfma_f32_32x32x16_bf16 v[112:127], v[72:75], a[248:251], v[112:127]
  buffer_load_dwordx4 a[212:215], v43, s[4:7], s41 offen offset:160
  v_mul_f32 v176, v176, v40
  v_add_f32 v29, v29, v109
  v_exp_f32 v111, v111
  v_mul_f32 v177, v177, v40
  v_mfma_f32_32x32x16_bf16 v[112:127], v[76:79], a[252:255], v[112:127]
  ds_write_b128 v35, v[168:171]
  v_add_f32 v28, v28, v110
  v_cvt_pk_bf16_f32 v87, v110, v111
  v_mul_f32 v178, v178, v40
  v_add_f32 v29, v29, v111
  v_mfma_f32_32x32x16_bf16 v[192:207], a[128:131], v[80:83], v[192:207]
  ds_read_b128 v[48:51], v1 offset:49152
  v_mul_f32 v179, v179, v40
  v_mul_f32 v180, v180, v40
  v_mul_f32 v181, v181, v40
  v_mul_f32 v182, v182, v40
  v_mul_f32 v183, v183, v40
  v_mfma_f32_32x32x16_bf16 v[208:223], a[132:135], v[80:83], v[208:223]
  ds_read_b128 v[52:55], v2 offset:49152
  v_fma_f32 v112, v112, s20, v31
  v_exp_f32 v112, v112
  v_fma_f32 v113, v113, s20, v31
  v_fma_f32 v114, v114, s20, v31
  v_mfma_f32_32x32x16_bf16 v[224:239], a[136:139], v[80:83], v[224:239]
  ds_read_b128 v[56:59], v3 offset:49152
  v_exp_f32 v113, v113
  v_exp_f32 v114, v114
  v_fma_f32 v115, v115, s20, v31
  v_mfma_f32_32x32x16_bf16 v[240:255], a[140:143], v[80:83], v[240:255]
  ds_read_b128 v[60:63], v4 offset:49152
  v_cvt_pk_bf16_f32 v88, v112, v113
  v_exp_f32 v115, v115
  v_fma_f32 v116, v116, s20, v31
  v_fma_f32 v117, v117, s20, v31
  v_mfma_f32_32x32x16_bf16 v[192:207], a[144:147], v[84:87], v[192:207]
  ds_read_b128 v[64:67], v5 offset:49152
  v_cvt_pk_bf16_f32 v89, v114, v115
  v_exp_f32 v116, v116
  v_exp_f32 v117, v117
  v_mfma_f32_32x32x16_bf16 v[208:223], a[148:151], v[84:87], v[208:223]
  ds_read_b128 v[68:71], v6 offset:49152
  v_fma_f32 v118, v118, s20, v31
  v_cvt_pk_bf16_f32 v90, v116, v117
  v_exp_f32 v118, v118
  v_fma_f32 v119, v119, s20, v31
  v_mfma_f32_32x32x16_bf16 v[224:239], a[152:155], v[84:87], v[224:239]
  ds_read_b128 v[72:75], v7 offset:49152
  buffer_load_dwordx4 a[216:219], v43, s[4:7], s41 offen offset:192
  v_cvt_pk_bf16_f32 v176, v176, v177
  v_exp_f32 v119, v119
  v_fma_f32 v120, v120, s20, v31
  v_mfma_f32_32x32x16_bf16 v[240:255], a[156:159], v[84:87], v[240:255]
  s_waitcnt lgkmcnt(5)
  ds_read_b128 v[76:79], v8 offset:49152
  v_cvt_pk_bf16_f32 v177, v178, v179
  v_cvt_pk_bf16_f32 v91, v118, v119
  v_exp_f32 v120, v120
  v_fma_f32 v121, v121, s20, v31
  v_mfma_f32_32x32x16_bf16 v[96:111], v[48:51], a[224:227], 0
  v_cvt_pk_bf16_f32 v178, v180, v181
  v_exp_f32 v121, v121
  v_fma_f32 v122, v122, s20, v31
  v_cvt_pk_bf16_f32 v179, v182, v183
  v_fma_f32 v123, v123, s20, v31
  v_mfma_f32_32x32x16_bf16 v[96:111], v[52:55], a[228:231], v[96:111]
  s_waitcnt lgkmcnt(4)
  v_cvt_pk_bf16_f32 v92, v120, v121
  v_exp_f32 v122, v122
  v_mul_f32 v184, v184, v40
  v_exp_f32 v123, v123
  v_mfma_f32_32x32x16_bf16 v[96:111], v[56:59], a[232:235], v[96:111]
  ds_write_b128 v36, v[176:179]
  v_fma_f32 v124, v124, s20, v31
  v_mul_f32 v185, v185, v40
  v_cvt_pk_bf16_f32 v93, v122, v123
  v_fma_f32 v125, v125, s20, v31
  v_mfma_f32_32x32x16_bf16 v[96:111], v[60:63], a[236:239], v[96:111]
  s_waitcnt lgkmcnt(3)
  v_exp_f32 v124, v124
  v_mul_f32 v186, v186, v40
  v_exp_f32 v125, v125
  v_fma_f32 v126, v126, s20, v31
  v_mfma_f32_32x32x16_bf16 v[96:111], v[64:67], a[240:243], v[96:111]
  v_mul_f32 v187, v187, v40
  v_cvt_pk_bf16_f32 v94, v124, v125
  v_exp_f32 v126, v126
  v_fma_f32 v127, v127, s20, v31
  v_mul_f32 v188, v188, v40
  v_mfma_f32_32x32x16_bf16 v[96:111], v[68:71], a[244:247], v[96:111]
  s_waitcnt lgkmcnt(1)
  v_exp_f32 v127, v127
  v_mul_f32 v189, v189, v40
  v_mul_f32 v190, v190, v40
  v_mul_f32 v191, v191, v40
  v_cvt_pk_bf16_f32 v184, v184, v185
  v_mfma_f32_32x32x16_bf16 v[96:111], v[72:75], a[248:251], v[96:111]
  buffer_load_dwordx4 a[220:223], v43, s[4:7], s41 offen offset:224
  v_cvt_pk_bf16_f32 v95, v126, v127
  v_cvt_pk_bf16_f32 v185, v186, v187
  v_cvt_pk_bf16_f32 v186, v188, v189
  v_cvt_pk_bf16_f32 v187, v190, v191
  v_mfma_f32_32x32x16_bf16 v[96:111], v[76:79], a[252:255], v[96:111]
  ds_write_b128 v37, v[184:187]
  v_mfma_f32_32x32x16_bf16 v[192:207], a[160:163], v[88:91], v[192:207]
  ds_read_b128 v[48:51], v1 offset:57344
  ds_read_b128 v[164:167], v38
  v_mfma_f32_16x16x32_bf16 v[22:25], v[44:47], v[88:91], v[22:25]
  ds_read_b128 v[172:175], v39 offset:1024
  ds_read_b128 v[180:183], v38 offset:2048
  v_mfma_f32_32x32x16_bf16 v[208:223], a[164:167], v[88:91], v[208:223]
  ds_read_b128 v[52:55], v2 offset:57344
  s_nop 2
  v_fma_f32 v96, v96, s20, v31
  v_exp_f32 v96, v96
  v_fma_f32 v97, v97, s20, v31
  v_fma_f32 v98, v98, s20, v31
  v_mfma_f32_32x32x16_bf16 v[224:239], a[168:171], v[88:91], v[224:239]
  ds_read_b128 v[56:59], v3 offset:57344
  v_exp_f32 v97, v97
  v_add_f32 v28, v28, v96
  v_exp_f32 v98, v98
  v_mfma_f32_32x32x16_bf16 v[240:255], a[172:175], v[88:91], v[240:255]
  ds_read_b128 v[60:63], v4 offset:57344
  v_cvt_pk_bf16_f32 v80, v96, v97
  v_fma_f32 v99, v99, s20, v31
  v_add_f32 v29, v29, v97
  v_exp_f32 v99, v99
  v_mfma_f32_32x32x16_bf16 v[192:207], a[176:179], v[92:95], v[192:207]
  ds_read_b128 v[64:67], v5 offset:57344
  v_add_f32 v28, v28, v98
  v_cvt_pk_bf16_f32 v81, v98, v99
  v_fma_f32 v100, v100, s20, v31
  v_add_f32 v29, v29, v99
  v_fma_f32 v101, v101, s20, v31
  v_mfma_f32_16x16x32_bf16 v[22:25], v[44:47], v[92:95], v[22:25]
  v_exp_f32 v100, v100
  v_mfma_f32_32x32x16_bf16 v[208:223], a[180:183], v[92:95], v[208:223]
  ds_read_b128 v[68:71], v6 offset:57344
  v_exp_f32 v101, v101
  v_fma_f32 v102, v102, s20, v31
  v_add_f32 v28, v28, v100
  v_fma_f32 v103, v103, s20, v31
  v_mfma_f32_32x32x16_bf16 v[224:239], a[184:187], v[92:95], v[224:239]
  ds_read_b128 v[72:75], v7 offset:57344
  v_cvt_pk_bf16_f32 v82, v100, v101
  v_exp_f32 v102, v102
  v_add_f32 v29, v29, v101
  v_fma_f32 v104, v104, s20, v31
  v_mfma_f32_32x32x16_bf16 v[240:255], a[188:191], v[92:95], v[240:255]
  s_waitcnt lgkmcnt(5)
  ds_read_b128 v[76:79], v8 offset:57344
  v_exp_f32 v103, v103
  v_add_f32 v28, v28, v102
  v_exp_f32 v104, v104
  v_mfma_f32_32x32x16_bf16 v[112:127], v[48:51], a[224:227], 0
  ds_read_b64_tr_b16 v[48:49], v17 offset:49152
  ds_read_b64_tr_b16 v[50:51], v17 offset:51200
  v_cvt_pk_bf16_f32 v83, v102, v103
  v_fma_f32 v105, v105, s20, v31
  v_add_f32 v29, v29, v103
  v_fma_f32 v106, v106, s20, v31
  v_mfma_f32_32x32x16_bf16 v[112:127], v[52:55], a[228:231], v[112:127]
  s_waitcnt lgkmcnt(6)
  ds_read_b64_tr_b16 v[52:53], v18 offset:49152
  ds_read_b64_tr_b16 v[54:55], v18 offset:51200
  v_exp_f32 v105, v105
  v_add_f32 v28, v28, v104
  v_fma_f32 v107, v107, s20, v31
  v_mfma_f32_32x32x16_bf16 v[112:127], v[56:59], a[232:235], v[112:127]
  ds_read_b64_tr_b16 v[56:57], v19 offset:49152
  ds_read_b64_tr_b16 v[58:59], v19 offset:51200
  v_cvt_pk_bf16_f32 v84, v104, v105
  v_exp_f32 v106, v106
  v_add_f32 v29, v29, v105
  v_mfma_f32_32x32x16_bf16 v[112:127], v[60:63], a[236:239], v[112:127]
  s_waitcnt lgkmcnt(8)
  ds_read_b64_tr_b16 v[60:61], v20 offset:49152
  ds_read_b64_tr_b16 v[62:63], v20 offset:51200
  v_exp_f32 v107, v107
  v_fma_f32 v108, v108, s20, v31
  v_add_f32 v28, v28, v106
  v_mfma_f32_32x32x16_bf16 v[112:127], v[64:67], a[240:243], v[112:127]
  ds_read_b64_tr_b16 v[64:65], v17 offset:53248
  ds_read_b64_tr_b16 v[66:67], v17 offset:55296
  v_cvt_pk_bf16_f32 v85, v106, v107
  v_exp_f32 v108, v108
  v_fma_f32 v109, v109, s20, v31
  v_mfma_f32_32x32x16_bf16 v[112:127], v[68:71], a[244:247], v[112:127]
  s_waitcnt lgkmcnt(10)
  ds_read_b64_tr_b16 v[68:69], v18 offset:53248
  ds_read_b64_tr_b16 v[70:71], v18 offset:55296
  v_add_f32 v29, v29, v107
  v_exp_f32 v109, v109
  v_fma_f32 v110, v110, s20, v31
  v_mfma_f32_32x32x16_bf16 v[112:127], v[72:75], a[248:251], v[112:127]
  ds_read_b64_tr_b16 v[72:73], v19 offset:53248
  ds_read_b64_tr_b16 v[74:75], v19 offset:55296
  ds_read_b128 v[188:191], v39 offset:3072
  v_add_f32 v28, v28, v108
  v_cvt_pk_bf16_f32 v86, v108, v109
  v_fma_f32 v111, v111, s20, v31
  v_mfma_f32_32x32x16_bf16 v[112:127], v[76:79], a[252:255], v[112:127]
  s_waitcnt lgkmcnt(11)
  ds_read_b64_tr_b16 v[76:77], v20 offset:53248
  ds_read_b64_tr_b16 v[78:79], v20 offset:55296
  v_exp_f32 v110, v110
  v_add_f32 v29, v29, v109
  v_mfma_f32_32x32x16_bf16 v[192:207], v[48:51], v[80:83], v[192:207]
  ds_read_b128 v[48:51], v9
  buffer_store_dwordx4 v[164:167], v0, s[16:19], 0 offen sc1
  v_exp_f32 v111, v111
  v_add_f32 v28, v28, v110
  v_mfma_f32_32x32x16_bf16 v[208:223], v[52:55], v[80:83], v[208:223]
  s_waitcnt lgkmcnt(10)
  ds_read_b128 v[52:55], v10
  buffer_store_dwordx4 v[172:175], v0, s[16:19], 0 offen offset:2048 sc1
  v_fma_f32 v112, v112, s20, v31
  v_cvt_pk_bf16_f32 v87, v110, v111
  v_exp_f32 v112, v112
  v_mfma_f32_32x32x16_bf16 v[224:239], v[56:59], v[80:83], v[224:239]
  ds_read_b128 v[56:59], v11
  buffer_store_dwordx4 v[180:183], v0, s[16:19], s44 offen sc1
  v_fma_f32 v113, v113, s20, v31
  v_add_f32 v29, v29, v111
  v_exp_f32 v113, v113
  v_mfma_f32_32x32x16_bf16 v[240:255], v[60:63], v[80:83], v[240:255]
  s_waitcnt lgkmcnt(5)
  ds_read_b128 v[60:63], v12
  buffer_store_dwordx4 v[188:191], v0, s[16:19], s44 offen offset:2048 sc1
  v_fma_f32 v114, v114, s20, v31
  v_add_f32 v28, v28, v112
  v_cvt_pk_bf16_f32 v88, v112, v113
  v_fma_f32 v115, v115, s20, v31
  v_mfma_f32_32x32x16_bf16 v[192:207], v[64:67], v[84:87], v[192:207]
  ds_read_b128 v[64:67], v13
  v_exp_f32 v114, v114
  v_add_f32 v29, v29, v113
  v_exp_f32 v115, v115
  v_mfma_f32_32x32x16_bf16 v[208:223], v[68:71], v[84:87], v[208:223]
  s_waitcnt lgkmcnt(5)
  ds_read_b128 v[68:71], v14
  v_fma_f32 v116, v116, s20, v31
  v_add_f32 v28, v28, v114
  v_cvt_pk_bf16_f32 v89, v114, v115
  v_exp_f32 v116, v116
  v_mfma_f32_32x32x16_bf16 v[224:239], v[72:75], v[84:87], v[224:239]
  ds_read_b128 v[72:75], v15
  v_fma_f32 v117, v117, s20, v31
  v_add_f32 v29, v29, v115
  v_exp_f32 v117, v117
  v_fma_f32 v118, v118, s20, v31
  v_mfma_f32_32x32x16_bf16 v[240:255], v[76:79], v[84:87], v[240:255]
  s_waitcnt lgkmcnt(5)
  ds_read_b128 v[76:79], v16
  v_add_f32 v28, v28, v116
  v_cvt_pk_bf16_f32 v90, v116, v117
  v_exp_f32 v118, v118
  v_fma_f32 v119, v119, s20, v31
  v_mfma_f32_32x32x16_bf16 v[96:111], v[48:51], a[224:227], 0
  ds_read_b64_tr_b16 v[48:49], v17 offset:57344
  ds_read_b64_tr_b16 v[50:51], v17 offset:59392
  v_add_f32 v29, v29, v117
  v_exp_f32 v119, v119
  v_fma_f32 v120, v120, s20, v31
  v_mfma_f32_32x32x16_bf16 v[96:111], v[52:55], a[228:231], v[96:111]
  s_waitcnt lgkmcnt(6)
  ds_read_b64_tr_b16 v[52:53], v18 offset:57344
  ds_read_b64_tr_b16 v[54:55], v18 offset:59392
  v_add_f32 v28, v28, v118
  v_cvt_pk_bf16_f32 v91, v118, v119
  v_exp_f32 v120, v120
  v_mfma_f32_32x32x16_bf16 v[96:111], v[56:59], a[232:235], v[96:111]
  ds_read_b64_tr_b16 v[56:57], v19 offset:57344
  ds_read_b64_tr_b16 v[58:59], v19 offset:59392
  v_fma_f32 v121, v121, s20, v31
  v_add_f32 v29, v29, v119
  v_exp_f32 v121, v121
  v_mfma_f32_32x32x16_bf16 v[96:111], v[60:63], a[236:239], v[96:111]
  s_waitcnt lgkmcnt(8)
  ds_read_b64_tr_b16 v[60:61], v20 offset:57344
  ds_read_b64_tr_b16 v[62:63], v20 offset:59392
  v_fma_f32 v122, v122, s20, v31
  v_add_f32 v28, v28, v120
  v_cvt_pk_bf16_f32 v92, v120, v121
  v_fma_f32 v123, v123, s20, v31
  v_mfma_f32_32x32x16_bf16 v[96:111], v[64:67], a[240:243], v[96:111]
  ds_read_b64_tr_b16 v[64:65], v17 offset:61440
  ds_read_b64_tr_b16 v[66:67], v17 offset:63488
  v_exp_f32 v122, v122
  v_add_f32 v29, v29, v121
  v_fma_f32 v124, v124, s20, v31
  v_mfma_f32_32x32x16_bf16 v[96:111], v[68:71], a[244:247], v[96:111]
  s_waitcnt lgkmcnt(10)
  ds_read_b64_tr_b16 v[68:69], v18 offset:61440
  ds_read_b64_tr_b16 v[70:71], v18 offset:63488
  v_exp_f32 v123, v123
  v_add_f32 v28, v28, v122
  v_fma_f32 v125, v125, s20, v31
  v_mfma_f32_32x32x16_bf16 v[96:111], v[72:75], a[248:251], v[96:111]
  ds_read_b64_tr_b16 v[72:73], v19 offset:61440
  ds_read_b64_tr_b16 v[74:75], v19 offset:63488
  v_cvt_pk_bf16_f32 v93, v122, v123
  v_exp_f32 v124, v124
  v_add_f32 v29, v29, v123
  v_mfma_f32_32x32x16_bf16 v[96:111], v[76:79], a[252:255], v[96:111]
  s_waitcnt lgkmcnt(10)
  ds_read_b64_tr_b16 v[76:77], v20 offset:61440
  ds_read_b64_tr_b16 v[78:79], v20 offset:63488
  v_exp_f32 v125, v125
  v_fma_f32 v126, v126, s20, v31
  v_add_f32 v28, v28, v124
  v_mfma_f32_32x32x16_bf16 v[192:207], v[48:51], v[88:91], v[192:207]
  ds_read_b128 v[48:51], v9 offset:8192
  v_cvt_pk_bf16_f32 v94, v124, v125
  v_exp_f32 v126, v126
  v_fma_f32 v127, v127, s20, v31
  v_add_f32 v29, v29, v125
  v_mfma_f32_32x32x16_bf16 v[208:223], v[52:55], v[88:91], v[208:223]
  s_waitcnt lgkmcnt(9)
  ds_read_b128 v[52:55], v10 offset:8192
  v_exp_f32 v127, v127
  v_fma_f32 v96, v96, s20, v31
  v_add_f32 v28, v28, v126
  v_fma_f32 v97, v97, s20, v31
  v_mfma_f32_32x32x16_bf16 v[224:239], v[56:59], v[88:91], v[224:239]
  ds_read_b128 v[56:59], v11 offset:8192
  v_cvt_pk_bf16_f32 v95, v126, v127
  v_exp_f32 v96, v96
  v_add_f32 v29, v29, v127
  v_fma_f32 v98, v98, s20, v31
  v_mfma_f32_32x32x16_bf16 v[240:255], v[60:63], v[88:91], v[240:255]
  s_waitcnt lgkmcnt(7)
  ds_read_b128 v[60:63], v12 offset:8192
  v_exp_f32 v97, v97
  v_add_f32 v28, v28, v96
  v_exp_f32 v98, v98
  v_mfma_f32_32x32x16_bf16 v[192:207], v[64:67], v[92:95], v[192:207]
  ds_read_b128 v[64:67], v13 offset:8192
  v_cvt_pk_bf16_f32 v80, v96, v97
  v_fma_f32 v99, v99, s20, v31
  v_add_f32 v29, v29, v97
  v_exp_f32 v99, v99
  v_mfma_f32_32x32x16_bf16 v[208:223], v[68:71], v[92:95], v[208:223]
  s_waitcnt lgkmcnt(5)
  ds_read_b128 v[68:71], v14 offset:8192
  v_fma_f32 v100, v100, s20, v31
  v_add_f32 v28, v28, v98
  v_cvt_pk_bf16_f32 v81, v98, v99
  v_exp_f32 v100, v100
  v_mfma_f32_32x32x16_bf16 v[224:239], v[72:75], v[92:95], v[224:239]
  ds_read_b128 v[72:75], v15 offset:8192
  v_fma_f32 v101, v101, s20, v31
  v_add_f32 v29, v29, v99
  v_exp_f32 v101, v101
  v_fma_f32 v102, v102, s20, v31
  v_mfma_f32_32x32x16_bf16 v[240:255], v[76:79], v[92:95], v[240:255]
  s_waitcnt lgkmcnt(5)
  ds_read_b128 v[76:79], v16 offset:8192
  v_add_f32 v28, v28, v100
  v_cvt_pk_bf16_f32 v82, v100, v101
  v_exp_f32 v102, v102
  v_fma_f32 v103, v103, s20, v31
  v_mfma_f32_32x32x16_bf16 v[112:127], v[48:51], a[224:227], 0
  ds_read_b64_tr_b16 v[48:49], v17
  ds_read_b64_tr_b16 v[50:51], v17 offset:2048
  v_add_f32 v29, v29, v101
  v_exp_f32 v103, v103
  v_fma_f32 v104, v104, s20, v31
  v_mfma_f32_32x32x16_bf16 v[112:127], v[52:55], a[228:231], v[112:127]
  s_waitcnt lgkmcnt(6)
  ds_read_b64_tr_b16 v[52:53], v18
  ds_read_b64_tr_b16 v[54:55], v18 offset:2048
  v_add_f32 v28, v28, v102
  v_cvt_pk_bf16_f32 v83, v102, v103
  v_exp_f32 v104, v104
  v_mfma_f32_32x32x16_bf16 v[112:127], v[56:59], a[232:235], v[112:127]
  ds_read_b64_tr_b16 v[56:57], v19
  ds_read_b64_tr_b16 v[58:59], v19 offset:2048
  v_fma_f32 v105, v105, s20, v31
  v_add_f32 v29, v29, v103
  v_exp_f32 v105, v105
  v_mfma_f32_32x32x16_bf16 v[112:127], v[60:63], a[236:239], v[112:127]
  s_waitcnt lgkmcnt(8)
  ds_read_b64_tr_b16 v[60:61], v20
  ds_read_b64_tr_b16 v[62:63], v20 offset:2048
  v_fma_f32 v106, v106, s20, v31
  v_add_f32 v28, v28, v104
  v_cvt_pk_bf16_f32 v84, v104, v105
  v_fma_f32 v107, v107, s20, v31
  v_mfma_f32_32x32x16_bf16 v[112:127], v[64:67], a[240:243], v[112:127]
  ds_read_b64_tr_b16 v[64:65], v17 offset:4096
  ds_read_b64_tr_b16 v[66:67], v17 offset:6144
  v_exp_f32 v106, v106
  v_add_f32 v29, v29, v105
  v_fma_f32 v108, v108, s20, v31
  v_mfma_f32_32x32x16_bf16 v[112:127], v[68:71], a[244:247], v[112:127]
  s_waitcnt lgkmcnt(10)
  ds_read_b64_tr_b16 v[68:69], v18 offset:4096
  ds_read_b64_tr_b16 v[70:71], v18 offset:6144
  v_exp_f32 v107, v107
  v_add_f32 v28, v28, v106
  v_fma_f32 v109, v109, s20, v31
  v_mfma_f32_32x32x16_bf16 v[112:127], v[72:75], a[248:251], v[112:127]
  ds_read_b64_tr_b16 v[72:73], v19 offset:4096
  ds_read_b64_tr_b16 v[74:75], v19 offset:6144
  v_cvt_pk_bf16_f32 v85, v106, v107
  v_exp_f32 v108, v108
  v_add_f32 v29, v29, v107
  v_mfma_f32_32x32x16_bf16 v[112:127], v[76:79], a[252:255], v[112:127]
  s_waitcnt lgkmcnt(10)
  ds_read_b64_tr_b16 v[76:77], v20 offset:4096
  ds_read_b64_tr_b16 v[78:79], v20 offset:6144
  v_exp_f32 v109, v109
  v_fma_f32 v110, v110, s20, v31
  v_add_f32 v28, v28, v108
  v_mfma_f32_32x32x16_bf16 v[192:207], v[48:51], v[80:83], v[192:207]
  ds_read_b128 v[48:51], v9 offset:16384
  v_cvt_pk_bf16_f32 v86, v108, v109
  v_exp_f32 v110, v110
  v_fma_f32 v111, v111, s20, v31
  v_add_f32 v29, v29, v109
  v_mfma_f32_32x32x16_bf16 v[208:223], v[52:55], v[80:83], v[208:223]
  s_waitcnt lgkmcnt(9)
  ds_read_b128 v[52:55], v10 offset:16384
  v_exp_f32 v111, v111
  v_fma_f32 v112, v112, s20, v31
  v_add_f32 v28, v28, v110
  v_fma_f32 v113, v113, s20, v31
  v_mfma_f32_32x32x16_bf16 v[224:239], v[56:59], v[80:83], v[224:239]
  ds_read_b128 v[56:59], v11 offset:16384
  v_cvt_pk_bf16_f32 v87, v110, v111
  v_exp_f32 v112, v112
  v_add_f32 v29, v29, v111
  v_fma_f32 v114, v114, s20, v31
  v_mfma_f32_32x32x16_bf16 v[240:255], v[60:63], v[80:83], v[240:255]
  s_waitcnt lgkmcnt(7)
  ds_read_b128 v[60:63], v12 offset:16384
  v_exp_f32 v113, v113
  v_add_f32 v28, v28, v112
  v_exp_f32 v114, v114
  v_mfma_f32_32x32x16_bf16 v[192:207], v[64:67], v[84:87], v[192:207]
  ds_read_b128 v[64:67], v13 offset:16384
  v_cvt_pk_bf16_f32 v88, v112, v113
  v_fma_f32 v115, v115, s20, v31
  v_add_f32 v29, v29, v113
  v_exp_f32 v115, v115
  v_mfma_f32_32x32x16_bf16 v[208:223], v[68:71], v[84:87], v[208:223]
  s_waitcnt lgkmcnt(5)
  ds_read_b128 v[68:71], v14 offset:16384
  v_fma_f32 v116, v116, s20, v31
  v_add_f32 v28, v28, v114
  v_cvt_pk_bf16_f32 v89, v114, v115
  v_exp_f32 v116, v116
  v_mfma_f32_32x32x16_bf16 v[224:239], v[72:75], v[84:87], v[224:239]
  ds_read_b128 v[72:75], v15 offset:16384
  v_fma_f32 v117, v117, s20, v31
  v_add_f32 v29, v29, v115
  v_exp_f32 v117, v117
  v_fma_f32 v118, v118, s20, v31
  v_mfma_f32_32x32x16_bf16 v[240:255], v[76:79], v[84:87], v[240:255]
  s_waitcnt lgkmcnt(5)
  ds_read_b128 v[76:79], v16 offset:16384
  v_add_f32 v28, v28, v116
  v_cvt_pk_bf16_f32 v90, v116, v117
  v_exp_f32 v118, v118
  v_fma_f32 v119, v119, s20, v31
  v_mfma_f32_32x32x16_bf16 v[96:111], v[48:51], a[224:227], 0
  ds_read_b64_tr_b16 v[48:49], v17 offset:8192
  ds_read_b64_tr_b16 v[50:51], v17 offset:10240
  v_add_f32 v29, v29, v117
  v_exp_f32 v119, v119
  v_fma_f32 v120, v120, s20, v31
  v_mfma_f32_32x32x16_bf16 v[96:111], v[52:55], a[228:231], v[96:111]
  s_waitcnt lgkmcnt(6)
  ds_read_b64_tr_b16 v[52:53], v18 offset:8192
  ds_read_b64_tr_b16 v[54:55], v18 offset:10240
  v_add_f32 v28, v28, v118
  v_cvt_pk_bf16_f32 v91, v118, v119
  v_exp_f32 v120, v120
  v_mfma_f32_32x32x16_bf16 v[96:111], v[56:59], a[232:235], v[96:111]
  ds_read_b64_tr_b16 v[56:57], v19 offset:8192
  ds_read_b64_tr_b16 v[58:59], v19 offset:10240
  v_fma_f32 v121, v121, s20, v31
  v_add_f32 v29, v29, v119
  v_exp_f32 v121, v121
  v_mfma_f32_32x32x16_bf16 v[96:111], v[60:63], a[236:239], v[96:111]
  s_waitcnt lgkmcnt(8)
  ds_read_b64_tr_b16 v[60:61], v20 offset:8192
  ds_read_b64_tr_b16 v[62:63], v20 offset:10240
  v_fma_f32 v122, v122, s20, v31
  v_add_f32 v28, v28, v120
  v_cvt_pk_bf16_f32 v92, v120, v121
  v_fma_f32 v123, v123, s20, v31
  v_mfma_f32_32x32x16_bf16 v[96:111], v[64:67], a[240:243], v[96:111]
  ds_read_b64_tr_b16 v[64:65], v17 offset:12288
  ds_read_b64_tr_b16 v[66:67], v17 offset:14336
  v_exp_f32 v122, v122
  v_add_f32 v29, v29, v121
  v_fma_f32 v124, v124, s20, v31
  v_mfma_f32_32x32x16_bf16 v[96:111], v[68:71], a[244:247], v[96:111]
  s_waitcnt lgkmcnt(10)
  ds_read_b64_tr_b16 v[68:69], v18 offset:12288
  ds_read_b64_tr_b16 v[70:71], v18 offset:14336
  v_exp_f32 v123, v123
  v_add_f32 v28, v28, v122
  v_fma_f32 v125, v125, s20, v31
  v_mfma_f32_32x32x16_bf16 v[96:111], v[72:75], a[248:251], v[96:111]
  ds_read_b64_tr_b16 v[72:73], v19 offset:12288
  ds_read_b64_tr_b16 v[74:75], v19 offset:14336
  v_cvt_pk_bf16_f32 v93, v122, v123
  v_exp_f32 v124, v124
  v_add_f32 v29, v29, v123
  v_mfma_f32_32x32x16_bf16 v[96:111], v[76:79], a[252:255], v[96:111]
  s_waitcnt lgkmcnt(10)
  ds_read_b64_tr_b16 v[76:77], v20 offset:12288
  ds_read_b64_tr_b16 v[78:79], v20 offset:14336
  v_exp_f32 v125, v125
  v_fma_f32 v126, v126, s20, v31
  v_add_f32 v28, v28, v124
  v_mfma_f32_32x32x16_bf16 v[192:207], v[48:51], v[88:91], v[192:207]
  ds_read_b128 v[48:51], v9 offset:24576
  v_cvt_pk_bf16_f32 v94, v124, v125
  v_exp_f32 v126, v126
  v_fma_f32 v127, v127, s20, v31
  v_add_f32 v29, v29, v125
  v_mfma_f32_32x32x16_bf16 v[208:223], v[52:55], v[88:91], v[208:223]
  s_waitcnt lgkmcnt(9)
  ds_read_b128 v[52:55], v10 offset:24576
  v_exp_f32 v127, v127
  v_fma_f32 v96, v96, s20, v31
  v_add_f32 v28, v28, v126
  v_fma_f32 v97, v97, s20, v31
  v_mfma_f32_32x32x16_bf16 v[224:239], v[56:59], v[88:91], v[224:239]
  ds_read_b128 v[56:59], v11 offset:24576
  v_cvt_pk_bf16_f32 v95, v126, v127
  v_exp_f32 v96, v96
  v_add_f32 v29, v29, v127
  v_fma_f32 v98, v98, s20, v31
  v_mfma_f32_32x32x16_bf16 v[240:255], v[60:63], v[88:91], v[240:255]
  s_waitcnt lgkmcnt(7)
  ds_read_b128 v[60:63], v12 offset:24576
  v_exp_f32 v97, v97
  v_add_f32 v28, v28, v96
  v_exp_f32 v98, v98
  v_mfma_f32_32x32x16_bf16 v[192:207], v[64:67], v[92:95], v[192:207]
  ds_read_b128 v[64:67], v13 offset:24576
  v_cvt_pk_bf16_f32 v80, v96, v97
  v_fma_f32 v99, v99, s20, v31
  v_add_f32 v29, v29, v97
  v_exp_f32 v99, v99
  v_mfma_f32_32x32x16_bf16 v[208:223], v[68:71], v[92:95], v[208:223]
  s_waitcnt lgkmcnt(5)
  ds_read_b128 v[68:71], v14 offset:24576
  v_fma_f32 v100, v100, s20, v31
  v_add_f32 v28, v28, v98
  v_cvt_pk_bf16_f32 v81, v98, v99
  v_exp_f32 v100, v100
  v_mfma_f32_32x32x16_bf16 v[224:239], v[72:75], v[92:95], v[224:239]
  ds_read_b128 v[72:75], v15 offset:24576
  v_fma_f32 v101, v101, s20, v31
  v_add_f32 v29, v29, v99
  v_exp_f32 v101, v101
  v_fma_f32 v102, v102, s20, v31
  v_mfma_f32_32x32x16_bf16 v[240:255], v[76:79], v[92:95], v[240:255]
  s_waitcnt lgkmcnt(5)
  ds_read_b128 v[76:79], v16 offset:24576
  v_add_f32 v28, v28, v100
  v_cvt_pk_bf16_f32 v82, v100, v101
  v_exp_f32 v102, v102
  v_fma_f32 v103, v103, s20, v31
  v_mfma_f32_32x32x16_bf16 v[112:127], v[48:51], a[224:227], 0
  ds_read_b64_tr_b16 v[48:49], v17 offset:16384
  ds_read_b64_tr_b16 v[50:51], v17 offset:18432
  v_add_f32 v29, v29, v101
  v_exp_f32 v103, v103
  v_fma_f32 v104, v104, s20, v31
  v_mfma_f32_32x32x16_bf16 v[112:127], v[52:55], a[228:231], v[112:127]
  s_waitcnt lgkmcnt(6)
  ds_read_b64_tr_b16 v[52:53], v18 offset:16384
  ds_read_b64_tr_b16 v[54:55], v18 offset:18432
  v_add_f32 v28, v28, v102
  v_cvt_pk_bf16_f32 v83, v102, v103
  v_exp_f32 v104, v104
  v_mfma_f32_32x32x16_bf16 v[112:127], v[56:59], a[232:235], v[112:127]
  ds_read_b64_tr_b16 v[56:57], v19 offset:16384
  ds_read_b64_tr_b16 v[58:59], v19 offset:18432
  v_fma_f32 v105, v105, s20, v31
  v_add_f32 v29, v29, v103
  v_exp_f32 v105, v105
  v_mfma_f32_32x32x16_bf16 v[112:127], v[60:63], a[236:239], v[112:127]
  s_waitcnt lgkmcnt(8)
  ds_read_b64_tr_b16 v[60:61], v20 offset:16384
  ds_read_b64_tr_b16 v[62:63], v20 offset:18432
  v_fma_f32 v106, v106, s20, v31
  v_add_f32 v28, v28, v104
  v_cvt_pk_bf16_f32 v84, v104, v105
  v_fma_f32 v107, v107, s20, v31
  v_mfma_f32_32x32x16_bf16 v[112:127], v[64:67], a[240:243], v[112:127]
  ds_read_b64_tr_b16 v[64:65], v17 offset:20480
  ds_read_b64_tr_b16 v[66:67], v17 offset:22528
  v_exp_f32 v106, v106
  v_add_f32 v29, v29, v105
  v_fma_f32 v108, v108, s20, v31
  v_mfma_f32_32x32x16_bf16 v[112:127], v[68:71], a[244:247], v[112:127]
  s_waitcnt lgkmcnt(10)
  ds_read_b64_tr_b16 v[68:69], v18 offset:20480
  ds_read_b64_tr_b16 v[70:71], v18 offset:22528
  v_exp_f32 v107, v107
  v_add_f32 v28, v28, v106
  v_fma_f32 v109, v109, s20, v31
  v_mfma_f32_32x32x16_bf16 v[112:127], v[72:75], a[248:251], v[112:127]
  ds_read_b64_tr_b16 v[72:73], v19 offset:20480
  ds_read_b64_tr_b16 v[74:75], v19 offset:22528
  v_cvt_pk_bf16_f32 v85, v106, v107
  v_exp_f32 v108, v108
  v_add_f32 v29, v29, v107
  v_mfma_f32_32x32x16_bf16 v[112:127], v[76:79], a[252:255], v[112:127]
  s_waitcnt lgkmcnt(10)
  ds_read_b64_tr_b16 v[76:77], v20 offset:20480
  ds_read_b64_tr_b16 v[78:79], v20 offset:22528
  v_exp_f32 v109, v109
  v_fma_f32 v110, v110, s20, v31
  v_add_f32 v28, v28, v108
  v_mfma_f32_32x32x16_bf16 v[192:207], v[48:51], v[80:83], v[192:207]
  ds_read_b128 v[48:51], v1
  v_cvt_pk_bf16_f32 v86, v108, v109
  v_exp_f32 v110, v110
  v_fma_f32 v111, v111, s20, v31
  v_add_f32 v29, v29, v109
  v_mfma_f32_32x32x16_bf16 v[208:223], v[52:55], v[80:83], v[208:223]
  s_waitcnt lgkmcnt(9)
  ds_read_b128 v[52:55], v2
  v_exp_f32 v111, v111
  v_fma_f32 v112, v112, s20, v31
  v_add_f32 v28, v28, v110
  v_fma_f32 v113, v113, s20, v31
  v_mfma_f32_32x32x16_bf16 v[224:239], v[56:59], v[80:83], v[224:239]
  ds_read_b128 v[56:59], v3
  v_cvt_pk_bf16_f32 v87, v110, v111
  v_exp_f32 v112, v112
  v_add_f32 v29, v29, v111
  v_fma_f32 v114, v114, s20, v31
  v_mfma_f32_32x32x16_bf16 v[240:255], v[60:63], v[80:83], v[240:255]
  s_waitcnt lgkmcnt(7)
  ds_read_b128 v[60:63], v4
  v_exp_f32 v113, v113
  v_add_f32 v28, v28, v112
  v_exp_f32 v114, v114
  v_mfma_f32_32x32x16_bf16 v[192:207], v[64:67], v[84:87], v[192:207]
  ds_read_b128 v[64:67], v5
  v_cvt_pk_bf16_f32 v88, v112, v113
  v_fma_f32 v115, v115, s20, v31
  v_add_f32 v29, v29, v113
  v_exp_f32 v115, v115
  v_mfma_f32_32x32x16_bf16 v[208:223], v[68:71], v[84:87], v[208:223]
  s_waitcnt lgkmcnt(5)
  ds_read_b128 v[68:71], v6
  v_fma_f32 v116, v116, s20, v31
  v_add_f32 v28, v28, v114
  v_cvt_pk_bf16_f32 v89, v114, v115
  v_exp_f32 v116, v116
  v_mfma_f32_32x32x16_bf16 v[224:239], v[72:75], v[84:87], v[224:239]
  ds_read_b128 v[72:75], v7
  v_fma_f32 v117, v117, s20, v31
  v_add_f32 v29, v29, v115
  v_exp_f32 v117, v117
  v_fma_f32 v118, v118, s20, v31
  v_mfma_f32_32x32x16_bf16 v[240:255], v[76:79], v[84:87], v[240:255]
  s_waitcnt vmcnt(14) lgkmcnt(5)
  ds_read_b128 v[76:79], v8
  v_add_f32 v28, v28, v116
  v_cvt_pk_bf16_f32 v90, v116, v117
  v_exp_f32 v118, v118
  v_fma_f32 v119, v119, s20, v31
  v_mfma_f32_32x32x16_bf16 v[96:111], v[48:51], a[192:195], 0
  ds_read_b64_tr_b16 v[48:49], v17 offset:24576
  ds_read_b64_tr_b16 v[50:51], v17 offset:26624
  v_add_f32 v29, v29, v117
  v_exp_f32 v119, v119
  v_fma_f32 v120, v120, s20, v31
  v_mfma_f32_32x32x16_bf16 v[96:111], v[52:55], a[196:199], v[96:111]
  s_waitcnt vmcnt(12) lgkmcnt(6)
  ds_read_b64_tr_b16 v[52:53], v18 offset:24576
  ds_read_b64_tr_b16 v[54:55], v18 offset:26624
  v_add_f32 v28, v28, v118
  v_cvt_pk_bf16_f32 v91, v118, v119
  v_exp_f32 v120, v120
  v_mfma_f32_32x32x16_bf16 v[96:111], v[56:59], a[200:203], v[96:111]
  ds_read_b64_tr_b16 v[56:57], v19 offset:24576
  ds_read_b64_tr_b16 v[58:59], v19 offset:26624
  v_fma_f32 v121, v121, s20, v31
  v_add_f32 v29, v29, v119
  v_exp_f32 v121, v121
  v_mfma_f32_32x32x16_bf16 v[96:111], v[60:63], a[204:207], v[96:111]
  s_waitcnt vmcnt(6) lgkmcnt(8)
  ds_read_b64_tr_b16 v[60:61], v20 offset:24576
  ds_read_b64_tr_b16 v[62:63], v20 offset:26624
  v_fma_f32 v122, v122, s20, v31
  v_add_f32 v28, v28, v120
  v_cvt_pk_bf16_f32 v92, v120, v121
  v_fma_f32 v123, v123, s20, v31
  v_mfma_f32_32x32x16_bf16 v[96:111], v[64:67], a[208:211], v[96:111]
  ds_read_b64_tr_b16 v[64:65], v17 offset:28672
  ds_read_b64_tr_b16 v[66:67], v17 offset:30720
  v_exp_f32 v122, v122
  v_add_f32 v29, v29, v121
  v_fma_f32 v124, v124, s20, v31
  v_mfma_f32_32x32x16_bf16 v[96:111], v[68:71], a[212:215], v[96:111]
  s_waitcnt vmcnt(4) lgkmcnt(10)
  ds_read_b64_tr_b16 v[68:69], v18 offset:28672
  ds_read_b64_tr_b16 v[70:71], v18 offset:30720
  v_exp_f32 v123, v123
  v_add_f32 v28, v28, v122
  v_fma_f32 v125, v125, s20, v31
  v_mfma_f32_32x32x16_bf16 v[96:111], v[72:75], a[216:219], v[96:111]
  ds_read_b64_tr_b16 v[72:73], v19 offset:28672
  ds_read_b64_tr_b16 v[74:75], v19 offset:30720
  v_cvt_pk_bf16_f32 v93, v122, v123
  v_exp_f32 v124, v124
  v_add_f32 v29, v29, v123
  v_mfma_f32_32x32x16_bf16 v[96:111], v[76:79], a[220:223], v[96:111]
  s_waitcnt lgkmcnt(10)
  ds_read_b64_tr_b16 v[76:77], v20 offset:28672
  ds_read_b64_tr_b16 v[78:79], v20 offset:30720
  v_exp_f32 v125, v125
  v_fma_f32 v126, v126, s20, v31
  v_add_f32 v28, v28, v124
  v_mfma_f32_32x32x16_bf16 v[192:207], v[48:51], v[88:91], v[192:207]
  ds_read_b128 v[48:51], v1 offset:8192
  v_cvt_pk_bf16_f32 v94, v124, v125
  v_exp_f32 v126, v126
  v_fma_f32 v127, v127, s20, v31
  v_add_f32 v29, v29, v125
  v_mfma_f32_32x32x16_bf16 v[208:223], v[52:55], v[88:91], v[208:223]
  s_waitcnt lgkmcnt(9)
  ds_read_b128 v[52:55], v2 offset:8192
  v_exp_f32 v127, v127
  v_max3_f32 v32, v96, v97, v98
  v_max3_f32 v33, v99, v100, v101
  v_max3_f32 v32, v32, v102, v103
  v_max3_f32 v33, v33, v104, v105
  v_mfma_f32_32x32x16_bf16 v[224:239], v[56:59], v[88:91], v[224:239]
  ds_read_b128 v[56:59], v3 offset:8192
  v_add_f32 v28, v28, v126
  v_cvt_pk_bf16_f32 v95, v126, v127
  v_max3_f32 v32, v32, v106, v107
  v_max3_f32 v33, v33, v108, v109
  v_max3_f32 v32, v32, v110, v111
  v_max_f32 v32, v32, v33
  v_max_f32 v33, v32, v33
  v_mfma_f32_32x32x16_bf16 v[240:255], v[60:63], v[88:91], v[240:255]
  s_waitcnt lgkmcnt(7)
  ds_read_b128 v[60:63], v4 offset:8192
  v_add_f32 v29, v29, v127
  v_permlane32_swap_b32 v32, v33
  v_max_f32 v32, v32, v33
  v_mul_f32 v30, s23, v32
  v_fma_f32 v96, v96, s20, v30
  v_fma_f32 v97, v97, s20, v30
  v_mfma_f32_32x32x16_bf16 v[192:207], v[64:67], v[92:95], v[192:207]
  ds_read_b128 v[64:67], v5 offset:8192
  v_exp_f32 v96, v96
  v_exp_f32 v97, v97
  v_fma_f32 v98, v98, s20, v30
  v_mfma_f32_32x32x16_bf16 v[208:223], v[68:71], v[92:95], v[208:223]
  s_waitcnt lgkmcnt(5)
  ds_read_b128 v[68:71], v6 offset:8192
  v_cvt_pk_bf16_f32 v80, v96, v97
  v_exp_f32 v98, v98
  v_fma_f32 v99, v99, s20, v30
  v_mov_b32 v26, v96
  v_mfma_f32_32x32x16_bf16 v[224:239], v[72:75], v[92:95], v[224:239]
  ds_read_b128 v[72:75], v7 offset:8192
  v_mov_b32 v27, v97
  v_exp_f32 v99, v99
  v_fma_f32 v100, v100, s20, v30
  v_add_f32 v40, v28, v29
  v_add_f32 v41, v28, v29
  v_mfma_f32_32x32x16_bf16 v[240:255], v[76:79], v[92:95], v[240:255]
  s_waitcnt lgkmcnt(5)
  ds_read_b128 v[76:79], v8 offset:8192
  v_add_f32 v26, v26, v98
  v_cvt_pk_bf16_f32 v81, v98, v99
  v_exp_f32 v100, v100
  v_fma_f32 v101, v101, s20, v30
  v_permlane32_swap_b32 v40, v41
  v_mfma_f32_32x32x16_bf16 v[112:127], v[48:51], a[192:195], 0
  v_add_f32 v27, v27, v99
  v_exp_f32 v101, v101
  v_fma_f32 v102, v102, s20, v30
  v_add_f32 v40, v40, v41
  v_add_f32 v40, v40, v22
  v_cmp_nge_f32 vcc, 0x47800000, v40
  v_rcp_f32 v40, v40
  v_mfma_f32_32x32x16_bf16 v[112:127], v[52:55], a[196:199], v[112:127]
  s_waitcnt lgkmcnt(4)
  v_add_f32 v26, v26, v100
  v_cvt_pk_bf16_f32 v82, v100, v101
  v_exp_f32 v102, v102
  v_fma_f32 v103, v103, s20, v30
  s_cbranch_vccz L_OK1
  s_call_b64 s[32:33], L_SLOW1
L_OK1:
  v_mfma_f32_32x32x16_bf16 v[112:127], v[56:59], a[200:203], v[112:127]
  v_add_f32 v27, v27, v101
  v_exp_f32 v103, v103
  v_fma_f32 v104, v104, s20, v30
  v_fma_f32 v105, v105, s20, v30
  v_mul_f32 v192, v192, v40
  v_mul_f32 v193, v193, v40
  v_mfma_f32_32x32x16_bf16 v[112:127], v[60:63], a[204:207], v[112:127]
  s_waitcnt lgkmcnt(2)
  v_add_f32 v26, v26, v102
  v_cvt_pk_bf16_f32 v83, v102, v103
  v_exp_f32 v104, v104
  v_exp_f32 v105, v105
  v_fma_f32 v106, v106, s20, v30
  v_mul_f32 v194, v194, v40
  v_mfma_f32_32x32x16_bf16 v[112:127], v[64:67], a[208:211], v[112:127]
  v_add_f32 v27, v27, v103
  v_cvt_pk_bf16_f32 v84, v104, v105
  v_exp_f32 v106, v106
  v_fma_f32 v107, v107, s20, v30
  v_mul_f32 v195, v195, v40
  v_mfma_f32_32x32x16_bf16 v[112:127], v[68:71], a[212:215], v[112:127]
  s_waitcnt lgkmcnt(0)
  v_add_f32 v26, v26, v104
  v_add_f32 v27, v27, v105
  v_exp_f32 v107, v107
  v_fma_f32 v108, v108, s20, v30
  v_mul_f32 v196, v196, v40
  v_mfma_f32_32x32x16_bf16 v[112:127], v[72:75], a[216:219], v[112:127]
  v_add_f32 v26, v26, v106
  v_cvt_pk_bf16_f32 v85, v106, v107
  v_exp_f32 v108, v108
  v_fma_f32 v109, v109, s20, v30
  v_mul_f32 v197, v197, v40
  v_mfma_f32_32x32x16_bf16 v[112:127], v[76:79], a[220:223], v[112:127]
  v_add_f32 v27, v27, v107
  v_exp_f32 v109, v109
  v_fma_f32 v110, v110, s20, v30
  v_mul_f32 v198, v198, v40
  v_mul_f32 v199, v199, v40
  v_mfma_f32_32x32x16_bf16 v[128:143], a[0:3], v[80:83], 0
  ds_read_b128 v[48:51], v1 offset:16384
  v_add_f32 v26, v26, v108
  v_cvt_pk_bf16_f32 v86, v108, v109
  v_exp_f32 v110, v110
  v_fma_f32 v111, v111, s20, v30
  v_cvt_pk_bf16_f32 v192, v192, v193
  v_mfma_f32_32x32x16_bf16 v[144:159], a[4:7], v[80:83], 0
  ds_read_b128 v[52:55], v2 offset:16384
  v_add_f32 v27, v27, v109
  v_exp_f32 v111, v111
  v_cvt_pk_bf16_f32 v193, v194, v195
  v_fma_f32 v112, v112, s20, v30
  v_mfma_f32_32x32x16_bf16 v[160:175], a[8:11], v[80:83], 0
  ds_read_b128 v[56:59], v3 offset:16384
  v_add_f32 v26, v26, v110
  v_cvt_pk_bf16_f32 v87, v110, v111
  v_cvt_pk_bf16_f32 v194, v196, v197
  v_exp_f32 v112, v112
  v_fma_f32 v113, v113, s20, v30
  v_mfma_f32_32x32x16_bf16 v[176:191], a[12:15], v[80:83], 0
  ds_read_b128 v[60:63], v4 offset:16384
  v_add_f32 v27, v27, v111
  v_cvt_pk_bf16_f32 v195, v198, v199
  v_exp_f32 v113, v113
  v_fma_f32 v114, v114, s20, v30
  v_mfma_f32_32x32x16_bf16 v[128:143], a[16:19], v[84:87], v[128:143]
  ds_read_b128 v[64:67], v5 offset:16384
  v_mul_f32 v200, v200, v40
  v_mul_f32 v201, v201, v40
  v_cvt_pk_bf16_f32 v88, v112, v113
  v_exp_f32 v114, v114
  v_fma_f32 v115, v115, s20, v30
  v_mfma_f32_32x32x16_bf16 v[144:159], a[20:23], v[84:87], v[144:159]
  ds_read_b128 v[68:71], v6 offset:16384
  ds_write_b128 v34, v[192:195]
  v_mul_f32 v202, v202, v40
  v_exp_f32 v115, v115
  v_fma_f32 v116, v116, s20, v30
  v_mfma_f32_32x32x16_bf16 v[160:175], a[24:27], v[84:87], v[160:175]
  ds_read_b128 v[72:75], v7 offset:16384
  v_mul_f32 v203, v203, v40
  v_cvt_pk_bf16_f32 v89, v114, v115
  v_exp_f32 v116, v116
  v_fma_f32 v117, v117, s20, v30
  v_mfma_f32_32x32x16_bf16 v[176:191], a[28:31], v[84:87], v[176:191]
  s_waitcnt lgkmcnt(6)
  ds_read_b128 v[76:79], v8 offset:16384
  v_mul_f32 v204, v204, v40
  v_exp_f32 v117, v117
  v_fma_f32 v118, v118, s20, v30
  v_mul_f32 v205, v205, v40
  v_mfma_f32_32x32x16_bf16 v[96:111], v[48:51], a[192:195], 0
  v_cvt_pk_bf16_f32 v90, v116, v117
  v_exp_f32 v118, v118
  v_fma_f32 v119, v119, s20, v30
  v_mul_f32 v206, v206, v40
  v_mul_f32 v207, v207, v40
  v_mfma_f32_32x32x16_bf16 v[96:111], v[52:55], a[196:199], v[96:111]
  s_waitcnt lgkmcnt(5)
  v_exp_f32 v119, v119
  v_fma_f32 v120, v120, s20, v30
  v_cvt_pk_bf16_f32 v200, v200, v201
  v_exp_f32 v120, v120
  v_mfma_f32_32x32x16_bf16 v[96:111], v[56:59], a[200:203], v[96:111]
  v_cvt_pk_bf16_f32 v91, v118, v119
  v_fma_f32 v121, v121, s20, v30
  v_cvt_pk_bf16_f32 v201, v202, v203
  v_exp_f32 v121, v121
  v_fma_f32 v122, v122, s20, v30
  v_mfma_f32_32x32x16_bf16 v[96:111], v[60:63], a[204:207], v[96:111]
  s_waitcnt lgkmcnt(3)
  v_cvt_pk_bf16_f32 v202, v204, v205
  v_cvt_pk_bf16_f32 v92, v120, v121
  v_exp_f32 v122, v122
  v_fma_f32 v123, v123, s20, v30
  v_cvt_pk_bf16_f32 v203, v206, v207
  v_mfma_f32_32x32x16_bf16 v[96:111], v[64:67], a[208:211], v[96:111]
  v_exp_f32 v123, v123
  v_fma_f32 v124, v124, s20, v30
  v_mul_f32 v208, v208, v40
  v_mul_f32 v209, v209, v40
  v_fma_f32 v125, v125, s20, v30
  v_mfma_f32_32x32x16_bf16 v[96:111], v[68:71], a[212:215], v[96:111]
  s_waitcnt lgkmcnt(0)
  ds_write_b128 v35, v[200:203]
  v_cvt_pk_bf16_f32 v93, v122, v123
  v_exp_f32 v124, v124
  v_mul_f32 v210, v210, v40
  v_mfma_f32_32x32x16_bf16 v[96:111], v[72:75], a[216:219], v[96:111]
  v_exp_f32 v125, v125
  v_fma_f32 v126, v126, s20, v30
  v_mul_f32 v211, v211, v40
  v_exp_f32 v126, v126
  v_mfma_f32_32x32x16_bf16 v[96:111], v[76:79], a[220:223], v[96:111]
  v_cvt_pk_bf16_f32 v94, v124, v125
  v_fma_f32 v127, v127, s20, v30
  v_mul_f32 v212, v212, v40
  v_exp_f32 v127, v127
  v_mul_f32 v213, v213, v40
  v_mfma_f32_32x32x16_bf16 v[128:143], a[32:35], v[88:91], v[128:143]
  ds_read_b128 v[48:51], v1 offset:24576
  v_cvt_pk_bf16_f32 v95, v126, v127
  v_mul_f32 v214, v214, v40
  v_mul_f32 v215, v215, v40
  v_cvt_pk_bf16_f32 v208, v208, v209
  v_cvt_pk_bf16_f32 v209, v210, v211
  v_mfma_f32_16x16x32_bf16 v[22:25], v[44:47], v[88:91], 0
  v_cvt_pk_bf16_f32 v210, v212, v213
  v_cvt_pk_bf16_f32 v211, v214, v215
  v_mfma_f32_32x32x16_bf16 v[144:159], a[36:39], v[88:91], v[144:159]
  ds_read_b128 v[52:55], v2 offset:24576
  v_fma_f32 v96, v96, s20, v30
  v_exp_f32 v96, v96
  v_fma_f32 v97, v97, s20, v30
  v_fma_f32 v98, v98, s20, v30
  v_mfma_f32_32x32x16_bf16 v[160:175], a[40:43], v[88:91], v[160:175]
  ds_read_b128 v[56:59], v3 offset:24576
  v_exp_f32 v97, v97
  v_exp_f32 v98, v98
  v_fma_f32 v99, v99, s20, v30
  v_mfma_f32_32x32x16_bf16 v[176:191], a[44:47], v[88:91], v[176:191]
  ds_read_b128 v[60:63], v4 offset:24576
  v_cvt_pk_bf16_f32 v80, v96, v97
  v_exp_f32 v99, v99
  v_fma_f32 v100, v100, s20, v30
  v_mul_f32 v216, v216, v40
  v_mfma_f32_32x32x16_bf16 v[128:143], a[48:51], v[92:95], v[128:143]
  ds_read_b128 v[64:67], v5 offset:24576
  v_cvt_pk_bf16_f32 v81, v98, v99
  v_mul_f32 v217, v217, v40
  v_exp_f32 v100, v100
  v_fma_f32 v101, v101, s20, v30
  v_mfma_f32_16x16x32_bf16 v[22:25], v[44:47], v[92:95], v[22:25]
  ds_write_b128 v36, v[208:211]
  v_mfma_f32_32x32x16_bf16 v[144:159], a[52:55], v[92:95], v[144:159]
  ds_read_b128 v[68:71], v6 offset:24576
  v_mul_f32 v218, v218, v40
  v_exp_f32 v101, v101
  v_fma_f32 v102, v102, s20, v30
  v_mul_f32 v219, v219, v40
  v_mfma_f32_32x32x16_bf16 v[160:175], a[56:59], v[92:95], v[160:175]
  ds_read_b128 v[72:75], v7 offset:24576
  v_cvt_pk_bf16_f32 v82, v100, v101
  v_exp_f32 v102, v102
  v_fma_f32 v103, v103, s20, v30
  v_mul_f32 v220, v220, v40
  v_mfma_f32_32x32x16_bf16 v[176:191], a[60:63], v[92:95], v[176:191]
  s_waitcnt lgkmcnt(6)
  ds_read_b128 v[76:79], v8 offset:24576
  v_exp_f32 v103, v103
  v_fma_f32 v104, v104, s20, v30
  v_mul_f32 v221, v221, v40
  v_fma_f32 v105, v105, s20, v30
  v_mfma_f32_32x32x16_bf16 v[112:127], v[48:51], a[192:195], 0
  v_cvt_pk_bf16_f32 v83, v102, v103
  v_exp_f32 v104, v104
  v_mul_f32 v222, v222, v40
  v_mul_f32 v223, v223, v40
  v_fma_f32 v106, v106, s20, v30
  v_mfma_f32_32x32x16_bf16 v[112:127], v[52:55], a[196:199], v[112:127]
  s_waitcnt lgkmcnt(5)
  v_exp_f32 v105, v105
  v_cvt_pk_bf16_f32 v216, v216, v217
  v_exp_f32 v106, v106
  v_fma_f32 v107, v107, s20, v30
  v_mfma_f32_32x32x16_bf16 v[112:127], v[56:59], a[200:203], v[112:127]
  ds_read_b128 v[56:59], v3 offset:32768
  v_cvt_pk_bf16_f32 v84, v104, v105
  v_cvt_pk_bf16_f32 v217, v218, v219
  v_exp_f32 v107, v107
  v_fma_f32 v108, v108, s20, v30
  v_mfma_f32_32x32x16_bf16 v[112:127], v[60:63], a[204:207], v[112:127]
  s_waitcnt lgkmcnt(3)
  ds_read_b128 v[60:63], v4 offset:32768
  v_cvt_pk_bf16_f32 v218, v220, v221
  v_cvt_pk_bf16_f32 v85, v106, v107
  v_exp_f32 v108, v108
  v_fma_f32 v109, v109, s20, v30
  v_mfma_f32_32x32x16_bf16 v[112:127], v[64:67], a[208:211], v[112:127]
  v_cvt_pk_bf16_f32 v219, v222, v223
  v_exp_f32 v109, v109
  v_fma_f32 v110, v110, s20, v30
  v_mul_f32 v224, v224, v40
  v_mul_f32 v225, v225, v40
  v_mfma_f32_32x32x16_bf16 v[112:127], v[68:71], a[212:215], v[112:127]
  s_waitcnt lgkmcnt(2)
  ds_write_b128 v37, v[216:219]
  v_cvt_pk_bf16_f32 v86, v108, v109
  v_exp_f32 v110, v110
  v_fma_f32 v111, v111, s20, v30
  v_mfma_f32_32x32x16_bf16 v[112:127], v[72:75], a[216:219], v[112:127]
  ds_read_b128 v[72:75], v7 offset:32768
  ds_read_b128 v[196:199], v38
  v_mul_f32 v226, v226, v40
  v_exp_f32 v111, v111
  v_mul_f32 v227, v227, v40
  v_mfma_f32_32x32x16_bf16 v[112:127], v[76:79], a[220:223], v[112:127]
  ds_read_b128 v[76:79], v8 offset:32768
  ds_read_b128 v[204:207], v39 offset:1024
  v_cvt_pk_bf16_f32 v87, v110, v111
  v_mul_f32 v228, v228, v40
  v_mul_f32 v229, v229, v40
  v_mul_f32 v230, v230, v40
  v_mfma_f32_32x32x16_bf16 v[128:143], a[64:67], v[80:83], v[128:143]
  ds_read_b128 v[48:51], v1 offset:32768
  ds_read_b128 v[212:215], v38 offset:2048
  v_mul_f32 v231, v231, v40
  v_cvt_pk_bf16_f32 v224, v224, v225
  v_cvt_pk_bf16_f32 v225, v226, v227
  v_cvt_pk_bf16_f32 v226, v228, v229
  v_mfma_f32_16x16x32_bf16 v[22:25], v[44:47], v[80:83], v[22:25]
  ds_read_b128 v[220:223], v39 offset:3072
  v_cvt_pk_bf16_f32 v227, v230, v231
  v_mfma_f32_32x32x16_bf16 v[144:159], a[68:71], v[80:83], v[144:159]
  ds_read_b128 v[52:55], v2 offset:32768
  v_fma_f32 v112, v112, s20, v30
  v_fma_f32 v113, v113, s20, v30
  v_exp_f32 v112, v112
  v_fma_f32 v114, v114, s20, v30
  v_mfma_f32_32x32x16_bf16 v[128:143], a[80:83], v[84:87], v[128:143]
  ds_read_b128 v[64:67], v5 offset:32768
  v_exp_f32 v113, v113
  v_exp_f32 v114, v114
  v_fma_f32 v115, v115, s20, v30
  v_mfma_f32_16x16x32_bf16 v[22:25], v[44:47], v[84:87], v[22:25]
  v_cvt_pk_bf16_f32 v88, v112, v113
  v_fma_f32 v116, v116, s20, v30
  v_mfma_f32_32x32x16_bf16 v[144:159], a[84:87], v[84:87], v[144:159]
  s_waitcnt lgkmcnt(1)
  ds_read_b128 v[68:71], v6 offset:32768
  v_exp_f32 v115, v115
  v_fma_f32 v117, v117, s20, v30
  v_exp_f32 v116, v116
  v_mfma_f32_32x32x16_bf16 v[96:111], v[48:51], a[192:195], 0
  v_cvt_pk_bf16_f32 v89, v114, v115
  v_exp_f32 v117, v117
  v_fma_f32 v118, v118, s20, v30
  v_exp_f32 v118, v118
  v_mfma_f32_32x32x16_bf16 v[96:111], v[52:55], a[196:199], v[96:111]
  buffer_store_dwordx4 v[196:199], v21, s[16:19], s40 offen sc1
  v_cvt_pk_bf16_f32 v90, v116, v117
  v_fma_f32 v119, v119, s20, v30
  v_exp_f32 v119, v119
  v_fma_f32 v120, v120, s20, v30
  v_mfma_f32_32x32x16_bf16 v[96:111], v[56:59], a[200:203], v[96:111]
  ds_read_b128 v[56:59], v3 offset:49152
  buffer_store_dwordx4 v[204:207], v21, s[16:19], s40 offen offset:2048 sc1
  v_fma_f32 v121, v121, s20, v30
  v_mul_f32 v232, v232, v40
  v_mul_f32 v233, v233, v40
  v_cvt_pk_bf16_f32 v91, v118, v119
  v_mfma_f32_32x32x16_bf16 v[96:111], v[60:63], a[204:207], v[96:111]
  s_waitcnt lgkmcnt(1)
  ds_read_b128 v[60:63], v4 offset:49152
  v_exp_f32 v120, v120
  v_exp_f32 v121, v121
  v_fma_f32 v122, v122, s20, v30
  v_mfma_f32_32x32x16_bf16 v[96:111], v[64:67], a[208:211], v[96:111]
  buffer_store_dwordx4 v[212:215], v21, s[16:19], s45 offen sc1
  ds_write_b128 v34, v[224:227]
  v_mul_f32 v234, v234, v40
  v_cvt_pk_bf16_f32 v92, v120, v121
  v_fma_f32 v123, v123, s20, v30
  v_mfma_f32_32x32x16_bf16 v[96:111], v[68:71], a[212:215], v[96:111]
  buffer_store_dwordx4 v[220:223], v21, s[16:19], s45 offen offset:2048 sc1
  v_exp_f32 v122, v122
  v_mul_f32 v235, v235, v40
  v_exp_f32 v123, v123
  v_mfma_f32_32x32x16_bf16 v[96:111], v[72:75], a[216:219], v[96:111]
  ds_read_b128 v[72:75], v7 offset:49152
  v_fma_f32 v124, v124, s20, v30
  v_fma_f32 v125, v125, s20, v30
  v_mul_f32 v236, v236, v40
  v_cvt_pk_bf16_f32 v93, v122, v123
  v_fma_f32 v126, v126, s20, v30
  v_mfma_f32_32x32x16_bf16 v[96:111], v[76:79], a[220:223], v[96:111]
  ds_read_b128 v[76:79], v8 offset:49152
  v_exp_f32 v124, v124
  v_exp_f32 v125, v125
  v_mul_f32 v237, v237, v40
  v_mfma_f32_32x32x16_bf16 v[128:143], a[96:99], v[88:91], v[128:143]
  ds_read_b128 v[48:51], v1 offset:49152
  v_cvt_pk_bf16_f32 v94, v124, v125
  v_exp_f32 v126, v126
  v_fma_f32 v127, v127, s20, v30
  v_mul_f32 v238, v238, v40
  v_mfma_f32_16x16x32_bf16 v[22:25], v[44:47], v[88:91], v[22:25]
  v_mul_f32 v239, v239, v40
  v_exp_f32 v127, v127
  v_mfma_f32_32x32x16_bf16 v[144:159], a[100:103], v[88:91], v[144:159]
  ds_read_b128 v[52:55], v2 offset:49152
  v_cvt_pk_bf16_f32 v232, v232, v233
  v_cvt_pk_bf16_f32 v95, v126, v127
  v_fma_f32 v96, v96, s20, v30
  v_fma_f32 v97, v97, s20, v30
  v_cvt_pk_bf16_f32 v233, v234, v235
  v_mfma_f32_32x32x16_bf16 v[128:143], a[112:115], v[92:95], v[128:143]
  ds_read_b128 v[64:67], v5 offset:49152
  v_exp_f32 v96, v96
  v_exp_f32 v97, v97
  v_fma_f32 v98, v98, s20, v30
  v_mfma_f32_16x16x32_bf16 v[22:25], v[44:47], v[92:95], v[22:25]
  v_cvt_pk_bf16_f32 v234, v236, v237
  v_cvt_pk_bf16_f32 v192, v96, v97
  v_exp_f32 v98, v98
  v_mfma_f32_32x32x16_bf16 v[144:159], a[116:119], v[92:95], v[144:159]
  s_waitcnt lgkmcnt(1)
  ds_read_b128 v[68:71], v6 offset:49152
  v_cvt_pk_bf16_f32 v235, v238, v239
  v_fma_f32 v99, v99, s20, v30
  v_mul_f32 v240, v240, v40
  v_mul_f32 v241, v241, v40
  v_fma_f32 v100, v100, s20, v30
  v_mfma_f32_32x32x16_bf16 v[112:127], v[48:51], a[192:195], 0
  ds_write_b128 v35, v[232:235]
  v_exp_f32 v99, v99
  v_fma_f32 v101, v101, s20, v30
  v_mul_f32 v242, v242, v40
  v_mfma_f32_32x32x16_bf16 v[112:127], v[52:55], a[196:199], v[112:127]
  v_cvt_pk_bf16_f32 v193, v98, v99
  v_exp_f32 v100, v100
  v_exp_f32 v101, v101
  v_fma_f32 v102, v102, s20, v30
  v_mfma_f32_32x32x16_bf16 v[112:127], v[56:59], a[200:203], v[112:127]
  ds_read_b128 v[56:59], v3 offset:57344
  v_mul_f32 v243, v243, v40
  v_cvt_pk_bf16_f32 v194, v100, v101
  v_exp_f32 v102, v102
  v_fma_f32 v103, v103, s20, v30
  v_mfma_f32_32x32x16_bf16 v[112:127], v[60:63], a[204:207], v[112:127]
  s_waitcnt lgkmcnt(2)
  ds_read_b128 v[60:63], v4 offset:57344
  v_mul_f32 v244, v244, v40
  v_exp_f32 v103, v103
  v_fma_f32 v104, v104, s20, v30
  v_fma_f32 v105, v105, s20, v30
  v_mfma_f32_32x32x16_bf16 v[112:127], v[64:67], a[208:211], v[112:127]
  v_mul_f32 v245, v245, v40
  v_cvt_pk_bf16_f32 v195, v102, v103
  v_exp_f32 v104, v104
  v_exp_f32 v105, v105
  v_fma_f32 v106, v106, s20, v30
  v_mfma_f32_32x32x16_bf16 v[112:127], v[68:71], a[212:215], v[112:127]
  v_mul_f32 v246, v246, v40
  v_mul_f32 v247, v247, v40
  v_cvt_pk_bf16_f32 v196, v104, v105
  v_exp_f32 v106, v106
  v_fma_f32 v107, v107, s20, v30
  v_mfma_f32_32x32x16_bf16 v[112:127], v[72:75], a[216:219], v[112:127]
  ds_read_b128 v[72:75], v7 offset:57344
  v_cvt_pk_bf16_f32 v240, v240, v241
  v_exp_f32 v107, v107
  v_fma_f32 v108, v108, s20, v30
  v_fma_f32 v109, v109, s20, v30
  v_mfma_f32_32x32x16_bf16 v[112:127], v[76:79], a[220:223], v[112:127]
  ds_read_b128 v[76:79], v8 offset:57344
  v_cvt_pk_bf16_f32 v241, v242, v243
  v_cvt_pk_bf16_f32 v197, v106, v107
  v_exp_f32 v108, v108
  v_exp_f32 v109, v109
  v_fma_f32 v110, v110, s20, v30
  v_mfma_f32_32x32x16_bf16 v[128:143], a[128:131], v[192:195], v[128:143]
  ds_read_b128 v[48:51], v1 offset:57344
  v_cvt_pk_bf16_f32 v242, v244, v245
  v_cvt_pk_bf16_f32 v198, v108, v109
  v_exp_f32 v110, v110
  v_fma_f32 v111, v111, s20, v30
  v_mfma_f32_16x16x32_bf16 v[22:25], v[44:47], v[192:195], v[22:25]
  v_cvt_pk_bf16_f32 v243, v246, v247
  v_exp_f32 v111, v111
  v_mfma_f32_32x32x16_bf16 v[144:159], a[132:135], v[192:195], v[144:159]
  ds_read_b128 v[52:55], v2 offset:57344
  v_mul_f32 v248, v248, v40
  v_mul_f32 v249, v249, v40
  v_cvt_pk_bf16_f32 v199, v110, v111
  v_fma_f32 v112, v112, s20, v30
  v_fma_f32 v113, v113, s20, v30
  v_mfma_f32_32x32x16_bf16 v[128:143], a[144:147], v[196:199], v[128:143]
  ds_read_b128 v[64:67], v5 offset:57344
  ds_write_b128 v36, v[240:243]
  v_mul_f32 v250, v250, v40
  v_exp_f32 v112, v112
  v_exp_f32 v113, v113
  v_fma_f32 v114, v114, s20, v30
  v_mfma_f32_16x16x32_bf16 v[22:25], v[44:47], v[196:199], v[22:25]
  v_mul_f32 v251, v251, v40
  v_cvt_pk_bf16_f32 v200, v112, v113
  v_exp_f32 v114, v114
  v_mfma_f32_32x32x16_bf16 v[144:159], a[148:151], v[196:199], v[144:159]
  s_waitcnt lgkmcnt(2)
  ds_read_b128 v[68:71], v6 offset:57344
  v_mul_f32 v252, v252, v40
  v_fma_f32 v115, v115, s20, v30
  v_mul_f32 v253, v253, v40
  v_exp_f32 v115, v115
  v_mfma_f32_32x32x16_bf16 v[96:111], v[48:51], a[192:195], 0
  ds_read_b64_tr_b16 v[48:49], v17 offset:49152
  ds_read_b64_tr_b16 v[50:51], v17 offset:51200
  v_fma_f32 v116, v116, s20, v30
  v_fma_f32 v117, v117, s20, v30
  v_mul_f32 v254, v254, v40
  v_mul_f32 v255, v255, v40
  v_mfma_f32_32x32x16_bf16 v[96:111], v[52:55], a[196:199], v[96:111]
  ds_read_b64_tr_b16 v[52:53], v18 offset:49152
  ds_read_b64_tr_b16 v[54:55], v18 offset:51200
  v_cvt_pk_bf16_f32 v201, v114, v115
  v_exp_f32 v116, v116
  v_exp_f32 v117, v117
  v_fma_f32 v118, v118, s20, v30
  v_mfma_f32_32x32x16_bf16 v[96:111], v[56:59], a[200:203], v[96:111]
  ds_read_b128 v[56:59], v11
  v_cvt_pk_bf16_f32 v248, v248, v249
  v_cvt_pk_bf16_f32 v202, v116, v117
  v_exp_f32 v118, v118
  v_fma_f32 v119, v119, s20, v30
  v_mfma_f32_32x32x16_bf16 v[96:111], v[60:63], a[204:207], v[96:111]
  s_waitcnt lgkmcnt(5)
  ds_read_b128 v[60:63], v12
  v_cvt_pk_bf16_f32 v249, v250, v251
  v_exp_f32 v119, v119
  v_fma_f32 v120, v120, s20, v30
  v_fma_f32 v121, v121, s20, v30
  v_mfma_f32_32x32x16_bf16 v[96:111], v[64:67], a[208:211], v[96:111]
  ds_read_b64_tr_b16 v[64:65], v17 offset:53248
  ds_read_b64_tr_b16 v[66:67], v17 offset:55296
  v_cvt_pk_bf16_f32 v250, v252, v253
  v_cvt_pk_bf16_f32 v203, v118, v119
  v_exp_f32 v120, v120
  v_exp_f32 v121, v121
  v_fma_f32 v122, v122, s20, v30
  v_mfma_f32_32x32x16_bf16 v[96:111], v[68:71], a[212:215], v[96:111]
  ds_read_b64_tr_b16 v[68:69], v18 offset:53248
  ds_read_b64_tr_b16 v[70:71], v18 offset:55296
  v_cvt_pk_bf16_f32 v251, v254, v255
  v_cvt_pk_bf16_f32 v204, v120, v121
  v_exp_f32 v122, v122
  v_fma_f32 v123, v123, s20, v30
  v_mfma_f32_32x32x16_bf16 v[96:111], v[72:75], a[216:219], v[96:111]
  ds_read_b128 v[72:75], v15
  v_exp_f32 v123, v123
  v_fma_f32 v124, v124, s20, v30
  v_fma_f32 v125, v125, s20, v30
  v_fma_f32 v126, v126, s20, v30
  v_mfma_f32_32x32x16_bf16 v[96:111], v[76:79], a[220:223], v[96:111]
  s_waitcnt lgkmcnt(7)
  ds_read_b128 v[76:79], v16
  ds_write_b128 v37, v[248:251]
  v_cvt_pk_bf16_f32 v205, v122, v123
  v_exp_f32 v124, v124
  v_exp_f32 v125, v125
  v_mfma_f32_32x32x16_bf16 v[128:143], v[48:51], v[200:203], v[128:143]
  ds_read_b128 v[48:51], v9
  ds_read_b128 v[228:231], v38
  v_cvt_pk_bf16_f32 v206, v124, v125
  v_exp_f32 v126, v126
  v_fma_f32 v127, v127, s20, v30
  v_mfma_f32_16x16x32_bf16 v[22:25], v[44:47], v[200:203], v[22:25]
  v_exp_f32 v127, v127
  v_mfma_f32_32x32x16_bf16 v[144:159], v[52:55], v[200:203], v[144:159]
  s_waitcnt lgkmcnt(5)
  ds_read_b128 v[52:55], v10
  ds_read_b128 v[236:239], v39 offset:1024
  v_cvt_pk_bf16_f32 v207, v126, v127
  v_fma_f32 v96, v96, s20, v30
  v_fma_f32 v97, v97, s20, v30
  v_fma_f32 v98, v98, s20, v30
  v_mfma_f32_32x32x16_bf16 v[128:143], v[64:67], v[204:207], v[128:143]
  ds_read_b128 v[64:67], v13
  ds_read_b128 v[244:247], v38 offset:2048
  v_exp_f32 v96, v96
  v_exp_f32 v97, v97
  v_mfma_f32_16x16x32_bf16 v[22:25], v[44:47], v[204:207], v[22:25]
  ds_read_b128 v[252:255], v39 offset:3072
  v_cvt_pk_bf16_f32 v208, v96, v97
  v_exp_f32 v98, v98
  v_mfma_f32_32x32x16_bf16 v[144:159], v[68:71], v[204:207], v[144:159]
  s_waitcnt lgkmcnt(4)
  ds_read_b128 v[68:71], v14
  v_fma_f32 v99, v99, s20, v30
  v_exp_f32 v99, v99
  v_fma_f32 v100, v100, s20, v30
  v_fma_f32 v101, v101, s20, v30
  v_mfma_f32_32x32x16_bf16 v[112:127], v[48:51], a[192:195], 0
  ds_read_b64_tr_b16 v[48:49], v17 offset:57344
  ds_read_b64_tr_b16 v[50:51], v17 offset:59392
  v_cvt_pk_bf16_f32 v209, v98, v99
  v_exp_f32 v100, v100
  v_fma_f32 v102, v102, s20, v30
  v_mfma_f32_32x32x16_bf16 v[112:127], v[52:55], a[196:199], v[112:127]
  s_waitcnt lgkmcnt(6)
  ds_read_b64_tr_b16 v[52:53], v18 offset:57344
  ds_read_b64_tr_b16 v[54:55], v18 offset:59392
  buffer_store_dwordx4 v[228:231], v0, s[16:19], s40 offen sc1
  v_exp_f32 v101, v101
  v_fma_f32 v103, v103, s20, v30
  v_mfma_f32_32x32x16_bf16 v[112:127], v[56:59], a[200:203], v[112:127]
  ds_read_b128 v[56:59], v11 offset:8192
  buffer_store_dwordx4 v[236:239], v0, s[16:19], s40 offen offset:2048 sc1
  v_cvt_pk_bf16_f32 v210, v100, v101
  v_exp_f32 v102, v102
  v_fma_f32 v104, v104, s20, v30
  v_mfma_f32_32x32x16_bf16 v[112:127], v[60:63], a[204:207], v[112:127]
  s_waitcnt lgkmcnt(5)
  ds_read_b128 v[60:63], v12 offset:8192
  buffer_store_dwordx4 v[244:247], v0, s[16:19], s45 offen sc1
  v_exp_f32 v103, v103
  v_fma_f32 v105, v105, s20, v30
  v_fma_f32 v106, v106, s20, v30
  v_mfma_f32_32x32x16_bf16 v[112:127], v[64:67], a[208:211], v[112:127]
  ds_read_b64_tr_b16 v[64:65], v17 offset:61440
  ds_read_b64_tr_b16 v[66:67], v17 offset:63488
  buffer_store_dwordx4 v[252:255], v0, s[16:19], s45 offen offset:2048 sc1
  v_cvt_pk_bf16_f32 v211, v102, v103
  v_exp_f32 v104, v104
  v_exp_f32 v105, v105
  v_mfma_f32_32x32x16_bf16 v[112:127], v[68:71], a[212:215], v[112:127]
  ds_read_b64_tr_b16 v[68:69], v18 offset:61440
  ds_read_b64_tr_b16 v[70:71], v18 offset:63488
  v_cvt_pk_bf16_f32 v212, v104, v105
  v_exp_f32 v106, v106
  v_fma_f32 v107, v107, s20, v30
  v_mfma_f32_32x32x16_bf16 v[112:127], v[72:75], a[216:219], v[112:127]
  ds_read_b128 v[72:75], v15 offset:8192
  v_exp_f32 v107, v107
  v_fma_f32 v108, v108, s20, v30
  v_fma_f32 v109, v109, s20, v30
  v_fma_f32 v110, v110, s20, v30
  v_mfma_f32_32x32x16_bf16 v[112:127], v[76:79], a[220:223], v[112:127]
  s_waitcnt lgkmcnt(7)
  ds_read_b128 v[76:79], v16 offset:8192
  v_cvt_pk_bf16_f32 v213, v106, v107
  v_exp_f32 v108, v108
  v_exp_f32 v109, v109
  v_mfma_f32_32x32x16_bf16 v[128:143], v[48:51], v[208:211], v[128:143]
  ds_read_b128 v[48:51], v9 offset:8192
  v_cvt_pk_bf16_f32 v214, v108, v109
  v_exp_f32 v110, v110
  v_fma_f32 v111, v111, s20, v30
  v_mfma_f32_16x16x32_bf16 v[22:25], v[44:47], v[208:211], v[22:25]
  v_exp_f32 v111, v111
  v_mfma_f32_32x32x16_bf16 v[144:159], v[52:55], v[208:211], v[144:159]
  s_waitcnt lgkmcnt(3)
  ds_read_b128 v[52:55], v10 offset:8192
  v_cvt_pk_bf16_f32 v215, v110, v111
  v_fma_f32 v112, v112, s20, v30
  v_fma_f32 v113, v113, s20, v30
  v_exp_f32 v112, v112
  v_mfma_f32_32x32x16_bf16 v[128:143], v[64:67], v[212:215], v[128:143]
  ds_read_b128 v[64:67], v13 offset:8192
  v_exp_f32 v113, v113
  v_fma_f32 v114, v114, s20, v30
  v_exp_f32 v114, v114
  v_mfma_f32_16x16x32_bf16 v[22:25], v[44:47], v[212:215], v[22:25]
  v_cvt_pk_bf16_f32 v216, v112, v113
  v_fma_f32 v115, v115, s20, v30
  v_mfma_f32_32x32x16_bf16 v[144:159], v[68:71], v[212:215], v[144:159]
  s_waitcnt lgkmcnt(1)
  ds_read_b128 v[68:71], v14 offset:8192
  v_exp_f32 v115, v115
  v_fma_f32 v116, v116, s20, v30
  v_fma_f32 v117, v117, s20, v30
  v_fma_f32 v118, v118, s20, v30
  v_mfma_f32_32x32x16_bf16 v[96:111], v[48:51], a[192:195], 0
  ds_read_b64_tr_b16 v[48:49], v17
  ds_read_b64_tr_b16 v[50:51], v17 offset:2048
  v_cvt_pk_bf16_f32 v217, v114, v115
  v_exp_f32 v116, v116
  v_fma_f32 v119, v119, s20, v30
  v_mfma_f32_32x32x16_bf16 v[96:111], v[52:55], a[196:199], v[96:111]
  ds_read_b64_tr_b16 v[52:53], v18
  ds_read_b64_tr_b16 v[54:55], v18 offset:2048
  v_exp_f32 v117, v117
  v_exp_f32 v118, v118
  v_mfma_f32_32x32x16_bf16 v[96:111], v[56:59], a[200:203], v[96:111]
  ds_read_b128 v[56:59], v11 offset:16384
  v_cvt_pk_bf16_f32 v218, v116, v117
  v_exp_f32 v119, v119
  v_fma_f32 v120, v120, s20, v30
  v_fma_f32 v121, v121, s20, v30
  v_mfma_f32_32x32x16_bf16 v[96:111], v[60:63], a[204:207], v[96:111]
  s_waitcnt lgkmcnt(5)
  ds_read_b128 v[60:63], v12 offset:16384
  v_cvt_pk_bf16_f32 v219, v118, v119
  v_exp_f32 v120, v120
  v_exp_f32 v121, v121
  v_mfma_f32_32x32x16_bf16 v[96:111], v[64:67], a[208:211], v[96:111]
  ds_read_b64_tr_b16 v[64:65], v17 offset:4096
  ds_read_b64_tr_b16 v[66:67], v17 offset:6144
  v_fma_f32 v122, v122, s20, v30
  v_cvt_pk_bf16_f32 v220, v120, v121
  v_exp_f32 v122, v122
  v_mfma_f32_32x32x16_bf16 v[96:111], v[68:71], a[212:215], v[96:111]
  ds_read_b64_tr_b16 v[68:69], v18 offset:4096
  ds_read_b64_tr_b16 v[70:71], v18 offset:6144
  v_fma_f32 v123, v123, s20, v30
  v_exp_f32 v123, v123
  v_fma_f32 v124, v124, s20, v30
  v_mfma_f32_32x32x16_bf16 v[96:111], v[72:75], a[216:219], v[96:111]
  ds_read_b128 v[72:75], v15 offset:16384
  v_fma_f32 v125, v125, s20, v30
  v_cvt_pk_bf16_f32 v221, v122, v123
  v_exp_f32 v124, v124
  v_fma_f32 v126, v126, s20, v30
  v_mfma_f32_32x32x16_bf16 v[96:111], v[76:79], a[220:223], v[96:111]
  s_waitcnt lgkmcnt(7)
  ds_read_b128 v[76:79], v16 offset:16384
  v_exp_f32 v125, v125
  v_exp_f32 v126, v126
  v_fma_f32 v127, v127, s20, v30
  v_mfma_f32_32x32x16_bf16 v[128:143], v[48:51], v[216:219], v[128:143]
  ds_read_b128 v[48:51], v9 offset:16384
  v_cvt_pk_bf16_f32 v222, v124, v125
  v_exp_f32 v127, v127
  v_mfma_f32_16x16x32_bf16 v[22:25], v[44:47], v[216:219], v[22:25]
  v_cvt_pk_bf16_f32 v223, v126, v127
  v_mfma_f32_32x32x16_bf16 v[144:159], v[52:55], v[216:219], v[144:159]
  s_waitcnt lgkmcnt(3)
  ds_read_b128 v[52:55], v10 offset:16384
  v_fma_f32 v96, v96, s20, v30
  v_fma_f32 v97, v97, s20, v30
  v_exp_f32 v96, v96
  v_fma_f32 v98, v98, s20, v30
  v_mfma_f32_32x32x16_bf16 v[128:143], v[64:67], v[220:223], v[128:143]
  ds_read_b128 v[64:67], v13 offset:16384
  v_exp_f32 v97, v97
  v_exp_f32 v98, v98
  v_fma_f32 v99, v99, s20, v30
  v_mfma_f32_16x16x32_bf16 v[22:25], v[44:47], v[220:223], v[22:25]
  v_cvt_pk_bf16_f32 v224, v96, v97
  v_fma_f32 v100, v100, s20, v30
  v_mfma_f32_32x32x16_bf16 v[144:159], v[68:71], v[220:223], v[144:159]
  s_waitcnt lgkmcnt(1)
  ds_read_b128 v[68:71], v14 offset:16384
  v_exp_f32 v99, v99
  v_fma_f32 v101, v101, s20, v30
  v_exp_f32 v100, v100
  v_mfma_f32_32x32x16_bf16 v[112:127], v[48:51], a[192:195], 0
  ds_read_b64_tr_b16 v[48:49], v17 offset:8192
  ds_read_b64_tr_b16 v[50:51], v17 offset:10240
  v_cvt_pk_bf16_f32 v225, v98, v99
  v_exp_f32 v101, v101
  v_fma_f32 v102, v102, s20, v30
  v_mfma_f32_32x32x16_bf16 v[112:127], v[52:55], a[196:199], v[112:127]
  ds_read_b64_tr_b16 v[52:53], v18 offset:8192
  ds_read_b64_tr_b16 v[54:55], v18 offset:10240
  v_cvt_pk_bf16_f32 v226, v100, v101
  v_exp_f32 v102, v102
  v_fma_f32 v103, v103, s20, v30
  v_mfma_f32_32x32x16_bf16 v[112:127], v[56:59], a[200:203], v[112:127]
  ds_read_b128 v[56:59], v11 offset:24576
  v_exp_f32 v103, v103
  v_fma_f32 v104, v104, s20, v30
  v_fma_f32 v105, v105, s20, v30
  v_fma_f32 v106, v106, s20, v30
  v_mfma_f32_32x32x16_bf16 v[112:127], v[60:63], a[204:207], v[112:127]
  s_waitcnt lgkmcnt(5)
  ds_read_b128 v[60:63], v12 offset:24576
  v_cvt_pk_bf16_f32 v227, v102, v103
  v_exp_f32 v104, v104
  v_exp_f32 v105, v105
  v_mfma_f32_32x32x16_bf16 v[112:127], v[64:67], a[208:211], v[112:127]
  ds_read_b64_tr_b16 v[64:65], v17 offset:12288
  ds_read_b64_tr_b16 v[66:67], v17 offset:14336
  v_cvt_pk_bf16_f32 v228, v104, v105
  v_exp_f32 v106, v106
  v_fma_f32 v107, v107, s20, v30
  v_mfma_f32_32x32x16_bf16 v[112:127], v[68:71], a[212:215], v[112:127]
  ds_read_b64_tr_b16 v[68:69], v18 offset:12288
  ds_read_b64_tr_b16 v[70:71], v18 offset:14336
  v_exp_f32 v107, v107
  v_fma_f32 v108, v108, s20, v30
  v_fma_f32 v109, v109, s20, v30
  v_mfma_f32_32x32x16_bf16 v[112:127], v[72:75], a[216:219], v[112:127]
  ds_read_b128 v[72:75], v15 offset:24576
  v_cvt_pk_bf16_f32 v229, v106, v107
  v_exp_f32 v108, v108
  v_exp_f32 v109, v109
  v_mfma_f32_32x32x16_bf16 v[112:127], v[76:79], a[220:223], v[112:127]
  s_waitcnt lgkmcnt(7)
  ds_read_b128 v[76:79], v16 offset:24576
  v_fma_f32 v110, v110, s20, v30
  v_cvt_pk_bf16_f32 v230, v108, v109
  v_exp_f32 v110, v110
  v_fma_f32 v111, v111, s20, v30
  v_mfma_f32_32x32x16_bf16 v[128:143], v[48:51], v[224:227], v[128:143]
  ds_read_b128 v[48:51], v9 offset:24576
  v_exp_f32 v111, v111
  v_mfma_f32_16x16x32_bf16 v[22:25], v[44:47], v[224:227], v[22:25]
  v_cvt_pk_bf16_f32 v231, v110, v111
  v_mfma_f32_32x32x16_bf16 v[144:159], v[52:55], v[224:227], v[144:159]
  s_waitcnt lgkmcnt(3)
  ds_read_b128 v[52:55], v10 offset:24576
  v_fma_f32 v112, v112, s20, v30
  v_fma_f32 v113, v113, s20, v30
  v_exp_f32 v112, v112
  v_fma_f32 v114, v114, s20, v30
  v_mfma_f32_32x32x16_bf16 v[128:143], v[64:67], v[228:231], v[128:143]
  ds_read_b128 v[64:67], v13 offset:24576
  v_exp_f32 v113, v113
  v_exp_f32 v114, v114
  v_fma_f32 v115, v115, s20, v30
  v_mfma_f32_16x16x32_bf16 v[22:25], v[44:47], v[228:231], v[22:25]
  v_cvt_pk_bf16_f32 v232, v112, v113
  v_fma_f32 v116, v116, s20, v30
  v_mfma_f32_32x32x16_bf16 v[144:159], v[68:71], v[228:231], v[144:159]
  s_waitcnt lgkmcnt(1)
  ds_read_b128 v[68:71], v14 offset:24576
  v_exp_f32 v115, v115
  v_fma_f32 v117, v117, s20, v30
  v_exp_f32 v116, v116
  v_mfma_f32_32x32x16_bf16 v[96:111], v[48:51], a[192:195], 0
  ds_read_b64_tr_b16 v[48:49], v17 offset:16384
  ds_read_b64_tr_b16 v[50:51], v17 offset:18432
  v_cvt_pk_bf16_f32 v233, v114, v115
  v_exp_f32 v117, v117
  v_fma_f32 v118, v118, s20, v30
  v_mfma_f32_32x32x16_bf16 v[96:111], v[52:55], a[196:199], v[96:111]
  ds_read_b64_tr_b16 v[52:53], v18 offset:16384
  ds_read_b64_tr_b16 v[54:55], v18 offset:18432
  v_cvt_pk_bf16_f32 v234, v116, v117
  v_exp_f32 v118, v118
  v_fma_f32 v119, v119, s20, v30
  v_mfma_f32_32x32x16_bf16 v[96:111], v[56:59], a[200:203], v[96:111]
  ds_read_b128 v[56:59], v3 offset:40960
  v_exp_f32 v119, v119
  v_fma_f32 v120, v120, s20, v30
  v_fma_f32 v121, v121, s20, v30
  v_fma_f32 v122, v122, s20, v30
  v_mfma_f32_32x32x16_bf16 v[96:111], v[60:63], a[204:207], v[96:111]
  s_waitcnt lgkmcnt(5)
  ds_read_b128 v[60:63], v4 offset:40960
  v_cvt_pk_bf16_f32 v235, v118, v119
  v_exp_f32 v120, v120
  v_exp_f32 v121, v121
  v_mfma_f32_32x32x16_bf16 v[96:111], v[64:67], a[208:211], v[96:111]
  ds_read_b64_tr_b16 v[64:65], v17 offset:20480
  ds_read_b64_tr_b16 v[66:67], v17 offset:22528
  v_cvt_pk_bf16_f32 v236, v120, v121
  v_exp_f32 v122, v122
  v_fma_f32 v123, v123, s20, v30
  v_mfma_f32_32x32x16_bf16 v[96:111], v[68:71], a[212:215], v[96:111]
  ds_read_b64_tr_b16 v[68:69], v18 offset:20480
  ds_read_b64_tr_b16 v[70:71], v18 offset:22528
  v_exp_f32 v123, v123
  v_fma_f32 v124, v124, s20, v30
  v_fma_f32 v125, v125, s20, v30
  v_mfma_f32_32x32x16_bf16 v[96:111], v[72:75], a[216:219], v[96:111]
  ds_read_b128 v[72:75], v7 offset:40960
  v_cvt_pk_bf16_f32 v237, v122, v123
  v_exp_f32 v124, v124
  v_exp_f32 v125, v125
  v_mfma_f32_32x32x16_bf16 v[96:111], v[76:79], a[220:223], v[96:111]
  s_waitcnt lgkmcnt(7)
  ds_read_b128 v[76:79], v8 offset:40960
  v_fma_f32 v126, v126, s20, v30
  v_cvt_pk_bf16_f32 v238, v124, v125
  v_exp_f32 v126, v126
  v_fma_f32 v127, v127, s20, v30
  v_mfma_f32_32x32x16_bf16 v[128:143], v[48:51], v[232:235], v[128:143]
  ds_read_b128 v[48:51], v1 offset:40960
  v_exp_f32 v127, v127
  v_mfma_f32_16x16x32_bf16 v[22:25], v[44:47], v[232:235], v[22:25]
  v_cvt_pk_bf16_f32 v239, v126, v127
  v_mfma_f32_32x32x16_bf16 v[144:159], v[52:55], v[232:235], v[144:159]
  s_waitcnt lgkmcnt(3)
  ds_read_b128 v[52:55], v2 offset:40960
  v_fma_f32 v96, v96, s20, v30
  v_fma_f32 v97, v97, s20, v30
  v_exp_f32 v96, v96
  v_fma_f32 v98, v98, s20, v30
  v_mfma_f32_32x32x16_bf16 v[128:143], v[64:67], v[236:239], v[128:143]
  ds_read_b128 v[64:67], v5 offset:40960
  v_exp_f32 v97, v97
  v_exp_f32 v98, v98
  v_fma_f32 v99, v99, s20, v30
  v_mfma_f32_16x16x32_bf16 v[22:25], v[44:47], v[236:239], v[22:25]
  v_cvt_pk_bf16_f32 v240, v96, v97
  v_fma_f32 v100, v100, s20, v30
  v_mfma_f32_32x32x16_bf16 v[144:159], v[68:71], v[236:239], v[144:159]
  s_waitcnt lgkmcnt(1)
  ds_read_b128 v[68:71], v6 offset:40960
  v_exp_f32 v99, v99
  v_fma_f32 v101, v101, s20, v30
  v_exp_f32 v100, v100
  v_mfma_f32_32x32x16_bf16 v[112:127], v[48:51], a[192:195], 0
  ds_read_b64_tr_b16 v[48:49], v17 offset:24576
  ds_read_b64_tr_b16 v[50:51], v17 offset:26624
  v_cvt_pk_bf16_f32 v241, v98, v99
  v_exp_f32 v101, v101
  v_fma_f32 v102, v102, s20, v30
  v_mfma_f32_32x32x16_bf16 v[112:127], v[52:55], a[196:199], v[112:127]
  ds_read_b64_tr_b16 v[52:53], v18 offset:24576
  ds_read_b64_tr_b16 v[54:55], v18 offset:26624
  v_cvt_pk_bf16_f32 v242, v100, v101
  v_exp_f32 v102, v102
  v_fma_f32 v103, v103, s20, v30
  v_mfma_f32_32x32x16_bf16 v[112:127], v[56:59], a[200:203], v[112:127]
  ds_read_b64_tr_b16 v[56:57], v19 offset:49152
  ds_read_b64_tr_b16 v[58:59], v19 offset:51200
  v_exp_f32 v103, v103
  v_fma_f32 v104, v104, s20, v30
  v_fma_f32 v105, v105, s20, v30
  v_mfma_f32_32x32x16_bf16 v[112:127], v[60:63], a[204:207], v[112:127]
  s_waitcnt lgkmcnt(6)
  ds_read_b64_tr_b16 v[60:61], v19 offset:53248
  ds_read_b64_tr_b16 v[62:63], v19 offset:55296
  v_cvt_pk_bf16_f32 v243, v102, v103
  v_exp_f32 v104, v104
  v_fma_f32 v106, v106, s20, v30
  v_mfma_f32_32x32x16_bf16 v[112:127], v[64:67], a[208:211], v[112:127]
  ds_read_b64_tr_b16 v[64:65], v17 offset:28672
  ds_read_b64_tr_b16 v[66:67], v17 offset:30720
  v_exp_f32 v105, v105
  v_exp_f32 v106, v106
  v_mfma_f32_32x32x16_bf16 v[112:127], v[68:71], a[212:215], v[112:127]
  ds_read_b64_tr_b16 v[68:69], v18 offset:28672
  ds_read_b64_tr_b16 v[70:71], v18 offset:30720
  v_cvt_pk_bf16_f32 v244, v104, v105
  v_fma_f32 v107, v107, s20, v30
  v_exp_f32 v107, v107
  v_mfma_f32_32x32x16_bf16 v[112:127], v[72:75], a[216:219], v[112:127]
  ds_read_b64_tr_b16 v[72:73], v19 offset:57344
  ds_read_b64_tr_b16 v[74:75], v19 offset:59392
  v_fma_f32 v108, v108, s20, v30
  v_fma_f32 v109, v109, s20, v30
  v_cvt_pk_bf16_f32 v245, v106, v107
  v_fma_f32 v110, v110, s20, v30
  v_mfma_f32_32x32x16_bf16 v[112:127], v[76:79], a[220:223], v[112:127]
  s_waitcnt lgkmcnt(10)
  ds_read_b64_tr_b16 v[76:77], v19 offset:61440
  ds_read_b64_tr_b16 v[78:79], v19 offset:63488
  v_exp_f32 v108, v108
  v_exp_f32 v109, v109
  v_mfma_f32_32x32x16_bf16 v[128:143], v[48:51], v[240:243], v[128:143]
  v_cvt_pk_bf16_f32 v246, v108, v109
  v_exp_f32 v110, v110
  v_fma_f32 v111, v111, s20, v30
  v_exp_f32 v111, v111
  v_mfma_f32_16x16x32_bf16 v[22:25], v[44:47], v[240:243], v[22:25]
  v_cvt_pk_bf16_f32 v247, v110, v111
  v_mfma_f32_32x32x16_bf16 v[144:159], v[52:55], v[240:243], v[144:159]
  s_waitcnt lgkmcnt(4)
  v_fma_f32 v112, v112, s20, v30
  v_fma_f32 v113, v113, s20, v30
  v_exp_f32 v112, v112
  v_exp_f32 v113, v113
  v_mfma_f32_32x32x16_bf16 v[128:143], v[64:67], v[244:247], v[128:143]
  v_fma_f32 v114, v114, s20, v30
  v_fma_f32 v115, v115, s20, v30
  v_cvt_pk_bf16_f32 v248, v112, v113
  v_exp_f32 v114, v114
  v_add_f32 v26, v26, v112
  v_mfma_f32_16x16x32_bf16 v[22:25], v[44:47], v[244:247], v[22:25]
  v_exp_f32 v115, v115
  v_mfma_f32_32x32x16_bf16 v[144:159], v[68:71], v[244:247], v[144:159]
  v_add_f32 v27, v27, v113
  v_cvt_pk_bf16_f32 v249, v114, v115
  v_fma_f32 v116, v116, s20, v30
  v_fma_f32 v117, v117, s20, v30
  v_add_f32 v26, v26, v114
  v_add_f32 v27, v27, v115
  v_mfma_f32_32x32x16_bf16 v[160:175], v[56:59], v[200:203], v[160:175]
  v_exp_f32 v116, v116
  v_exp_f32 v117, v117
  v_fma_f32 v118, v118, s20, v30
  v_fma_f32 v119, v119, s20, v30
  v_mfma_f32_32x32x16_bf16 v[160:175], v[60:63], v[204:207], v[160:175]
  s_waitcnt lgkmcnt(2)
  v_cvt_pk_bf16_f32 v250, v116, v117
  v_exp_f32 v118, v118
  v_exp_f32 v119, v119
  v_fma_f32 v120, v120, s20, v30
  v_mfma_f32_32x32x16_bf16 v[160:175], v[72:75], v[208:211], v[160:175]
  v_add_f32 v26, v26, v116
  v_add_f32 v27, v27, v117
  v_cvt_pk_bf16_f32 v251, v118, v119
  v_exp_f32 v120, v120
  v_fma_f32 v121, v121, s20, v30
  v_fma_f32 v122, v122, s20, v30
  v_mfma_f32_32x32x16_bf16 v[128:143], a[160:163], v[248:251], v[128:143]
  v_add_f32 v26, v26, v118
  v_add_f32 v27, v27, v119
  v_exp_f32 v121, v121
  v_exp_f32 v122, v122
  v_fma_f32 v123, v123, s20, v30
  v_fma_f32 v124, v124, s20, v30
  v_mfma_f32_32x32x16_bf16 v[144:159], a[164:167], v[248:251], v[144:159]
  s_waitcnt lgkmcnt(0)
  v_add_f32 v26, v26, v120
  v_cvt_pk_bf16_f32 v252, v120, v121
  v_exp_f32 v123, v123
  v_exp_f32 v124, v124
  v_fma_f32 v125, v125, s20, v30
  v_fma_f32 v126, v126, s20, v30
  v_fma_f32 v127, v127, s20, v30
  v_mfma_f32_32x32x16_bf16 v[160:175], v[76:79], v[212:215], v[160:175]
  v_add_f32 v27, v27, v121
  v_add_f32 v26, v26, v122
  v_cvt_pk_bf16_f32 v253, v122, v123
  v_exp_f32 v125, v125
  v_exp_f32 v126, v126
  v_exp_f32 v127, v127
  v_mfma_f32_32x32x16_bf16 v[160:175], a[72:75], v[80:83], v[160:175]
  v_add_f32 v27, v27, v123
  v_add_f32 v26, v26, v124
  v_cvt_pk_bf16_f32 v254, v124, v125
  v_cvt_pk_bf16_f32 v255, v126, v127
  v_add_f32 v27, v27, v125
  v_add_f32 v26, v26, v126
  v_mfma_f32_32x32x16_bf16 v[128:143], a[176:179], v[252:255], v[128:143]
  ds_read_b64_tr_b16 v[48:49], v19
  ds_read_b64_tr_b16 v[50:51], v19 offset:2048
  v_add_f32 v27, v27, v127
  v_add_f32 v40, v26, v27
  v_add_f32 v41, v26, v27
  v_mfma_f32_32x32x16_bf16 v[144:159], a[180:183], v[252:255], v[144:159]
  s_nop 0
  v_permlane32_swap_b32 v40, v41
  v_add_f32 v40, v40, v41
  v_add_f32 v40, v40, v22
  v_cmp_nge_f32 vcc, 0x47800000, v40
  v_rcp_f32 v40, v40
  v_mfma_f32_32x32x16_bf16 v[160:175], a[88:91], v[84:87], v[160:175]
  s_cbranch_vccz L_OK2
  s_call_b64 s[32:33], L_SLOW2
L_OK2:
  v_mul_f32 v128, v128, v40
  v_mul_f32 v129, v129, v40
  v_mul_f32 v130, v130, v40
  v_mul_f32 v131, v131, v40
  v_mul_f32 v132, v132, v40
  v_mfma_f32_32x32x16_bf16 v[176:191], a[76:79], v[80:83], v[176:191]
  v_mul_f32 v133, v133, v40
  v_mul_f32 v134, v134, v40
  v_mul_f32 v135, v135, v40
  v_cvt_pk_bf16_f32 v128, v128, v129
  v_cvt_pk_bf16_f32 v129, v130, v131
  v_cvt_pk_bf16_f32 v130, v132, v133
  v_mfma_f32_32x32x16_bf16 v[176:191], a[92:95], v[84:87], v[176:191]
  v_cvt_pk_bf16_f32 v131, v134, v135
  v_mul_f32 v136, v136, v40
  v_mul_f32 v137, v137, v40
  v_mul_f32 v138, v138, v40
  v_mul_f32 v139, v139, v40
  v_mul_f32 v140, v140, v40
  v_mfma_f32_32x32x16_bf16 v[160:175], a[104:107], v[88:91], v[160:175]
  ds_write_b128 v34, v[128:131]
  v_mul_f32 v141, v141, v40
  v_mul_f32 v142, v142, v40
  v_mul_f32 v143, v143, v40
  v_cvt_pk_bf16_f32 v136, v136, v137
  v_mfma_f32_32x32x16_bf16 v[160:175], a[120:123], v[92:95], v[160:175]
  v_cvt_pk_bf16_f32 v137, v138, v139
  v_cvt_pk_bf16_f32 v138, v140, v141
  v_cvt_pk_bf16_f32 v139, v142, v143
  v_mul_f32 v144, v144, v40
  v_mul_f32 v145, v145, v40
  v_mul_f32 v146, v146, v40
  v_mfma_f32_32x32x16_bf16 v[176:191], a[108:111], v[88:91], v[176:191]
  ds_write_b128 v35, v[136:139]
  v_mul_f32 v147, v147, v40
  v_mul_f32 v148, v148, v40
  v_mul_f32 v149, v149, v40
  v_mul_f32 v150, v150, v40
  v_mfma_f32_32x32x16_bf16 v[176:191], a[124:127], v[92:95], v[176:191]
  v_mul_f32 v151, v151, v40
  v_cvt_pk_bf16_f32 v144, v144, v145
  v_cvt_pk_bf16_f32 v145, v146, v147
  v_cvt_pk_bf16_f32 v146, v148, v149
  v_cvt_pk_bf16_f32 v147, v150, v151
  v_mul_f32 v152, v152, v40
  v_mfma_f32_32x32x16_bf16 v[160:175], a[136:139], v[192:195], v[160:175]
  v_mul_f32 v153, v153, v40
  v_mul_f32 v154, v154, v40
  v_mul_f32 v155, v155, v40
  v_mul_f32 v156, v156, v40
  v_mul_f32 v157, v157, v40
  v_mul_f32 v158, v158, v40
  v_mfma_f32_32x32x16_bf16 v[160:175], a[152:155], v[196:199], v[160:175]
  ds_write_b128 v36, v[144:147]
  v_mul_f32 v159, v159, v40
  v_cvt_pk_bf16_f32 v152, v152, v153
  v_cvt_pk_bf16_f32 v153, v154, v155
  v_cvt_pk_bf16_f32 v154, v156, v157
  v_mfma_f32_32x32x16_bf16 v[176:191], a[140:143], v[192:195], v[176:191]
  ds_read_b64_tr_b16 v[52:53], v19 offset:4096
  ds_read_b64_tr_b16 v[54:55], v19 offset:6144
  v_cvt_pk_bf16_f32 v155, v158, v159
  v_mfma_f32_32x32x16_bf16 v[176:191], a[156:159], v[196:199], v[176:191]
  ds_write_b128 v37, v[152:155]
  ds_read_b64_tr_b16 v[64:65], v19 offset:8192
  ds_read_b64_tr_b16 v[66:67], v19 offset:10240
  v_mfma_f32_32x32x16_bf16 v[160:175], a[168:171], v[248:251], v[160:175]
  ds_read_b128 v[132:135], v38
  ds_read_b128 v[140:143], v39 offset:1024
  v_mfma_f32_32x32x16_bf16 v[160:175], a[184:187], v[252:255], v[160:175]
  ds_read_b64_tr_b16 v[68:69], v19 offset:12288
  ds_read_b64_tr_b16 v[70:71], v19 offset:14336
  v_mfma_f32_32x32x16_bf16 v[176:191], a[172:175], v[248:251], v[176:191]
  ds_read_b128 v[148:151], v38 offset:2048
  ds_read_b128 v[156:159], v39 offset:3072
  v_mfma_f32_32x32x16_bf16 v[176:191], a[188:191], v[252:255], v[176:191]
  s_waitcnt lgkmcnt(14)
  ds_read_b64_tr_b16 v[56:57], v19 offset:16384
  ds_read_b64_tr_b16 v[58:59], v19 offset:18432
  v_mfma_f32_32x32x16_bf16 v[160:175], v[48:51], v[216:219], v[160:175]
  s_waitcnt lgkmcnt(11)
  ds_read_b64_tr_b16 v[60:61], v19 offset:20480
  ds_read_b64_tr_b16 v[62:63], v19 offset:22528
  v_mfma_f32_32x32x16_bf16 v[160:175], v[52:55], v[220:223], v[160:175]
  s_waitcnt lgkmcnt(8)
  buffer_store_dwordx4 v[132:135], v21, s[16:19], s41 offen sc1
  buffer_store_dwordx4 v[140:143], v21, s[16:19], s41 offen offset:2048 sc1
  v_mfma_f32_32x32x16_bf16 v[160:175], v[64:67], v[224:227], v[160:175]
  s_waitcnt lgkmcnt(6)
  ds_read_b64_tr_b16 v[72:73], v19 offset:24576
  ds_read_b64_tr_b16 v[74:75], v19 offset:26624
  v_mfma_f32_32x32x16_bf16 v[160:175], v[68:71], v[228:231], v[160:175]
  s_waitcnt lgkmcnt(4)
  buffer_store_dwordx4 v[148:151], v21, s[16:19], s46 offen sc1
  buffer_store_dwordx4 v[156:159], v21, s[16:19], s46 offen offset:2048 sc1
  v_mfma_f32_32x32x16_bf16 v[160:175], v[56:59], v[232:235], v[160:175]
  s_waitcnt lgkmcnt(2)
  ds_read_b64_tr_b16 v[76:77], v19 offset:28672
  ds_read_b64_tr_b16 v[78:79], v19 offset:30720
  v_mfma_f32_32x32x16_bf16 v[160:175], v[60:63], v[236:239], v[160:175]
  s_waitcnt lgkmcnt(2)
  ds_read_b64_tr_b16 v[48:49], v20 offset:49152
  ds_read_b64_tr_b16 v[50:51], v20 offset:51200
  v_mfma_f32_32x32x16_bf16 v[160:175], v[72:75], v[240:243], v[160:175]
  s_waitcnt lgkmcnt(2)
  ds_read_b64_tr_b16 v[52:53], v20 offset:53248
  ds_read_b64_tr_b16 v[54:55], v20 offset:55296
  v_mfma_f32_32x32x16_bf16 v[160:175], v[76:79], v[244:247], v[160:175]
  s_waitcnt lgkmcnt(2)
  ds_read_b64_tr_b16 v[64:65], v20 offset:57344
  ds_read_b64_tr_b16 v[66:67], v20 offset:59392
  v_mfma_f32_32x32x16_bf16 v[176:191], v[48:51], v[200:203], v[176:191]
  s_waitcnt lgkmcnt(2)
  ds_read_b64_tr_b16 v[68:69], v20 offset:61440
  ds_read_b64_tr_b16 v[70:71], v20 offset:63488
  v_mfma_f32_32x32x16_bf16 v[176:191], v[52:55], v[204:207], v[176:191]
  s_waitcnt lgkmcnt(2)
  ds_read_b64_tr_b16 v[56:57], v20
  ds_read_b64_tr_b16 v[58:59], v20 offset:2048
  s_nop 0
  v_mul_f32 v160, v160, v40
  v_mul_f32 v161, v161, v40
  v_mul_f32 v162, v162, v40
  v_mul_f32 v163, v163, v40
  v_mul_f32 v164, v164, v40
  v_mul_f32 v165, v165, v40
  v_mfma_f32_32x32x16_bf16 v[176:191], v[64:67], v[208:211], v[176:191]
  s_waitcnt lgkmcnt(2)
  ds_read_b64_tr_b16 v[60:61], v20 offset:4096
  ds_read_b64_tr_b16 v[62:63], v20 offset:6144
  v_mul_f32 v166, v166, v40
  v_mul_f32 v167, v167, v40
  v_cvt_pk_bf16_f32 v160, v160, v161
  v_cvt_pk_bf16_f32 v161, v162, v163
  v_cvt_pk_bf16_f32 v162, v164, v165
  v_cvt_pk_bf16_f32 v163, v166, v167
  v_mfma_f32_32x32x16_bf16 v[176:191], v[68:71], v[212:215], v[176:191]
  s_waitcnt lgkmcnt(2)
  ds_read_b64_tr_b16 v[72:73], v20 offset:8192
  ds_read_b64_tr_b16 v[74:75], v20 offset:10240
  v_mul_f32 v168, v168, v40
  v_mul_f32 v169, v169, v40
  v_mul_f32 v170, v170, v40
  v_mul_f32 v171, v171, v40
  v_mul_f32 v172, v172, v40
  v_mul_f32 v173, v173, v40
  v_mfma_f32_32x32x16_bf16 v[176:191], v[56:59], v[216:219], v[176:191]
  s_waitcnt lgkmcnt(2)
  ds_read_b64_tr_b16 v[76:77], v20 offset:12288
  ds_read_b64_tr_b16 v[78:79], v20 offset:14336
  ds_write_b128 v34, v[160:163]
  v_mul_f32 v174, v174, v40
  v_mul_f32 v175, v175, v40
  v_cvt_pk_bf16_f32 v168, v168, v169
  v_cvt_pk_bf16_f32 v169, v170, v171
  v_cvt_pk_bf16_f32 v170, v172, v173
  v_cvt_pk_bf16_f32 v171, v174, v175
  v_mfma_f32_32x32x16_bf16 v[176:191], v[60:63], v[220:223], v[176:191]
  s_waitcnt lgkmcnt(3)
  ds_read_b64_tr_b16 v[48:49], v20 offset:16384
  ds_read_b64_tr_b16 v[50:51], v20 offset:18432
  v_mfma_f32_32x32x16_bf16 v[176:191], v[72:75], v[224:227], v[176:191]
  s_waitcnt lgkmcnt(3)
  ds_read_b64_tr_b16 v[52:53], v20 offset:20480
  ds_read_b64_tr_b16 v[54:55], v20 offset:22528
  ds_write_b128 v35, v[168:171]
  v_mfma_f32_32x32x16_bf16 v[176:191], v[76:79], v[228:231], v[176:191]
  s_waitcnt lgkmcnt(3)
  ds_read_b64_tr_b16 v[64:65], v20 offset:24576
  ds_read_b64_tr_b16 v[66:67], v20 offset:26624
  v_mfma_f32_32x32x16_bf16 v[176:191], v[48:51], v[232:235], v[176:191]
  s_waitcnt lgkmcnt(3)
  ds_read_b64_tr_b16 v[68:69], v20 offset:28672
  ds_read_b64_tr_b16 v[70:71], v20 offset:30720
  v_mfma_f32_32x32x16_bf16 v[176:191], v[52:55], v[236:239], v[176:191]
  s_waitcnt lgkmcnt(2)
  v_mfma_f32_32x32x16_bf16 v[176:191], v[64:67], v[240:243], v[176:191]
  s_waitcnt lgkmcnt(0)
  v_mfma_f32_32x32x16_bf16 v[176:191], v[68:71], v[244:247], v[176:191]
  s_nop 11
  v_pk_mul_f32 v[176:177], v[176:177], v[40:41] op_sel_hi:[1,0]
  v_pk_mul_f32 v[178:179], v[178:179], v[40:41] op_sel_hi:[1,0]
  v_pk_mul_f32 v[180:181], v[180:181], v[40:41] op_sel_hi:[1,0]
  v_pk_mul_f32 v[182:183], v[182:183], v[40:41] op_sel_hi:[1,0]
  v_cvt_pk_bf16_f32 v176, v176, v177
  v_cvt_pk_bf16_f32 v177, v178, v179
  v_cvt_pk_bf16_f32 v178, v180, v181
  v_cvt_pk_bf16_f32 v179, v182, v183
  ds_write_b128 v36, v[176:179]
  v_pk_mul_f32 v[184:185], v[184:185], v[40:41] op_sel_hi:[1,0]
  v_pk_mul_f32 v[186:187], v[186:187], v[40:41] op_sel_hi:[1,0]
  v_pk_mul_f32 v[188:189], v[188:189], v[40:41] op_sel_hi:[1,0]
  v_pk_mul_f32 v[190:191], v[190:191], v[40:41] op_sel_hi:[1,0]
  v_cvt_pk_bf16_f32 v184, v184, v185
  v_cvt_pk_bf16_f32 v185, v186, v187
  v_cvt_pk_bf16_f32 v186, v188, v189
  v_cvt_pk_bf16_f32 v187, v190, v191
  ds_write_b128 v37, v[184:187]
  ds_read_b128 v[164:167], v38
  ds_read_b128 v[172:175], v39 offset:1024
  ds_read_b128 v[180:183], v38 offset:2048
  ds_read_b128 v[188:191], v39 offset:3072
  s_waitcnt lgkmcnt(3)
  buffer_store_dwordx4 v[164:167], v0, s[16:19], s41 offen sc1
  s_waitcnt lgkmcnt(2)
  buffer_store_dwordx4 v[172:175], v0, s[16:19], s41 offen offset:2048 sc1
  s_waitcnt lgkmcnt(1)
  buffer_store_dwordx4 v[180:183], v0, s[16:19], s46 offen sc1
  s_waitcnt lgkmcnt(0)
  buffer_store_dwordx4 v[188:191], v0, s[16:19], s46 offen offset:2048 sc1
L_END:
  s_endpgm
L_SLOW0:
  s_waitcnt lgkmcnt(0)
  s_nop 7
  s_nop 7
  s_load_dwordx2 s[52:53], s[0:1], 40
  v_mbcnt_lo_u32_b32 v41, -1, 0
  v_mbcnt_hi_u32_b32 v41, -1, v41
  v_lshlrev_b32 v41, 4, v41
  s_lshl_b32 s34, s2, 2
  s_add_u32 s34, s34, s22
  s_mul_i32 s34, s34, 0x3000
  s_mov_b32 s54, 0x3000
  s_mov_b32 s55, 0x20000
  s_mov_b32 s35, 0x2000
  s_waitcnt lgkmcnt(0)
  s_add_u32 s52, s52, s34
  s_addc_u32 s53, s53, 0
  s_nop 3
  buffer_store_dwordx4 v[80:83], v41, s[52:55], 0 offen
  buffer_store_dwordx4 v[84:87], v41, s[52:55], 0 offen offset:1024
  buffer_store_dwordx4 v[88:91], v41, s[52:55], 0 offen offset:2048
  buffer_store_dwordx4 v[92:95], v41, s[52:55], 0 offen offset:3072
  buffer_store_dwordx4 v[96:99], v41, s[52:55], s44 offen
  buffer_store_dwordx4 v[100:103], v41, s[52:55], s44 offen offset:1024
  buffer_store_dwordx4 v[104:107], v41, s[52:55], s44 offen offset:2048
  buffer_store_dwordx4 v[108:111], v41, s[52:55], s44 offen offset:3072
  buffer_store_dwordx4 v[112:115], v41, s[52:55], s35 offen
  buffer_store_dwordx4 v[116:119], v41, s[52:55], s35 offen offset:1024
  buffer_store_dwordx4 v[120:123], v41, s[52:55], s35 offen offset:2048
  buffer_store_dwordx4 v[124:127], v41, s[52:55], s35 offen offset:3072
  s_waitcnt vmcnt(0)
  ds_read_b128 v[112:115], v1
  ds_read_b128 v[116:119], v2
  ds_read_b128 v[120:123], v3
  ds_read_b128 v[124:127], v4
  s_waitcnt lgkmcnt(3)
  v_mfma_f32_32x32x16_bf16 v[96:111], v[112:115], a[192:195], 0
  s_waitcnt lgkmcnt(2)
  v_mfma_f32_32x32x16_bf16 v[96:111], v[116:119], a[196:199], v[96:111]
  s_waitcnt lgkmcnt(1)
  v_mfma_f32_32x32x16_bf16 v[96:111], v[120:123], a[200:203], v[96:111]
  s_waitcnt lgkmcnt(0)
  v_mfma_f32_32x32x16_bf16 v[96:111], v[124:127], a[204:207], v[96:111]
  s_nop 7
  ds_read_b128 v[112:115], v5
  ds_read_b128 v[116:119], v6
  ds_read_b128 v[120:123], v7
  ds_read_b128 v[124:127], v8
  s_waitcnt lgkmcnt(3)
  v_mfma_f32_32x32x16_bf16 v[96:111], v[112:115], a[208:211], v[96:111]
  s_waitcnt lgkmcnt(2)
  v_mfma_f32_32x32x16_bf16 v[96:111], v[116:119], a[212:215], v[96:111]
  s_waitcnt lgkmcnt(1)
  v_mfma_f32_32x32x16_bf16 v[96:111], v[120:123], a[216:219], v[96:111]
  s_waitcnt lgkmcnt(0)
  v_mfma_f32_32x32x16_bf16 v[96:111], v[124:127], a[220:223], v[96:111]
  s_nop 7
  s_nop 3
  v_max_f32 v80, v96, v97
  v_max3_f32 v80, v80, v98, v99
  v_max3_f32 v80, v80, v100, v101
  v_max3_f32 v80, v80, v102, v103
  v_max3_f32 v80, v80, v104, v105
  v_max3_f32 v80, v80, v106, v107
  v_max3_f32 v80, v80, v108, v109
  v_max3_f32 v80, v80, v110, v111
  ds_read_b128 v[112:115], v1 offset:8192
  ds_read_b128 v[116:119], v2 offset:8192
  ds_read_b128 v[120:123], v3 offset:8192
  ds_read_b128 v[124:127], v4 offset:8192
  s_waitcnt lgkmcnt(3)
  v_mfma_f32_32x32x16_bf16 v[96:111], v[112:115], a[192:195], 0
  s_waitcnt lgkmcnt(2)
  v_mfma_f32_32x32x16_bf16 v[96:111], v[116:119], a[196:199], v[96:111]
  s_waitcnt lgkmcnt(1)
  v_mfma_f32_32x32x16_bf16 v[96:111], v[120:123], a[200:203], v[96:111]
  s_waitcnt lgkmcnt(0)
  v_mfma_f32_32x32x16_bf16 v[96:111], v[124:127], a[204:207], v[96:111]
  s_nop 7
  ds_read_b128 v[112:115], v5 offset:8192
  ds_read_b128 v[116:119], v6 offset:8192
  ds_read_b128 v[120:123], v7 offset:8192
  ds_read_b128 v[124:127], v8 offset:8192
  s_waitcnt lgkmcnt(3)
  v_mfma_f32_32x32x16_bf16 v[96:111], v[112:115], a[208:211], v[96:111]
  s_waitcnt lgkmcnt(2)
  v_mfma_f32_32x32x16_bf16 v[96:111], v[116:119], a[212:215], v[96:111]
  s_waitcnt lgkmcnt(1)
  v_mfma_f32_32x32x16_bf16 v[96:111], v[120:123], a[216:219], v[96:111]
  s_waitcnt lgkmcnt(0)
  v_mfma_f32_32x32x16_bf16 v[96:111], v[124:127], a[220:223], v[96:111]
  s_nop 7
  s_nop 3
  v_max3_f32 v80, v80, v96, v97
  v_max3_f32 v80, v80, v98, v99
  v_max3_f32 v80, v80, v100, v101
  v_max3_f32 v80, v80, v102, v103
  v_max3_f32 v80, v80, v104, v105
  v_max3_f32 v80, v80, v106, v107
  v_max3_f32 v80, v80, v108, v109
  v_max3_f32 v80, v80, v110, v111
  ds_read_b128 v[112:115], v1 offset:16384
  ds_read_b128 v[116:119], v2 offset:16384
  ds_read_b128 v[120:123], v3 offset:16384
  ds_read_b128 v[124:127], v4 offset:16384
  s_waitcnt lgkmcnt(3)
  v_mfma_f32_32x32x16_bf16 v[96:111], v[112:115], a[192:195], 0
  s_waitcnt lgkmcnt(2)
  v_mfma_f32_32x32x16_bf16 v[96:111], v[116:119], a[196:199], v[96:111]
  s_waitcnt lgkmcnt(1)
  v_mfma_f32_32x32x16_bf16 v[96:111], v[120:123], a[200:203], v[96:111]
  s_waitcnt lgkmcnt(0)
  v_mfma_f32_32x32x16_bf16 v[96:111], v[124:127], a[204:207], v[96:111]
  s_nop 7
  ds_read_b128 v[112:115], v5 offset:16384
  ds_read_b128 v[116:119], v6 offset:16384
  ds_read_b128 v[120:123], v7 offset:16384
  ds_read_b128 v[124:127], v8 offset:16384
  s_waitcnt lgkmcnt(3)
  v_mfma_f32_32x32x16_bf16 v[96:111], v[112:115], a[208:211], v[96:111]
  s_waitcnt lgkmcnt(2)
  v_mfma_f32_32x32x16_bf16 v[96:111], v[116:119], a[212:215], v[96:111]
  s_waitcnt lgkmcnt(1)
  v_mfma_f32_32x32x16_bf16 v[96:111], v[120:123], a[216:219], v[96:111]
  s_waitcnt lgkmcnt(0)
  v_mfma_f32_32x32x16_bf16 v[96:111], v[124:127], a[220:223], v[96:111]
  s_nop 7
  s_nop 3
  v_max3_f32 v80, v80, v96, v97
  v_max3_f32 v80, v80, v98, v99
  v_max3_f32 v80, v80, v100, v101
  v_max3_f32 v80, v80, v102, v103
  v_max3_f32 v80, v80, v104, v105
  v_max3_f32 v80, v80, v106, v107
  v_max3_f32 v80, v80, v108, v109
  v_max3_f32 v80, v80, v110, v111
  ds_read_b128 v[112:115], v1 offset:24576
  ds_read_b128 v[116:119], v2 offset:24576
  ds_read_b128 v[120:123], v3 offset:24576
  ds_read_b128 v[124:127], v4 offset:24576
  s_waitcnt lgkmcnt(3)
  v_mfma_f32_32x32x16_bf16 v[96:111], v[112:115], a[192:195], 0
  s_waitcnt lgkmcnt(2)
  v_mfma_f32_32x32x16_bf16 v[96:111], v[116:119], a[196:199], v[96:111]
  s_waitcnt lgkmcnt(1)
  v_mfma_f32_32x32x16_bf16 v[96:111], v[120:123], a[200:203], v[96:111]
  s_waitcnt lgkmcnt(0)
  v_mfma_f32_32x32x16_bf16 v[96:111], v[124:127], a[204:207], v[96:111]
  s_nop 7
  ds_read_b128 v[112:115], v5 offset:24576
  ds_read_b128 v[116:119], v6 offset:24576
  ds_read_b128 v[120:123], v7 offset:24576
  ds_read_b128 v[124:127], v8 offset:24576
  s_waitcnt lgkmcnt(3)
  v_mfma_f32_32x32x16_bf16 v[96:111], v[112:115], a[208:211], v[96:111]
  s_waitcnt lgkmcnt(2)
  v_mfma_f32_32x32x16_bf16 v[96:111], v[116:119], a[212:215], v[96:111]
  s_waitcnt lgkmcnt(1)
  v_mfma_f32_32x32x16_bf16 v[96:111], v[120:123], a[216:219], v[96:111]
  s_waitcnt lgkmcnt(0)
  v_mfma_f32_32x32x16_bf16 v[96:111], v[124:127], a[220:223], v[96:111]
  s_nop 7
  s_nop 3
  v_max3_f32 v80, v80, v96, v97
  v_max3_f32 v80, v80, v98, v99
  v_max3_f32 v80, v80, v100, v101
  v_max3_f32 v80, v80, v102, v103
  v_max3_f32 v80, v80, v104, v105
  v_max3_f32 v80, v80, v106, v107
  v_max3_f32 v80, v80, v108, v109
  v_max3_f32 v80, v80, v110, v111
  ds_read_b128 v[112:115], v1 offset:32768
  ds_read_b128 v[116:119], v2 offset:32768
  ds_read_b128 v[120:123], v3 offset:32768
  ds_read_b128 v[124:127], v4 offset:32768
  s_waitcnt lgkmcnt(3)
  v_mfma_f32_32x32x16_bf16 v[96:111], v[112:115], a[192:195], 0
  s_waitcnt lgkmcnt(2)
  v_mfma_f32_32x32x16_bf16 v[96:111], v[116:119], a[196:199], v[96:111]
  s_waitcnt lgkmcnt(1)
  v_mfma_f32_32x32x16_bf16 v[96:111], v[120:123], a[200:203], v[96:111]
  s_waitcnt lgkmcnt(0)
  v_mfma_f32_32x32x16_bf16 v[96:111], v[124:127], a[204:207], v[96:111]
  s_nop 7
  ds_read_b128 v[112:115], v5 offset:32768
  ds_read_b128 v[116:119], v6 offset:32768
  ds_read_b128 v[120:123], v7 offset:32768
  ds_read_b128 v[124:127], v8 offset:32768
  s_waitcnt lgkmcnt(3)
  v_mfma_f32_32x32x16_bf16 v[96:111], v[112:115], a[208:211], v[96:111]
  s_waitcnt lgkmcnt(2)
  v_mfma_f32_32x32x16_bf16 v[96:111], v[116:119], a[212:215], v[96:111]
  s_waitcnt lgkmcnt(1)
  v_mfma_f32_32x32x16_bf16 v[96:111], v[120:123], a[216:219], v[96:111]
  s_waitcnt lgkmcnt(0)
  v_mfma_f32_32x32x16_bf16 v[96:111], v[124:127], a[220:223], v[96:111]
  s_nop 7
  s_nop 3
  v_max3_f32 v80, v80, v96, v97
  v_max3_f32 v80, v80, v98, v99
  v_max3_f32 v80, v80, v100, v101
  v_max3_f32 v80, v80, v102, v103
  v_max3_f32 v80, v80, v104, v105
  v_max3_f32 v80, v80, v106, v107
  v_max3_f32 v80, v80, v108, v109
  v_max3_f32 v80, v80, v110, v111
  ds_read_b128 v[112:115], v1 offset:40960
  ds_read_b128 v[116:119], v2 offset:40960
  ds_read_b128 v[120:123], v3 offset:40960
  ds_read_b128 v[124:127], v4 offset:40960
  s_waitcnt lgkmcnt(3)
  v_mfma_f32_32x32x16_bf16 v[96:111], v[112:115], a[192:195], 0
  s_waitcnt lgkmcnt(2)
  v_mfma_f32_32x32x16_bf16 v[96:111], v[116:119], a[196:199], v[96:111]
  s_waitcnt lgkmcnt(1)
  v_mfma_f32_32x32x16_bf16 v[96:111], v[120:123], a[200:203], v[96:111]
  s_waitcnt lgkmcnt(0)
  v_mfma_f32_32x32x16_bf16 v[96:111], v[124:127], a[204:207], v[96:111]
  s_nop 7
  ds_read_b128 v[112:115], v5 offset:40960
  ds_read_b128 v[116:119], v6 offset:40960
  ds_read_b128 v[120:123], v7 offset:40960
  ds_read_b128 v[124:127], v8 offset:40960
  s_waitcnt lgkmcnt(3)
  v_mfma_f32_32x32x16_bf16 v[96:111], v[112:115], a[208:211], v[96:111]
  s_waitcnt lgkmcnt(2)
  v_mfma_f32_32x32x16_bf16 v[96:111], v[116:119], a[212:215], v[96:111]
  s_waitcnt lgkmcnt(1)
  v_mfma_f32_32x32x16_bf16 v[96:111], v[120:123], a[216:219], v[96:111]
  s_waitcnt lgkmcnt(0)
  v_mfma_f32_32x32x16_bf16 v[96:111], v[124:127], a[220:223], v[96:111]
  s_nop 7
  s_nop 3
  v_max3_f32 v80, v80, v96, v97
  v_max3_f32 v80, v80, v98, v99
  v_max3_f32 v80, v80, v100, v101
  v_max3_f32 v80, v80, v102, v103
  v_max3_f32 v80, v80, v104, v105
  v_max3_f32 v80, v80, v106, v107
  v_max3_f32 v80, v80, v108, v109
  v_max3_f32 v80, v80, v110, v111
  ds_read_b128 v[112:115], v1 offset:49152
  ds_read_b128 v[116:119], v2 offset:49152
  ds_read_b128 v[120:123], v3 offset:49152
  ds_read_b128 v[124:127], v4 offset:49152
  s_waitcnt lgkmcnt(3)
  v_mfma_f32_32x32x16_bf16 v[96:111], v[112:115], a[192:195], 0
  s_waitcnt lgkmcnt(2)
  v_mfma_f32_32x32x16_bf16 v[96:111], v[116:119], a[196:199], v[96:111]
  s_waitcnt lgkmcnt(1)
  v_mfma_f32_32x32x16_bf16 v[96:111], v[120:123], a[200:203], v[96:111]
  s_waitcnt lgkmcnt(0)
  v_mfma_f32_32x32x16_bf16 v[96:111], v[124:127], a[204:207], v[96:111]
  s_nop 7
  ds_read_b128 v[112:115], v5 offset:49152
  ds_read_b128 v[116:119], v6 offset:49152
  ds_read_b128 v[120:123], v7 offset:49152
  ds_read_b128 v[124:127], v8 offset:49152
  s_waitcnt lgkmcnt(3)
  v_mfma_f32_32x32x16_bf16 v[96:111], v[112:115], a[208:211], v[96:111]
  s_waitcnt lgkmcnt(2)
  v_mfma_f32_32x32x16_bf16 v[96:111], v[116:119], a[212:215], v[96:111]
  s_waitcnt lgkmcnt(1)
  v_mfma_f32_32x32x16_bf16 v[96:111], v[120:123], a[216:219], v[96:111]
  s_waitcnt lgkmcnt(0)
  v_mfma_f32_32x32x16_bf16 v[96:111], v[124:127], a[220:223], v[96:111]
  s_nop 7
  s_nop 3
  v_max3_f32 v80, v80, v96, v97
  v_max3_f32 v80, v80, v98, v99
  v_max3_f32 v80, v80, v100, v101
  v_max3_f32 v80, v80, v102, v103
  v_max3_f32 v80, v80, v104, v105
  v_max3_f32 v80, v80, v106, v107
  v_max3_f32 v80, v80, v108, v109
  v_max3_f32 v80, v80, v110, v111
  ds_read_b128 v[112:115], v1 offset:57344
  ds_read_b128 v[116:119], v2 offset:57344
  ds_read_b128 v[120:123], v3 offset:57344
  ds_read_b128 v[124:127], v4 offset:57344
  s_waitcnt lgkmcnt(3)
  v_mfma_f32_32x32x16_bf16 v[96:111], v[112:115], a[192:195], 0
  s_waitcnt lgkmcnt(2)
  v_mfma_f32_32x32x16_bf16 v[96:111], v[116:119], a[196:199], v[96:111]
  s_waitcnt lgkmcnt(1)
  v_mfma_f32_32x32x16_bf16 v[96:111], v[120:123], a[200:203], v[96:111]
  s_waitcnt lgkmcnt(0)
  v_mfma_f32_32x32x16_bf16 v[96:111], v[124:127], a[204:207], v[96:111]
  s_nop 7
  ds_read_b128 v[112:115], v5 offset:57344
  ds_read_b128 v[116:119], v6 offset:57344
  ds_read_b128 v[120:123], v7 offset:57344
  ds_read_b128 v[124:127], v8 offset:57344
  s_waitcnt lgkmcnt(3)
  v_mfma_f32_32x32x16_bf16 v[96:111], v[112:115], a[208:211], v[96:111]
  s_waitcnt lgkmcnt(2)
  v_mfma_f32_32x32x16_bf16 v[96:111], v[116:119], a[212:215], v[96:111]
  s_waitcnt lgkmcnt(1)
  v_mfma_f32_32x32x16_bf16 v[96:111], v[120:123], a[216:219], v[96:111]
  s_waitcnt lgkmcnt(0)
  v_mfma_f32_32x32x16_bf16 v[96:111], v[124:127], a[220:223], v[96:111]
  s_nop 7
  s_nop 3
  v_max3_f32 v80, v80, v96, v97
  v_max3_f32 v80, v80, v98, v99
  v_max3_f32 v80, v80, v100, v101
  v_max3_f32 v80, v80, v102, v103
  v_max3_f32 v80, v80, v104, v105
  v_max3_f32 v80, v80, v106, v107
  v_max3_f32 v80, v80, v108, v109
  v_max3_f32 v80, v80, v110, v111
  ds_read_b128 v[112:115], v9
  ds_read_b128 v[116:119], v10
  ds_read_b128 v[120:123], v11
  ds_read_b128 v[124:127], v12
  s_waitcnt lgkmcnt(3)
  v_mfma_f32_32x32x16_bf16 v[96:111], v[112:115], a[192:195], 0
  s_waitcnt lgkmcnt(2)
  v_mfma_f32_32x32x16_bf16 v[96:111], v[116:119], a[196:199], v[96:111]
  s_waitcnt lgkmcnt(1)
  v_mfma_f32_32x32x16_bf16 v[96:111], v[120:123], a[200:203], v[96:111]
  s_waitcnt lgkmcnt(0)
  v_mfma_f32_32x32x16_bf16 v[96:111], v[124:127], a[204:207], v[96:111]
  s_nop 7
  ds_read_b128 v[112:115], v13
  ds_read_b128 v[116:119], v14
  ds_read_b128 v[120:123], v15
  ds_read_b128 v[124:127], v16
  s_waitcnt lgkmcnt(3)
  v_mfma_f32_32x32x16_bf16 v[96:111], v[112:115], a[208:211], v[96:111]
  s_waitcnt lgkmcnt(2)
  v_mfma_f32_32x32x16_bf16 v[96:111], v[116:119], a[212:215], v[96:111]
  s_waitcnt lgkmcnt(1)
  v_mfma_f32_32x32x16_bf16 v[96:111], v[120:123], a[216:219], v[96:111]
  s_waitcnt lgkmcnt(0)
  v_mfma_f32_32x32x16_bf16 v[96:111], v[124:127], a[220:223], v[96:111]
  s_nop 7
  s_nop 3
  v_max3_f32 v80, v80, v96, v97
  v_max3_f32 v80, v80, v98, v99
  v_max3_f32 v80, v80, v100, v101
  v_max3_f32 v80, v80, v102, v103
  v_max3_f32 v80, v80, v104, v105
  v_max3_f32 v80, v80, v106, v107
  v_max3_f32 v80, v80, v108, v109
  v_max3_f32 v80, v80, v110, v111
  ds_read_b128 v[112:115], v9 offset:8192
  ds_read_b128 v[116:119], v10 offset:8192
  ds_read_b128 v[120:123], v11 offset:8192
  ds_read_b128 v[124:127], v12 offset:8192
  s_waitcnt lgkmcnt(3)
  v_mfma_f32_32x32x16_bf16 v[96:111], v[112:115], a[192:195], 0
  s_waitcnt lgkmcnt(2)
  v_mfma_f32_32x32x16_bf16 v[96:111], v[116:119], a[196:199], v[96:111]
  s_waitcnt lgkmcnt(1)
  v_mfma_f32_32x32x16_bf16 v[96:111], v[120:123], a[200:203], v[96:111]
  s_waitcnt lgkmcnt(0)
  v_mfma_f32_32x32x16_bf16 v[96:111], v[124:127], a[204:207], v[96:111]
  s_nop 7
  ds_read_b128 v[112:115], v13 offset:8192
  ds_read_b128 v[116:119], v14 offset:8192
  ds_read_b128 v[120:123], v15 offset:8192
  ds_read_b128 v[124:127], v16 offset:8192
  s_waitcnt lgkmcnt(3)
  v_mfma_f32_32x32x16_bf16 v[96:111], v[112:115], a[208:211], v[96:111]
  s_waitcnt lgkmcnt(2)
  v_mfma_f32_32x32x16_bf16 v[96:111], v[116:119], a[212:215], v[96:111]
  s_waitcnt lgkmcnt(1)
  v_mfma_f32_32x32x16_bf16 v[96:111], v[120:123], a[216:219], v[96:111]
  s_waitcnt lgkmcnt(0)
  v_mfma_f32_32x32x16_bf16 v[96:111], v[124:127], a[220:223], v[96:111]
  s_nop 7
  s_nop 3
  v_max3_f32 v80, v80, v96, v97
  v_max3_f32 v80, v80, v98, v99
  v_max3_f32 v80, v80, v100, v101
  v_max3_f32 v80, v80, v102, v103
  v_max3_f32 v80, v80, v104, v105
  v_max3_f32 v80, v80, v106, v107
  v_max3_f32 v80, v80, v108, v109
  v_max3_f32 v80, v80, v110, v111
  ds_read_b128 v[112:115], v9 offset:16384
  ds_read_b128 v[116:119], v10 offset:16384
  ds_read_b128 v[120:123], v11 offset:16384
  ds_read_b128 v[124:127], v12 offset:16384
  s_waitcnt lgkmcnt(3)
  v_mfma_f32_32x32x16_bf16 v[96:111], v[112:115], a[192:195], 0
  s_waitcnt lgkmcnt(2)
  v_mfma_f32_32x32x16_bf16 v[96:111], v[116:119], a[196:199], v[96:111]
  s_waitcnt lgkmcnt(1)
  v_mfma_f32_32x32x16_bf16 v[96:111], v[120:123], a[200:203], v[96:111]
  s_waitcnt lgkmcnt(0)
  v_mfma_f32_32x32x16_bf16 v[96:111], v[124:127], a[204:207], v[96:111]
  s_nop 7
  ds_read_b128 v[112:115], v13 offset:16384
  ds_read_b128 v[116:119], v14 offset:16384
  ds_read_b128 v[120:123], v15 offset:16384
  ds_read_b128 v[124:127], v16 offset:16384
  s_waitcnt lgkmcnt(3)
  v_mfma_f32_32x32x16_bf16 v[96:111], v[112:115], a[208:211], v[96:111]
  s_waitcnt lgkmcnt(2)
  v_mfma_f32_32x32x16_bf16 v[96:111], v[116:119], a[212:215], v[96:111]
  s_waitcnt lgkmcnt(1)
  v_mfma_f32_32x32x16_bf16 v[96:111], v[120:123], a[216:219], v[96:111]
  s_waitcnt lgkmcnt(0)
  v_mfma_f32_32x32x16_bf16 v[96:111], v[124:127], a[220:223], v[96:111]
  s_nop 7
  s_nop 3
  v_max3_f32 v80, v80, v96, v97
  v_max3_f32 v80, v80, v98, v99
  v_max3_f32 v80, v80, v100, v101
  v_max3_f32 v80, v80, v102, v103
  v_max3_f32 v80, v80, v104, v105
  v_max3_f32 v80, v80, v106, v107
  v_max3_f32 v80, v80, v108, v109
  v_max3_f32 v80, v80, v110, v111
  ds_read_b128 v[112:115], v9 offset:24576
  ds_read_b128 v[116:119], v10 offset:24576
  ds_read_b128 v[120:123], v11 offset:24576
  ds_read_b128 v[124:127], v12 offset:24576
  s_waitcnt lgkmcnt(3)
  v_mfma_f32_32x32x16_bf16 v[96:111], v[112:115], a[192:195], 0
  s_waitcnt lgkmcnt(2)
  v_mfma_f32_32x32x16_bf16 v[96:111], v[116:119], a[196:199], v[96:111]
  s_waitcnt lgkmcnt(1)
  v_mfma_f32_32x32x16_bf16 v[96:111], v[120:123], a[200:203], v[96:111]
  s_waitcnt lgkmcnt(0)
  v_mfma_f32_32x32x16_bf16 v[96:111], v[124:127], a[204:207], v[96:111]
  s_nop 7
  ds_read_b128 v[112:115], v13 offset:24576
  ds_read_b128 v[116:119], v14 offset:24576
  ds_read_b128 v[120:123], v15 offset:24576
  ds_read_b128 v[124:127], v16 offset:24576
  s_waitcnt lgkmcnt(3)
  v_mfma_f32_32x32x16_bf16 v[96:111], v[112:115], a[208:211], v[96:111]
  s_waitcnt lgkmcnt(2)
  v_mfma_f32_32x32x16_bf16 v[96:111], v[116:119], a[212:215], v[96:111]
  s_waitcnt lgkmcnt(1)
  v_mfma_f32_32x32x16_bf16 v[96:111], v[120:123], a[216:219], v[96:111]
  s_waitcnt lgkmcnt(0)
  v_mfma_f32_32x32x16_bf16 v[96:111], v[124:127], a[220:223], v[96:111]
  s_nop 7
  s_nop 3
  v_max3_f32 v80, v80, v96, v97
  v_max3_f32 v80, v80, v98, v99
  v_max3_f32 v80, v80, v100, v101
  v_max3_f32 v80, v80, v102, v103
  v_max3_f32 v80, v80, v104, v105
  v_max3_f32 v80, v80, v106, v107
  v_max3_f32 v80, v80, v108, v109
  v_max3_f32 v80, v80, v110, v111
  v_mov_b32 v83, v80
  s_nop 1
  v_permlane32_swap_b32 v80, v83
  v_max_f32 v80, v80, v83
  v_mul_f32 v81, s23, v80
  v_mov_b32 v82, 0
  ds_read_b128 v[112:115], v1
  ds_read_b128 v[116:119], v2
  ds_read_b128 v[120:123], v3
  ds_read_b128 v[124:127], v4
  s_waitcnt lgkmcnt(3)
  v_mfma_f32_32x32x16_bf16 v[96:111], v[112:115], a[192:195], 0
  s_waitcnt lgkmcnt(2)
  v_mfma_f32_32x32x16_bf16 v[96:111], v[116:119], a[196:199], v[96:111]
  s_waitcnt lgkmcnt(1)
  v_mfma_f32_32x32x16_bf16 v[96:111], v[120:123], a[200:203], v[96:111]
  s_waitcnt lgkmcnt(0)
  v_mfma_f32_32x32x16_bf16 v[96:111], v[124:127], a[204:207], v[96:111]
  s_nop 7
  ds_read_b128 v[112:115], v5
  ds_read_b128 v[116:119], v6
  ds_read_b128 v[120:123], v7
  ds_read_b128 v[124:127], v8
  s_waitcnt lgkmcnt(3)
  v_mfma_f32_32x32x16_bf16 v[96:111], v[112:115], a[208:211], v[96:111]
  s_waitcnt lgkmcnt(2)
  v_mfma_f32_32x32x16_bf16 v[96:111], v[116:119], a[212:215], v[96:111]
  s_waitcnt lgkmcnt(1)
  v_mfma_f32_32x32x16_bf16 v[96:111], v[120:123], a[216:219], v[96:111]
  s_waitcnt lgkmcnt(0)
  v_mfma_f32_32x32x16_bf16 v[96:111], v[124:127], a[220:223], v[96:111]
  s_nop 7
  s_nop 3
  v_fma_f32 v96, v96, s20, v81
  v_fma_f32 v97, v97, s20, v81
  v_fma_f32 v98, v98, s20, v81
  v_fma_f32 v99, v99, s20, v81
  v_fma_f32 v100, v100, s20, v81
  v_fma_f32 v101, v101, s20, v81
  v_fma_f32 v102, v102, s20, v81
  v_fma_f32 v103, v103, s20, v81
  v_fma_f32 v104, v104, s20, v81
  v_fma_f32 v105, v105, s20, v81
  v_fma_f32 v106, v106, s20, v81
  v_fma_f32 v107, v107, s20, v81
  v_fma_f32 v108, v108, s20, v81
  v_fma_f32 v109, v109, s20, v81
  v_fma_f32 v110, v110, s20, v81
  v_fma_f32 v111, v111, s20, v81
  v_exp_f32 v96, v96
  v_exp_f32 v97, v97
  v_exp_f32 v98, v98
  v_exp_f32 v99, v99
  v_exp_f32 v100, v100
  v_exp_f32 v101, v101
  v_exp_f32 v102, v102
  v_exp_f32 v103, v103
  v_exp_f32 v104, v104
  v_exp_f32 v105, v105
  v_exp_f32 v106, v106
  v_exp_f32 v107, v107
  v_exp_f32 v108, v108
  v_exp_f32 v109, v109
  v_exp_f32 v110, v110
  v_exp_f32 v111, v111
  v_add_f32 v82, v82, v96
  v_add_f32 v82, v82, v97
  v_add_f32 v82, v82, v98
  v_add_f32 v82, v82, v99
  v_add_f32 v82, v82, v100
  v_add_f32 v82, v82, v101
  v_add_f32 v82, v82, v102
  v_add_f32 v82, v82, v103
  v_add_f32 v82, v82, v104
  v_add_f32 v82, v82, v105
  v_add_f32 v82, v82, v106
  v_add_f32 v82, v82, v107
  v_add_f32 v82, v82, v108
  v_add_f32 v82, v82, v109
  v_add_f32 v82, v82, v110
  v_add_f32 v82, v82, v111
  v_cvt_pk_bf16_f32 v88, v96, v97
  v_cvt_pk_bf16_f32 v89, v98, v99
  v_cvt_pk_bf16_f32 v90, v100, v101
  v_cvt_pk_bf16_f32 v91, v102, v103
  v_cvt_pk_bf16_f32 v92, v104, v105
  v_cvt_pk_bf16_f32 v93, v106, v107
  v_cvt_pk_bf16_f32 v94, v108, v109
  v_cvt_pk_bf16_f32 v95, v110, v111
  v_mfma_f32_32x32x16_bf16 v[128:143], a[0:3], v[88:91], 0
  v_mfma_f32_32x32x16_bf16 v[144:159], a[4:7], v[88:91], 0
  v_mfma_f32_32x32x16_bf16 v[160:175], a[8:11], v[88:91], 0
  v_mfma_f32_32x32x16_bf16 v[176:191], a[12:15], v[88:91], 0
  s_nop 7
  v_mfma_f32_32x32x16_bf16 v[128:143], a[16:19], v[92:95], v[128:143]
  v_mfma_f32_32x32x16_bf16 v[144:159], a[20:23], v[92:95], v[144:159]
  v_mfma_f32_32x32x16_bf16 v[160:175], a[24:27], v[92:95], v[160:175]
  v_mfma_f32_32x32x16_bf16 v[176:191], a[28:31], v[92:95], v[176:191]
  s_nop 7
  ds_read_b128 v[112:115], v1 offset:8192
  ds_read_b128 v[116:119], v2 offset:8192
  ds_read_b128 v[120:123], v3 offset:8192
  ds_read_b128 v[124:127], v4 offset:8192
  s_waitcnt lgkmcnt(3)
  v_mfma_f32_32x32x16_bf16 v[96:111], v[112:115], a[192:195], 0
  s_waitcnt lgkmcnt(2)
  v_mfma_f32_32x32x16_bf16 v[96:111], v[116:119], a[196:199], v[96:111]
  s_waitcnt lgkmcnt(1)
  v_mfma_f32_32x32x16_bf16 v[96:111], v[120:123], a[200:203], v[96:111]
  s_waitcnt lgkmcnt(0)
  v_mfma_f32_32x32x16_bf16 v[96:111], v[124:127], a[204:207], v[96:111]
  s_nop 7
  ds_read_b128 v[112:115], v5 offset:8192
  ds_read_b128 v[116:119], v6 offset:8192
  ds_read_b128 v[120:123], v7 offset:8192
  ds_read_b128 v[124:127], v8 offset:8192
  s_waitcnt lgkmcnt(3)
  v_mfma_f32_32x32x16_bf16 v[96:111], v[112:115], a[208:211], v[96:111]
  s_waitcnt lgkmcnt(2)
  v_mfma_f32_32x32x16_bf16 v[96:111], v[116:119], a[212:215], v[96:111]
  s_waitcnt lgkmcnt(1)
  v_mfma_f32_32x32x16_bf16 v[96:111], v[120:123], a[216:219], v[96:111]
  s_waitcnt lgkmcnt(0)
  v_mfma_f32_32x32x16_bf16 v[96:111], v[124:127], a[220:223], v[96:111]
  s_nop 7
  s_nop 3
  v_fma_f32 v96, v96, s20, v81
  v_fma_f32 v97, v97, s20, v81
  v_fma_f32 v98, v98, s20, v81
  v_fma_f32 v99, v99, s20, v81
  v_fma_f32 v100, v100, s20, v81
  v_fma_f32 v101, v101, s20, v81
  v_fma_f32 v102, v102, s20, v81
  v_fma_f32 v103, v103, s20, v81
  v_fma_f32 v104, v104, s20, v81
  v_fma_f32 v105, v105, s20, v81
  v_fma_f32 v106, v106, s20, v81
  v_fma_f32 v107, v107, s20, v81
  v_fma_f32 v108, v108, s20, v81
  v_fma_f32 v109, v109, s20, v81
  v_fma_f32 v110, v110, s20, v81
  v_fma_f32 v111, v111, s20, v81
  v_exp_f32 v96, v96
  v_exp_f32 v97, v97
  v_exp_f32 v98, v98
  v_exp_f32 v99, v99
  v_exp_f32 v100, v100
  v_exp_f32 v101, v101
  v_exp_f32 v102, v102
  v_exp_f32 v103, v103
  v_exp_f32 v104, v104
  v_exp_f32 v105, v105
  v_exp_f32 v106, v106
  v_exp_f32 v107, v107
  v_exp_f32 v108, v108
  v_exp_f32 v109, v109
  v_exp_f32 v110, v110
  v_exp_f32 v111, v111
  v_add_f32 v82, v82, v96
  v_add_f32 v82, v82, v97
  v_add_f32 v82, v82, v98
  v_add_f32 v82, v82, v99
  v_add_f32 v82, v82, v100
  v_add_f32 v82, v82, v101
  v_add_f32 v82, v82, v102
  v_add_f32 v82, v82, v103
  v_add_f32 v82, v82, v104
  v_add_f32 v82, v82, v105
  v_add_f32 v82, v82, v106
  v_add_f32 v82, v82, v107
  v_add_f32 v82, v82, v108
  v_add_f32 v82, v82, v109
  v_add_f32 v82, v82, v110
  v_add_f32 v82, v82, v111
  v_cvt_pk_bf16_f32 v88, v96, v97
  v_cvt_pk_bf16_f32 v89, v98, v99
  v_cvt_pk_bf16_f32 v90, v100, v101
  v_cvt_pk_bf16_f32 v91, v102, v103
  v_cvt_pk_bf16_f32 v92, v104, v105
  v_cvt_pk_bf16_f32 v93, v106, v107
  v_cvt_pk_bf16_f32 v94, v108, v109
  v_cvt_pk_bf16_f32 v95, v110, v111
  v_mfma_f32_32x32x16_bf16 v[128:143], a[32:35], v[88:91], v[128:143]
  v_mfma_f32_32x32x16_bf16 v[144:159], a[36:39], v[88:91], v[144:159]
  v_mfma_f32_32x32x16_bf16 v[160:175], a[40:43], v[88:91], v[160:175]
  v_mfma_f32_32x32x16_bf16 v[176:191], a[44:47], v[88:91], v[176:191]
  s_nop 7
  v_mfma_f32_32x32x16_bf16 v[128:143], a[48:51], v[92:95], v[128:143]
  v_mfma_f32_32x32x16_bf16 v[144:159], a[52:55], v[92:95], v[144:159]
  v_mfma_f32_32x32x16_bf16 v[160:175], a[56:59], v[92:95], v[160:175]
  v_mfma_f32_32x32x16_bf16 v[176:191], a[60:63], v[92:95], v[176:191]
  s_nop 7
  ds_read_b128 v[112:115], v1 offset:16384
  ds_read_b128 v[116:119], v2 offset:16384
  ds_read_b128 v[120:123], v3 offset:16384
  ds_read_b128 v[124:127], v4 offset:16384
  s_waitcnt lgkmcnt(3)
  v_mfma_f32_32x32x16_bf16 v[96:111], v[112:115], a[192:195], 0
  s_waitcnt lgkmcnt(2)
  v_mfma_f32_32x32x16_bf16 v[96:111], v[116:119], a[196:199], v[96:111]
  s_waitcnt lgkmcnt(1)
  v_mfma_f32_32x32x16_bf16 v[96:111], v[120:123], a[200:203], v[96:111]
  s_waitcnt lgkmcnt(0)
  v_mfma_f32_32x32x16_bf16 v[96:111], v[124:127], a[204:207], v[96:111]
  s_nop 7
  ds_read_b128 v[112:115], v5 offset:16384
  ds_read_b128 v[116:119], v6 offset:16384
  ds_read_b128 v[120:123], v7 offset:16384
  ds_read_b128 v[124:127], v8 offset:16384
  s_waitcnt lgkmcnt(3)
  v_mfma_f32_32x32x16_bf16 v[96:111], v[112:115], a[208:211], v[96:111]
  s_waitcnt lgkmcnt(2)
  v_mfma_f32_32x32x16_bf16 v[96:111], v[116:119], a[212:215], v[96:111]
  s_waitcnt lgkmcnt(1)
  v_mfma_f32_32x32x16_bf16 v[96:111], v[120:123], a[216:219], v[96:111]
  s_waitcnt lgkmcnt(0)
  v_mfma_f32_32x32x16_bf16 v[96:111], v[124:127], a[220:223], v[96:111]
  s_nop 7
  s_nop 3
  v_fma_f32 v96, v96, s20, v81
  v_fma_f32 v97, v97, s20, v81
  v_fma_f32 v98, v98, s20, v81
  v_fma_f32 v99, v99, s20, v81
  v_fma_f32 v100, v100, s20, v81
  v_fma_f32 v101, v101, s20, v81
  v_fma_f32 v102, v102, s20, v81
  v_fma_f32 v103, v103, s20, v81
  v_fma_f32 v104, v104, s20, v81
  v_fma_f32 v105, v105, s20, v81
  v_fma_f32 v106, v106, s20, v81
  v_fma_f32 v107, v107, s20, v81
  v_fma_f32 v108, v108, s20, v81
  v_fma_f32 v109, v109, s20, v81
  v_fma_f32 v110, v110, s20, v81
  v_fma_f32 v111, v111, s20, v81
  v_exp_f32 v96, v96
  v_exp_f32 v97, v97
  v_exp_f32 v98, v98
  v_exp_f32 v99, v99
  v_exp_f32 v100, v100
  v_exp_f32 v101, v101
  v_exp_f32 v102, v102
  v_exp_f32 v103, v103
  v_exp_f32 v104, v104
  v_exp_f32 v105, v105
  v_exp_f32 v106, v106
  v_exp_f32 v107, v107
  v_exp_f32 v108, v108
  v_exp_f32 v109, v109
  v_exp_f32 v110, v110
  v_exp_f32 v111, v111
  v_add_f32 v82, v82, v96
  v_add_f32 v82, v82, v97
  v_add_f32 v82, v82, v98
  v_add_f32 v82, v82, v99
  v_add_f32 v82, v82, v100
  v_add_f32 v82, v82, v101
  v_add_f32 v82, v82, v102
  v_add_f32 v82, v82, v103
  v_add_f32 v82, v82, v104
  v_add_f32 v82, v82, v105
  v_add_f32 v82, v82, v106
  v_add_f32 v82, v82, v107
  v_add_f32 v82, v82, v108
  v_add_f32 v82, v82, v109
  v_add_f32 v82, v82, v110
  v_add_f32 v82, v82, v111
  v_cvt_pk_bf16_f32 v88, v96, v97
  v_cvt_pk_bf16_f32 v89, v98, v99
  v_cvt_pk_bf16_f32 v90, v100, v101
  v_cvt_pk_bf16_f32 v91, v102, v103
  v_cvt_pk_bf16_f32 v92, v104, v105
  v_cvt_pk_bf16_f32 v93, v106, v107
  v_cvt_pk_bf16_f32 v94, v108, v109
  v_cvt_pk_bf16_f32 v95, v110, v111
  v_mfma_f32_32x32x16_bf16 v[128:143], a[64:67], v[88:91], v[128:143]
  v_mfma_f32_32x32x16_bf16 v[144:159], a[68:71], v[88:91], v[144:159]
  v_mfma_f32_32x32x16_bf16 v[160:175], a[72:75], v[88:91], v[160:175]
  v_mfma_f32_32x32x16_bf16 v[176:191], a[76:79], v[88:91], v[176:191]
  s_nop 7
  v_mfma_f32_32x32x16_bf16 v[128:143], a[80:83], v[92:95], v[128:143]
  v_mfma_f32_32x32x16_bf16 v[144:159], a[84:87], v[92:95], v[144:159]
  v_mfma_f32_32x32x16_bf16 v[160:175], a[88:91], v[92:95], v[160:175]
  v_mfma_f32_32x32x16_bf16 v[176:191], a[92:95], v[92:95], v[176:191]
  s_nop 7
  ds_read_b128 v[112:115], v1 offset:24576
  ds_read_b128 v[116:119], v2 offset:24576
  ds_read_b128 v[120:123], v3 offset:24576
  ds_read_b128 v[124:127], v4 offset:24576
  s_waitcnt lgkmcnt(3)
  v_mfma_f32_32x32x16_bf16 v[96:111], v[112:115], a[192:195], 0
  s_waitcnt lgkmcnt(2)
  v_mfma_f32_32x32x16_bf16 v[96:111], v[116:119], a[196:199], v[96:111]
  s_waitcnt lgkmcnt(1)
  v_mfma_f32_32x32x16_bf16 v[96:111], v[120:123], a[200:203], v[96:111]
  s_waitcnt lgkmcnt(0)
  v_mfma_f32_32x32x16_bf16 v[96:111], v[124:127], a[204:207], v[96:111]
  s_nop 7
  ds_read_b128 v[112:115], v5 offset:24576
  ds_read_b128 v[116:119], v6 offset:24576
  ds_read_b128 v[120:123], v7 offset:24576
  ds_read_b128 v[124:127], v8 offset:24576
  s_waitcnt lgkmcnt(3)
  v_mfma_f32_32x32x16_bf16 v[96:111], v[112:115], a[208:211], v[96:111]
  s_waitcnt lgkmcnt(2)
  v_mfma_f32_32x32x16_bf16 v[96:111], v[116:119], a[212:215], v[96:111]
  s_waitcnt lgkmcnt(1)
  v_mfma_f32_32x32x16_bf16 v[96:111], v[120:123], a[216:219], v[96:111]
  s_waitcnt lgkmcnt(0)
  v_mfma_f32_32x32x16_bf16 v[96:111], v[124:127], a[220:223], v[96:111]
  s_nop 7
  s_nop 3
  v_fma_f32 v96, v96, s20, v81
  v_fma_f32 v97, v97, s20, v81
  v_fma_f32 v98, v98, s20, v81
  v_fma_f32 v99, v99, s20, v81
  v_fma_f32 v100, v100, s20, v81
  v_fma_f32 v101, v101, s20, v81
  v_fma_f32 v102, v102, s20, v81
  v_fma_f32 v103, v103, s20, v81
  v_fma_f32 v104, v104, s20, v81
  v_fma_f32 v105, v105, s20, v81
  v_fma_f32 v106, v106, s20, v81
  v_fma_f32 v107, v107, s20, v81
  v_fma_f32 v108, v108, s20, v81
  v_fma_f32 v109, v109, s20, v81
  v_fma_f32 v110, v110, s20, v81
  v_fma_f32 v111, v111, s20, v81
  v_exp_f32 v96, v96
  v_exp_f32 v97, v97
  v_exp_f32 v98, v98
  v_exp_f32 v99, v99
  v_exp_f32 v100, v100
  v_exp_f32 v101, v101
  v_exp_f32 v102, v102
  v_exp_f32 v103, v103
  v_exp_f32 v104, v104
  v_exp_f32 v105, v105
  v_exp_f32 v106, v106
  v_exp_f32 v107, v107
  v_exp_f32 v108, v108
  v_exp_f32 v109, v109
  v_exp_f32 v110, v110
  v_exp_f32 v111, v111
  v_add_f32 v82, v82, v96
  v_add_f32 v82, v82, v97
  v_add_f32 v82, v82, v98
  v_add_f32 v82, v82, v99
  v_add_f32 v82, v82, v100
  v_add_f32 v82, v82, v101
  v_add_f32 v82, v82, v102
  v_add_f32 v82, v82, v103
  v_add_f32 v82, v82, v104
  v_add_f32 v82, v82, v105
  v_add_f32 v82, v82, v106
  v_add_f32 v82, v82, v107
  v_add_f32 v82, v82, v108
  v_add_f32 v82, v82, v109
  v_add_f32 v82, v82, v110
  v_add_f32 v82, v82, v111
  v_cvt_pk_bf16_f32 v88, v96, v97
  v_cvt_pk_bf16_f32 v89, v98, v99
  v_cvt_pk_bf16_f32 v90, v100, v101
  v_cvt_pk_bf16_f32 v91, v102, v103
  v_cvt_pk_bf16_f32 v92, v104, v105
  v_cvt_pk_bf16_f32 v93, v106, v107
  v_cvt_pk_bf16_f32 v94, v108, v109
  v_cvt_pk_bf16_f32 v95, v110, v111
  v_mfma_f32_32x32x16_bf16 v[128:143], a[96:99], v[88:91], v[128:143]
  v_mfma_f32_32x32x16_bf16 v[144:159], a[100:103], v[88:91], v[144:159]
  v_mfma_f32_32x32x16_bf16 v[160:175], a[104:107], v[88:91], v[160:175]
  v_mfma_f32_32x32x16_bf16 v[176:191], a[108:111], v[88:91], v[176:191]
  s_nop 7
  v_mfma_f32_32x32x16_bf16 v[128:143], a[112:115], v[92:95], v[128:143]
  v_mfma_f32_32x32x16_bf16 v[144:159], a[116:119], v[92:95], v[144:159]
  v_mfma_f32_32x32x16_bf16 v[160:175], a[120:123], v[92:95], v[160:175]
  v_mfma_f32_32x32x16_bf16 v[176:191], a[124:127], v[92:95], v[176:191]
  s_nop 7
  ds_read_b128 v[112:115], v1 offset:32768
  ds_read_b128 v[116:119], v2 offset:32768
  ds_read_b128 v[120:123], v3 offset:32768
  ds_read_b128 v[124:127], v4 offset:32768
  s_waitcnt lgkmcnt(3)
  v_mfma_f32_32x32x16_bf16 v[96:111], v[112:115], a[192:195], 0
  s_waitcnt lgkmcnt(2)
  v_mfma_f32_32x32x16_bf16 v[96:111], v[116:119], a[196:199], v[96:111]
  s_waitcnt lgkmcnt(1)
  v_mfma_f32_32x32x16_bf16 v[96:111], v[120:123], a[200:203], v[96:111]
  s_waitcnt lgkmcnt(0)
  v_mfma_f32_32x32x16_bf16 v[96:111], v[124:127], a[204:207], v[96:111]
  s_nop 7
  ds_read_b128 v[112:115], v5 offset:32768
  ds_read_b128 v[116:119], v6 offset:32768
  ds_read_b128 v[120:123], v7 offset:32768
  ds_read_b128 v[124:127], v8 offset:32768
  s_waitcnt lgkmcnt(3)
  v_mfma_f32_32x32x16_bf16 v[96:111], v[112:115], a[208:211], v[96:111]
  s_waitcnt lgkmcnt(2)
  v_mfma_f32_32x32x16_bf16 v[96:111], v[116:119], a[212:215], v[96:111]
  s_waitcnt lgkmcnt(1)
  v_mfma_f32_32x32x16_bf16 v[96:111], v[120:123], a[216:219], v[96:111]
  s_waitcnt lgkmcnt(0)
  v_mfma_f32_32x32x16_bf16 v[96:111], v[124:127], a[220:223], v[96:111]
  s_nop 7
  s_nop 3
  v_fma_f32 v96, v96, s20, v81
  v_fma_f32 v97, v97, s20, v81
  v_fma_f32 v98, v98, s20, v81
  v_fma_f32 v99, v99, s20, v81
  v_fma_f32 v100, v100, s20, v81
  v_fma_f32 v101, v101, s20, v81
  v_fma_f32 v102, v102, s20, v81
  v_fma_f32 v103, v103, s20, v81
  v_fma_f32 v104, v104, s20, v81
  v_fma_f32 v105, v105, s20, v81
  v_fma_f32 v106, v106, s20, v81
  v_fma_f32 v107, v107, s20, v81
  v_fma_f32 v108, v108, s20, v81
  v_fma_f32 v109, v109, s20, v81
  v_fma_f32 v110, v110, s20, v81
  v_fma_f32 v111, v111, s20, v81
  v_exp_f32 v96, v96
  v_exp_f32 v97, v97
  v_exp_f32 v98, v98
  v_exp_f32 v99, v99
  v_exp_f32 v100, v100
  v_exp_f32 v101, v101
  v_exp_f32 v102, v102
  v_exp_f32 v103, v103
  v_exp_f32 v104, v104
  v_exp_f32 v105, v105
  v_exp_f32 v106, v106
  v_exp_f32 v107, v107
  v_exp_f32 v108, v108
  v_exp_f32 v109, v109
  v_exp_f32 v110, v110
  v_exp_f32 v111, v111
  v_add_f32 v82, v82, v96
  v_add_f32 v82, v82, v97
  v_add_f32 v82, v82, v98
  v_add_f32 v82, v82, v99
  v_add_f32 v82, v82, v100
  v_add_f32 v82, v82, v101
  v_add_f32 v82, v82, v102
  v_add_f32 v82, v82, v103
  v_add_f32 v82, v82, v104
  v_add_f32 v82, v82, v105
  v_add_f32 v82, v82, v106
  v_add_f32 v82, v82, v107
  v_add_f32 v82, v82, v108
  v_add_f32 v82, v82, v109
  v_add_f32 v82, v82, v110
  v_add_f32 v82, v82, v111
  v_cvt_pk_bf16_f32 v88, v96, v97
  v_cvt_pk_bf16_f32 v89, v98, v99
  v_cvt_pk_bf16_f32 v90, v100, v101
  v_cvt_pk_bf16_f32 v91, v102, v103
  v_cvt_pk_bf16_f32 v92, v104, v105
  v_cvt_pk_bf16_f32 v93, v106, v107
  v_cvt_pk_bf16_f32 v94, v108, v109
  v_cvt_pk_bf16_f32 v95, v110, v111
  v_mfma_f32_32x32x16_bf16 v[128:143], a[128:131], v[88:91], v[128:143]
  v_mfma_f32_32x32x16_bf16 v[144:159], a[132:135], v[88:91], v[144:159]
  v_mfma_f32_32x32x16_bf16 v[160:175], a[136:139], v[88:91], v[160:175]
  v_mfma_f32_32x32x16_bf16 v[176:191], a[140:143], v[88:91], v[176:191]
  s_nop 7
  v_mfma_f32_32x32x16_bf16 v[128:143], a[144:147], v[92:95], v[128:143]
  v_mfma_f32_32x32x16_bf16 v[144:159], a[148:151], v[92:95], v[144:159]
  v_mfma_f32_32x32x16_bf16 v[160:175], a[152:155], v[92:95], v[160:175]
  v_mfma_f32_32x32x16_bf16 v[176:191], a[156:159], v[92:95], v[176:191]
  s_nop 7
  ds_read_b128 v[112:115], v1 offset:40960
  ds_read_b128 v[116:119], v2 offset:40960
  ds_read_b128 v[120:123], v3 offset:40960
  ds_read_b128 v[124:127], v4 offset:40960
  s_waitcnt lgkmcnt(3)
  v_mfma_f32_32x32x16_bf16 v[96:111], v[112:115], a[192:195], 0
  s_waitcnt lgkmcnt(2)
  v_mfma_f32_32x32x16_bf16 v[96:111], v[116:119], a[196:199], v[96:111]
  s_waitcnt lgkmcnt(1)
  v_mfma_f32_32x32x16_bf16 v[96:111], v[120:123], a[200:203], v[96:111]
  s_waitcnt lgkmcnt(0)
  v_mfma_f32_32x32x16_bf16 v[96:111], v[124:127], a[204:207], v[96:111]
  s_nop 7
  ds_read_b128 v[112:115], v5 offset:40960
  ds_read_b128 v[116:119], v6 offset:40960
  ds_read_b128 v[120:123], v7 offset:40960
  ds_read_b128 v[124:127], v8 offset:40960
  s_waitcnt lgkmcnt(3)
  v_mfma_f32_32x32x16_bf16 v[96:111], v[112:115], a[208:211], v[96:111]
  s_waitcnt lgkmcnt(2)
  v_mfma_f32_32x32x16_bf16 v[96:111], v[116:119], a[212:215], v[96:111]
  s_waitcnt lgkmcnt(1)
  v_mfma_f32_32x32x16_bf16 v[96:111], v[120:123], a[216:219], v[96:111]
  s_waitcnt lgkmcnt(0)
  v_mfma_f32_32x32x16_bf16 v[96:111], v[124:127], a[220:223], v[96:111]
  s_nop 7
  s_nop 3
  v_fma_f32 v96, v96, s20, v81
  v_fma_f32 v97, v97, s20, v81
  v_fma_f32 v98, v98, s20, v81
  v_fma_f32 v99, v99, s20, v81
  v_fma_f32 v100, v100, s20, v81
  v_fma_f32 v101, v101, s20, v81
  v_fma_f32 v102, v102, s20, v81
  v_fma_f32 v103, v103, s20, v81
  v_fma_f32 v104, v104, s20, v81
  v_fma_f32 v105, v105, s20, v81
  v_fma_f32 v106, v106, s20, v81
  v_fma_f32 v107, v107, s20, v81
  v_fma_f32 v108, v108, s20, v81
  v_fma_f32 v109, v109, s20, v81
  v_fma_f32 v110, v110, s20, v81
  v_fma_f32 v111, v111, s20, v81
  v_exp_f32 v96, v96
  v_exp_f32 v97, v97
  v_exp_f32 v98, v98
  v_exp_f32 v99, v99
  v_exp_f32 v100, v100
  v_exp_f32 v101, v101
  v_exp_f32 v102, v102
  v_exp_f32 v103, v103
  v_exp_f32 v104, v104
  v_exp_f32 v105, v105
  v_exp_f32 v106, v106
  v_exp_f32 v107, v107
  v_exp_f32 v108, v108
  v_exp_f32 v109, v109
  v_exp_f32 v110, v110
  v_exp_f32 v111, v111
  v_add_f32 v82, v82, v96
  v_add_f32 v82, v82, v97
  v_add_f32 v82, v82, v98
  v_add_f32 v82, v82, v99
  v_add_f32 v82, v82, v100
  v_add_f32 v82, v82, v101
  v_add_f32 v82, v82, v102
  v_add_f32 v82, v82, v103
  v_add_f32 v82, v82, v104
  v_add_f32 v82, v82, v105
  v_add_f32 v82, v82, v106
  v_add_f32 v82, v82, v107
  v_add_f32 v82, v82, v108
  v_add_f32 v82, v82, v109
  v_add_f32 v82, v82, v110
  v_add_f32 v82, v82, v111
  v_cvt_pk_bf16_f32 v88, v96, v97
  v_cvt_pk_bf16_f32 v89, v98, v99
  v_cvt_pk_bf16_f32 v90, v100, v101
  v_cvt_pk_bf16_f32 v91, v102, v103
  v_cvt_pk_bf16_f32 v92, v104, v105
  v_cvt_pk_bf16_f32 v93, v106, v107
  v_cvt_pk_bf16_f32 v94, v108, v109
  v_cvt_pk_bf16_f32 v95, v110, v111
  v_mfma_f32_32x32x16_bf16 v[128:143], a[160:163], v[88:91], v[128:143]
  v_mfma_f32_32x32x16_bf16 v[144:159], a[164:167], v[88:91], v[144:159]
  v_mfma_f32_32x32x16_bf16 v[160:175], a[168:171], v[88:91], v[160:175]
  v_mfma_f32_32x32x16_bf16 v[176:191], a[172:175], v[88:91], v[176:191]
  s_nop 7
  v_mfma_f32_32x32x16_bf16 v[128:143], a[176:179], v[92:95], v[128:143]
  v_mfma_f32_32x32x16_bf16 v[144:159], a[180:183], v[92:95], v[144:159]
  v_mfma_f32_32x32x16_bf16 v[160:175], a[184:187], v[92:95], v[160:175]
  v_mfma_f32_32x32x16_bf16 v[176:191], a[188:191], v[92:95], v[176:191]
  s_nop 7
  ds_read_b128 v[112:115], v1 offset:49152
  ds_read_b128 v[116:119], v2 offset:49152
  ds_read_b128 v[120:123], v3 offset:49152
  ds_read_b128 v[124:127], v4 offset:49152
  s_waitcnt lgkmcnt(3)
  v_mfma_f32_32x32x16_bf16 v[96:111], v[112:115], a[192:195], 0
  s_waitcnt lgkmcnt(2)
  v_mfma_f32_32x32x16_bf16 v[96:111], v[116:119], a[196:199], v[96:111]
  s_waitcnt lgkmcnt(1)
  v_mfma_f32_32x32x16_bf16 v[96:111], v[120:123], a[200:203], v[96:111]
  s_waitcnt lgkmcnt(0)
  v_mfma_f32_32x32x16_bf16 v[96:111], v[124:127], a[204:207], v[96:111]
  s_nop 7
  ds_read_b128 v[112:115], v5 offset:49152
  ds_read_b128 v[116:119], v6 offset:49152
  ds_read_b128 v[120:123], v7 offset:49152
  ds_read_b128 v[124:127], v8 offset:49152
  s_waitcnt lgkmcnt(3)
  v_mfma_f32_32x32x16_bf16 v[96:111], v[112:115], a[208:211], v[96:111]
  s_waitcnt lgkmcnt(2)
  v_mfma_f32_32x32x16_bf16 v[96:111], v[116:119], a[212:215], v[96:111]
  s_waitcnt lgkmcnt(1)
  v_mfma_f32_32x32x16_bf16 v[96:111], v[120:123], a[216:219], v[96:111]
  s_waitcnt lgkmcnt(0)
  v_mfma_f32_32x32x16_bf16 v[96:111], v[124:127], a[220:223], v[96:111]
  s_nop 7
  s_nop 3
  v_fma_f32 v96, v96, s20, v81
  v_fma_f32 v97, v97, s20, v81
  v_fma_f32 v98, v98, s20, v81
  v_fma_f32 v99, v99, s20, v81
  v_fma_f32 v100, v100, s20, v81
  v_fma_f32 v101, v101, s20, v81
  v_fma_f32 v102, v102, s20, v81
  v_fma_f32 v103, v103, s20, v81
  v_fma_f32 v104, v104, s20, v81
  v_fma_f32 v105, v105, s20, v81
  v_fma_f32 v106, v106, s20, v81
  v_fma_f32 v107, v107, s20, v81
  v_fma_f32 v108, v108, s20, v81
  v_fma_f32 v109, v109, s20, v81
  v_fma_f32 v110, v110, s20, v81
  v_fma_f32 v111, v111, s20, v81
  v_exp_f32 v96, v96
  v_exp_f32 v97, v97
  v_exp_f32 v98, v98
  v_exp_f32 v99, v99
  v_exp_f32 v100, v100
  v_exp_f32 v101, v101
  v_exp_f32 v102, v102
  v_exp_f32 v103, v103
  v_exp_f32 v104, v104
  v_exp_f32 v105, v105
  v_exp_f32 v106, v106
  v_exp_f32 v107, v107
  v_exp_f32 v108, v108
  v_exp_f32 v109, v109
  v_exp_f32 v110, v110
  v_exp_f32 v111, v111
  v_add_f32 v82, v82, v96
  v_add_f32 v82, v82, v97
  v_add_f32 v82, v82, v98
  v_add_f32 v82, v82, v99
  v_add_f32 v82, v82, v100
  v_add_f32 v82, v82, v101
  v_add_f32 v82, v82, v102
  v_add_f32 v82, v82, v103
  v_add_f32 v82, v82, v104
  v_add_f32 v82, v82, v105
  v_add_f32 v82, v82, v106
  v_add_f32 v82, v82, v107
  v_add_f32 v82, v82, v108
  v_add_f32 v82, v82, v109
  v_add_f32 v82, v82, v110
  v_add_f32 v82, v82, v111
  v_cvt_pk_bf16_f32 v88, v96, v97
  v_cvt_pk_bf16_f32 v89, v98, v99
  v_cvt_pk_bf16_f32 v90, v100, v101
  v_cvt_pk_bf16_f32 v91, v102, v103
  v_cvt_pk_bf16_f32 v92, v104, v105
  v_cvt_pk_bf16_f32 v93, v106, v107
  v_cvt_pk_bf16_f32 v94, v108, v109
  v_cvt_pk_bf16_f32 v95, v110, v111
  ds_read_b64_tr_b16 v[112:113], v17 offset:49152
  ds_read_b64_tr_b16 v[114:115], v17 offset:51200
  ds_read_b64_tr_b16 v[116:117], v18 offset:49152
  ds_read_b64_tr_b16 v[118:119], v18 offset:51200
  ds_read_b64_tr_b16 v[120:121], v19 offset:49152
  ds_read_b64_tr_b16 v[122:123], v19 offset:51200
  ds_read_b64_tr_b16 v[124:125], v20 offset:49152
  ds_read_b64_tr_b16 v[126:127], v20 offset:51200
  s_waitcnt lgkmcnt(6)
  v_mfma_f32_32x32x16_bf16 v[128:143], v[112:115], v[88:91], v[128:143]
  s_waitcnt lgkmcnt(4)
  v_mfma_f32_32x32x16_bf16 v[144:159], v[116:119], v[88:91], v[144:159]
  s_waitcnt lgkmcnt(2)
  v_mfma_f32_32x32x16_bf16 v[160:175], v[120:123], v[88:91], v[160:175]
  s_waitcnt lgkmcnt(0)
  v_mfma_f32_32x32x16_bf16 v[176:191], v[124:127], v[88:91], v[176:191]
  s_nop 7
  ds_read_b64_tr_b16 v[112:113], v17 offset:53248
  ds_read_b64_tr_b16 v[114:115], v17 offset:55296
  ds_read_b64_tr_b16 v[116:117], v18 offset:53248
  ds_read_b64_tr_b16 v[118:119], v18 offset:55296
  ds_read_b64_tr_b16 v[120:121], v19 offset:53248
  ds_read_b64_tr_b16 v[122:123], v19 offset:55296
  ds_read_b64_tr_b16 v[124:125], v20 offset:53248
  ds_read_b64_tr_b16 v[126:127], v20 offset:55296
  s_waitcnt lgkmcnt(6)
  v_mfma_f32_32x32x16_bf16 v[128:143], v[112:115], v[92:95], v[128:143]
  s_waitcnt lgkmcnt(4)
  v_mfma_f32_32x32x16_bf16 v[144:159], v[116:119], v[92:95], v[144:159]
  s_waitcnt lgkmcnt(2)
  v_mfma_f32_32x32x16_bf16 v[160:175], v[120:123], v[92:95], v[160:175]
  s_waitcnt lgkmcnt(0)
  v_mfma_f32_32x32x16_bf16 v[176:191], v[124:127], v[92:95], v[176:191]
  s_nop 7
  ds_read_b128 v[112:115], v1 offset:57344
  ds_read_b128 v[116:119], v2 offset:57344
  ds_read_b128 v[120:123], v3 offset:57344
  ds_read_b128 v[124:127], v4 offset:57344
  s_waitcnt lgkmcnt(3)
  v_mfma_f32_32x32x16_bf16 v[96:111], v[112:115], a[192:195], 0
  s_waitcnt lgkmcnt(2)
  v_mfma_f32_32x32x16_bf16 v[96:111], v[116:119], a[196:199], v[96:111]
  s_waitcnt lgkmcnt(1)
  v_mfma_f32_32x32x16_bf16 v[96:111], v[120:123], a[200:203], v[96:111]
  s_waitcnt lgkmcnt(0)
  v_mfma_f32_32x32x16_bf16 v[96:111], v[124:127], a[204:207], v[96:111]
  s_nop 7
  ds_read_b128 v[112:115], v5 offset:57344
  ds_read_b128 v[116:119], v6 offset:57344
  ds_read_b128 v[120:123], v7 offset:57344
  ds_read_b128 v[124:127], v8 offset:57344
  s_waitcnt lgkmcnt(3)
  v_mfma_f32_32x32x16_bf16 v[96:111], v[112:115], a[208:211], v[96:111]
  s_waitcnt lgkmcnt(2)
  v_mfma_f32_32x32x16_bf16 v[96:111], v[116:119], a[212:215], v[96:111]
  s_waitcnt lgkmcnt(1)
  v_mfma_f32_32x32x16_bf16 v[96:111], v[120:123], a[216:219], v[96:111]
  s_waitcnt lgkmcnt(0)
  v_mfma_f32_32x32x16_bf16 v[96:111], v[124:127], a[220:223], v[96:111]
  s_nop 7
  s_nop 3
  v_fma_f32 v96, v96, s20, v81
  v_fma_f32 v97, v97, s20, v81
  v_fma_f32 v98, v98, s20, v81
  v_fma_f32 v99, v99, s20, v81
  v_fma_f32 v100, v100, s20, v81
  v_fma_f32 v101, v101, s20, v81
  v_fma_f32 v102, v102, s20, v81
  v_fma_f32 v103, v103, s20, v81
  v_fma_f32 v104, v104, s20, v81
  v_fma_f32 v105, v105, s20, v81
  v_fma_f32 v106, v106, s20, v81
  v_fma_f32 v107, v107, s20, v81
  v_fma_f32 v108, v108, s20, v81
  v_fma_f32 v109, v109, s20, v81
  v_fma_f32 v110, v110, s20, v81
  v_fma_f32 v111, v111, s20, v81
  v_exp_f32 v96, v96
  v_exp_f32 v97, v97
  v_exp_f32 v98, v98
  v_exp_f32 v99, v99
  v_exp_f32 v100, v100
  v_exp_f32 v101, v101
  v_exp_f32 v102, v102
  v_exp_f32 v103, v103
  v_exp_f32 v104, v104
  v_exp_f32 v105, v105
  v_exp_f32 v106, v106
  v_exp_f32 v107, v107
  v_exp_f32 v108, v108
  v_exp_f32 v109, v109
  v_exp_f32 v110, v110
  v_exp_f32 v111, v111
  v_add_f32 v82, v82, v96
  v_add_f32 v82, v82, v97
  v_add_f32 v82, v82, v98
  v_add_f32 v82, v82, v99
  v_add_f32 v82, v82, v100
  v_add_f32 v82, v82, v101
  v_add_f32 v82, v82, v102
  v_add_f32 v82, v82, v103
  v_add_f32 v82, v82, v104
  v_add_f32 v82, v82, v105
  v_add_f32 v82, v82, v106
  v_add_f32 v82, v82, v107
  v_add_f32 v82, v82, v108
  v_add_f32 v82, v82, v109
  v_add_f32 v82, v82, v110
  v_add_f32 v82, v82, v111
  v_cvt_pk_bf16_f32 v88, v96, v97
  v_cvt_pk_bf16_f32 v89, v98, v99
  v_cvt_pk_bf16_f32 v90, v100, v101
  v_cvt_pk_bf16_f32 v91, v102, v103
  v_cvt_pk_bf16_f32 v92, v104, v105
  v_cvt_pk_bf16_f32 v93, v106, v107
  v_cvt_pk_bf16_f32 v94, v108, v109
  v_cvt_pk_bf16_f32 v95, v110, v111
  ds_read_b64_tr_b16 v[112:113], v17 offset:57344
  ds_read_b64_tr_b16 v[114:115], v17 offset:59392
  ds_read_b64_tr_b16 v[116:117], v18 offset:57344
  ds_read_b64_tr_b16 v[118:119], v18 offset:59392
  ds_read_b64_tr_b16 v[120:121], v19 offset:57344
  ds_read_b64_tr_b16 v[122:123], v19 offset:59392
  ds_read_b64_tr_b16 v[124:125], v20 offset:57344
  ds_read_b64_tr_b16 v[126:127], v20 offset:59392
  s_waitcnt lgkmcnt(6)
  v_mfma_f32_32x32x16_bf16 v[128:143], v[112:115], v[88:91], v[128:143]
  s_waitcnt lgkmcnt(4)
  v_mfma_f32_32x32x16_bf16 v[144:159], v[116:119], v[88:91], v[144:159]
  s_waitcnt lgkmcnt(2)
  v_mfma_f32_32x32x16_bf16 v[160:175], v[120:123], v[88:91], v[160:175]
  s_waitcnt lgkmcnt(0)
  v_mfma_f32_32x32x16_bf16 v[176:191], v[124:127], v[88:91], v[176:191]
  s_nop 7
  ds_read_b64_tr_b16 v[112:113], v17 offset:61440
  ds_read_b64_tr_b16 v[114:115], v17 offset:63488
  ds_read_b64_tr_b16 v[116:117], v18 offset:61440
  ds_read_b64_tr_b16 v[118:119], v18 offset:63488
  ds_read_b64_tr_b16 v[120:121], v19 offset:61440
  ds_read_b64_tr_b16 v[122:123], v19 offset:63488
  ds_read_b64_tr_b16 v[124:125], v20 offset:61440
  ds_read_b64_tr_b16 v[126:127], v20 offset:63488
  s_waitcnt lgkmcnt(6)
  v_mfma_f32_32x32x16_bf16 v[128:143], v[112:115], v[92:95], v[128:143]
  s_waitcnt lgkmcnt(4)
  v_mfma_f32_32x32x16_bf16 v[144:159], v[116:119], v[92:95], v[144:159]
  s_waitcnt lgkmcnt(2)
  v_mfma_f32_32x32x16_bf16 v[160:175], v[120:123], v[92:95], v[160:175]
  s_waitcnt lgkmcnt(0)
  v_mfma_f32_32x32x16_bf16 v[176:191], v[124:127], v[92:95], v[176:191]
  s_nop 7
  ds_read_b128 v[112:115], v9
  ds_read_b128 v[116:119], v10
  ds_read_b128 v[120:123], v11
  ds_read_b128 v[124:127], v12
  s_waitcnt lgkmcnt(3)
  v_mfma_f32_32x32x16_bf16 v[96:111], v[112:115], a[192:195], 0
  s_waitcnt lgkmcnt(2)
  v_mfma_f32_32x32x16_bf16 v[96:111], v[116:119], a[196:199], v[96:111]
  s_waitcnt lgkmcnt(1)
  v_mfma_f32_32x32x16_bf16 v[96:111], v[120:123], a[200:203], v[96:111]
  s_waitcnt lgkmcnt(0)
  v_mfma_f32_32x32x16_bf16 v[96:111], v[124:127], a[204:207], v[96:111]
  s_nop 7
  ds_read_b128 v[112:115], v13
  ds_read_b128 v[116:119], v14
  ds_read_b128 v[120:123], v15
  ds_read_b128 v[124:127], v16
  s_waitcnt lgkmcnt(3)
  v_mfma_f32_32x32x16_bf16 v[96:111], v[112:115], a[208:211], v[96:111]
  s_waitcnt lgkmcnt(2)
  v_mfma_f32_32x32x16_bf16 v[96:111], v[116:119], a[212:215], v[96:111]
  s_waitcnt lgkmcnt(1)
  v_mfma_f32_32x32x16_bf16 v[96:111], v[120:123], a[216:219], v[96:111]
  s_waitcnt lgkmcnt(0)
  v_mfma_f32_32x32x16_bf16 v[96:111], v[124:127], a[220:223], v[96:111]
  s_nop 7
  s_nop 3
  v_fma_f32 v96, v96, s20, v81
  v_fma_f32 v97, v97, s20, v81
  v_fma_f32 v98, v98, s20, v81
  v_fma_f32 v99, v99, s20, v81
  v_fma_f32 v100, v100, s20, v81
  v_fma_f32 v101, v101, s20, v81
  v_fma_f32 v102, v102, s20, v81
  v_fma_f32 v103, v103, s20, v81
  v_fma_f32 v104, v104, s20, v81
  v_fma_f32 v105, v105, s20, v81
  v_fma_f32 v106, v106, s20, v81
  v_fma_f32 v107, v107, s20, v81
  v_fma_f32 v108, v108, s20, v81
  v_fma_f32 v109, v109, s20, v81
  v_fma_f32 v110, v110, s20, v81
  v_fma_f32 v111, v111, s20, v81
  v_exp_f32 v96, v96
  v_exp_f32 v97, v97
  v_exp_f32 v98, v98
  v_exp_f32 v99, v99
  v_exp_f32 v100, v100
  v_exp_f32 v101, v101
  v_exp_f32 v102, v102
  v_exp_f32 v103, v103
  v_exp_f32 v104, v104
  v_exp_f32 v105, v105
  v_exp_f32 v106, v106
  v_exp_f32 v107, v107
  v_exp_f32 v108, v108
  v_exp_f32 v109, v109
  v_exp_f32 v110, v110
  v_exp_f32 v111, v111
  v_add_f32 v82, v82, v96
  v_add_f32 v82, v82, v97
  v_add_f32 v82, v82, v98
  v_add_f32 v82, v82, v99
  v_add_f32 v82, v82, v100
  v_add_f32 v82, v82, v101
  v_add_f32 v82, v82, v102
  v_add_f32 v82, v82, v103
  v_add_f32 v82, v82, v104
  v_add_f32 v82, v82, v105
  v_add_f32 v82, v82, v106
  v_add_f32 v82, v82, v107
  v_add_f32 v82, v82, v108
  v_add_f32 v82, v82, v109
  v_add_f32 v82, v82, v110
  v_add_f32 v82, v82, v111
  v_cvt_pk_bf16_f32 v88, v96, v97
  v_cvt_pk_bf16_f32 v89, v98, v99
  v_cvt_pk_bf16_f32 v90, v100, v101
  v_cvt_pk_bf16_f32 v91, v102, v103
  v_cvt_pk_bf16_f32 v92, v104, v105
  v_cvt_pk_bf16_f32 v93, v106, v107
  v_cvt_pk_bf16_f32 v94, v108, v109
  v_cvt_pk_bf16_f32 v95, v110, v111
  ds_read_b64_tr_b16 v[112:113], v17
  ds_read_b64_tr_b16 v[114:115], v17 offset:2048
  ds_read_b64_tr_b16 v[116:117], v18
  ds_read_b64_tr_b16 v[118:119], v18 offset:2048
  ds_read_b64_tr_b16 v[120:121], v19
  ds_read_b64_tr_b16 v[122:123], v19 offset:2048
  ds_read_b64_tr_b16 v[124:125], v20
  ds_read_b64_tr_b16 v[126:127], v20 offset:2048
  s_waitcnt lgkmcnt(6)
  v_mfma_f32_32x32x16_bf16 v[128:143], v[112:115], v[88:91], v[128:143]
  s_waitcnt lgkmcnt(4)
  v_mfma_f32_32x32x16_bf16 v[144:159], v[116:119], v[88:91], v[144:159]
  s_waitcnt lgkmcnt(2)
  v_mfma_f32_32x32x16_bf16 v[160:175], v[120:123], v[88:91], v[160:175]
  s_waitcnt lgkmcnt(0)
  v_mfma_f32_32x32x16_bf16 v[176:191], v[124:127], v[88:91], v[176:191]
  s_nop 7
  ds_read_b64_tr_b16 v[112:113], v17 offset:4096
  ds_read_b64_tr_b16 v[114:115], v17 offset:6144
  ds_read_b64_tr_b16 v[116:117], v18 offset:4096
  ds_read_b64_tr_b16 v[118:119], v18 offset:6144
  ds_read_b64_tr_b16 v[120:121], v19 offset:4096
  ds_read_b64_tr_b16 v[122:123], v19 offset:6144
  ds_read_b64_tr_b16 v[124:125], v20 offset:4096
  ds_read_b64_tr_b16 v[126:127], v20 offset:6144
  s_waitcnt lgkmcnt(6)
  v_mfma_f32_32x32x16_bf16 v[128:143], v[112:115], v[92:95], v[128:143]
  s_waitcnt lgkmcnt(4)
  v_mfma_f32_32x32x16_bf16 v[144:159], v[116:119], v[92:95], v[144:159]
  s_waitcnt lgkmcnt(2)
  v_mfma_f32_32x32x16_bf16 v[160:175], v[120:123], v[92:95], v[160:175]
  s_waitcnt lgkmcnt(0)
  v_mfma_f32_32x32x16_bf16 v[176:191], v[124:127], v[92:95], v[176:191]
  s_nop 7
  ds_read_b128 v[112:115], v9 offset:8192
  ds_read_b128 v[116:119], v10 offset:8192
  ds_read_b128 v[120:123], v11 offset:8192
  ds_read_b128 v[124:127], v12 offset:8192
  s_waitcnt lgkmcnt(3)
  v_mfma_f32_32x32x16_bf16 v[96:111], v[112:115], a[192:195], 0
  s_waitcnt lgkmcnt(2)
  v_mfma_f32_32x32x16_bf16 v[96:111], v[116:119], a[196:199], v[96:111]
  s_waitcnt lgkmcnt(1)
  v_mfma_f32_32x32x16_bf16 v[96:111], v[120:123], a[200:203], v[96:111]
  s_waitcnt lgkmcnt(0)
  v_mfma_f32_32x32x16_bf16 v[96:111], v[124:127], a[204:207], v[96:111]
  s_nop 7
  ds_read_b128 v[112:115], v13 offset:8192
  ds_read_b128 v[116:119], v14 offset:8192
  ds_read_b128 v[120:123], v15 offset:8192
  ds_read_b128 v[124:127], v16 offset:8192
  s_waitcnt lgkmcnt(3)
  v_mfma_f32_32x32x16_bf16 v[96:111], v[112:115], a[208:211], v[96:111]
  s_waitcnt lgkmcnt(2)
  v_mfma_f32_32x32x16_bf16 v[96:111], v[116:119], a[212:215], v[96:111]
  s_waitcnt lgkmcnt(1)
  v_mfma_f32_32x32x16_bf16 v[96:111], v[120:123], a[216:219], v[96:111]
  s_waitcnt lgkmcnt(0)
  v_mfma_f32_32x32x16_bf16 v[96:111], v[124:127], a[220:223], v[96:111]
  s_nop 7
  s_nop 3
  v_fma_f32 v96, v96, s20, v81
  v_fma_f32 v97, v97, s20, v81
  v_fma_f32 v98, v98, s20, v81
  v_fma_f32 v99, v99, s20, v81
  v_fma_f32 v100, v100, s20, v81
  v_fma_f32 v101, v101, s20, v81
  v_fma_f32 v102, v102, s20, v81
  v_fma_f32 v103, v103, s20, v81
  v_fma_f32 v104, v104, s20, v81
  v_fma_f32 v105, v105, s20, v81
  v_fma_f32 v106, v106, s20, v81
  v_fma_f32 v107, v107, s20, v81
  v_fma_f32 v108, v108, s20, v81
  v_fma_f32 v109, v109, s20, v81
  v_fma_f32 v110, v110, s20, v81
  v_fma_f32 v111, v111, s20, v81
  v_exp_f32 v96, v96
  v_exp_f32 v97, v97
  v_exp_f32 v98, v98
  v_exp_f32 v99, v99
  v_exp_f32 v100, v100
  v_exp_f32 v101, v101
  v_exp_f32 v102, v102
  v_exp_f32 v103, v103
  v_exp_f32 v104, v104
  v_exp_f32 v105, v105
  v_exp_f32 v106, v106
  v_exp_f32 v107, v107
  v_exp_f32 v108, v108
  v_exp_f32 v109, v109
  v_exp_f32 v110, v110
  v_exp_f32 v111, v111
  v_add_f32 v82, v82, v96
  v_add_f32 v82, v82, v97
  v_add_f32 v82, v82, v98
  v_add_f32 v82, v82, v99
  v_add_f32 v82, v82, v100
  v_add_f32 v82, v82, v101
  v_add_f32 v82, v82, v102
  v_add_f32 v82, v82, v103
  v_add_f32 v82, v82, v104
  v_add_f32 v82, v82, v105
  v_add_f32 v82, v82, v106
  v_add_f32 v82, v82, v107
  v_add_f32 v82, v82, v108
  v_add_f32 v82, v82, v109
  v_add_f32 v82, v82, v110
  v_add_f32 v82, v82, v111
  v_cvt_pk_bf16_f32 v88, v96, v97
  v_cvt_pk_bf16_f32 v89, v98, v99
  v_cvt_pk_bf16_f32 v90, v100, v101
  v_cvt_pk_bf16_f32 v91, v102, v103
  v_cvt_pk_bf16_f32 v92, v104, v105
  v_cvt_pk_bf16_f32 v93, v106, v107
  v_cvt_pk_bf16_f32 v94, v108, v109
  v_cvt_pk_bf16_f32 v95, v110, v111
  ds_read_b64_tr_b16 v[112:113], v17 offset:8192
  ds_read_b64_tr_b16 v[114:115], v17 offset:10240
  ds_read_b64_tr_b16 v[116:117], v18 offset:8192
  ds_read_b64_tr_b16 v[118:119], v18 offset:10240
  ds_read_b64_tr_b16 v[120:121], v19 offset:8192
  ds_read_b64_tr_b16 v[122:123], v19 offset:10240
  ds_read_b64_tr_b16 v[124:125], v20 offset:8192
  ds_read_b64_tr_b16 v[126:127], v20 offset:10240
  s_waitcnt lgkmcnt(6)
  v_mfma_f32_32x32x16_bf16 v[128:143], v[112:115], v[88:91], v[128:143]
  s_waitcnt lgkmcnt(4)
  v_mfma_f32_32x32x16_bf16 v[144:159], v[116:119], v[88:91], v[144:159]
  s_waitcnt lgkmcnt(2)
  v_mfma_f32_32x32x16_bf16 v[160:175], v[120:123], v[88:91], v[160:175]
  s_waitcnt lgkmcnt(0)
  v_mfma_f32_32x32x16_bf16 v[176:191], v[124:127], v[88:91], v[176:191]
  s_nop 7
  ds_read_b64_tr_b16 v[112:113], v17 offset:12288
  ds_read_b64_tr_b16 v[114:115], v17 offset:14336
  ds_read_b64_tr_b16 v[116:117], v18 offset:12288
  ds_read_b64_tr_b16 v[118:119], v18 offset:14336
  ds_read_b64_tr_b16 v[120:121], v19 offset:12288
  ds_read_b64_tr_b16 v[122:123], v19 offset:14336
  ds_read_b64_tr_b16 v[124:125], v20 offset:12288
  ds_read_b64_tr_b16 v[126:127], v20 offset:14336
  s_waitcnt lgkmcnt(6)
  v_mfma_f32_32x32x16_bf16 v[128:143], v[112:115], v[92:95], v[128:143]
  s_waitcnt lgkmcnt(4)
  v_mfma_f32_32x32x16_bf16 v[144:159], v[116:119], v[92:95], v[144:159]
  s_waitcnt lgkmcnt(2)
  v_mfma_f32_32x32x16_bf16 v[160:175], v[120:123], v[92:95], v[160:175]
  s_waitcnt lgkmcnt(0)
  v_mfma_f32_32x32x16_bf16 v[176:191], v[124:127], v[92:95], v[176:191]
  s_nop 7
  ds_read_b128 v[112:115], v9 offset:16384
  ds_read_b128 v[116:119], v10 offset:16384
  ds_read_b128 v[120:123], v11 offset:16384
  ds_read_b128 v[124:127], v12 offset:16384
  s_waitcnt lgkmcnt(3)
  v_mfma_f32_32x32x16_bf16 v[96:111], v[112:115], a[192:195], 0
  s_waitcnt lgkmcnt(2)
  v_mfma_f32_32x32x16_bf16 v[96:111], v[116:119], a[196:199], v[96:111]
  s_waitcnt lgkmcnt(1)
  v_mfma_f32_32x32x16_bf16 v[96:111], v[120:123], a[200:203], v[96:111]
  s_waitcnt lgkmcnt(0)
  v_mfma_f32_32x32x16_bf16 v[96:111], v[124:127], a[204:207], v[96:111]
  s_nop 7
  ds_read_b128 v[112:115], v13 offset:16384
  ds_read_b128 v[116:119], v14 offset:16384
  ds_read_b128 v[120:123], v15 offset:16384
  ds_read_b128 v[124:127], v16 offset:16384
  s_waitcnt lgkmcnt(3)
  v_mfma_f32_32x32x16_bf16 v[96:111], v[112:115], a[208:211], v[96:111]
  s_waitcnt lgkmcnt(2)
  v_mfma_f32_32x32x16_bf16 v[96:111], v[116:119], a[212:215], v[96:111]
  s_waitcnt lgkmcnt(1)
  v_mfma_f32_32x32x16_bf16 v[96:111], v[120:123], a[216:219], v[96:111]
  s_waitcnt lgkmcnt(0)
  v_mfma_f32_32x32x16_bf16 v[96:111], v[124:127], a[220:223], v[96:111]
  s_nop 7
  s_nop 3
  v_fma_f32 v96, v96, s20, v81
  v_fma_f32 v97, v97, s20, v81
  v_fma_f32 v98, v98, s20, v81
  v_fma_f32 v99, v99, s20, v81
  v_fma_f32 v100, v100, s20, v81
  v_fma_f32 v101, v101, s20, v81
  v_fma_f32 v102, v102, s20, v81
  v_fma_f32 v103, v103, s20, v81
  v_fma_f32 v104, v104, s20, v81
  v_fma_f32 v105, v105, s20, v81
  v_fma_f32 v106, v106, s20, v81
  v_fma_f32 v107, v107, s20, v81
  v_fma_f32 v108, v108, s20, v81
  v_fma_f32 v109, v109, s20, v81
  v_fma_f32 v110, v110, s20, v81
  v_fma_f32 v111, v111, s20, v81
  v_exp_f32 v96, v96
  v_exp_f32 v97, v97
  v_exp_f32 v98, v98
  v_exp_f32 v99, v99
  v_exp_f32 v100, v100
  v_exp_f32 v101, v101
  v_exp_f32 v102, v102
  v_exp_f32 v103, v103
  v_exp_f32 v104, v104
  v_exp_f32 v105, v105
  v_exp_f32 v106, v106
  v_exp_f32 v107, v107
  v_exp_f32 v108, v108
  v_exp_f32 v109, v109
  v_exp_f32 v110, v110
  v_exp_f32 v111, v111
  v_add_f32 v82, v82, v96
  v_add_f32 v82, v82, v97
  v_add_f32 v82, v82, v98
  v_add_f32 v82, v82, v99
  v_add_f32 v82, v82, v100
  v_add_f32 v82, v82, v101
  v_add_f32 v82, v82, v102
  v_add_f32 v82, v82, v103
  v_add_f32 v82, v82, v104
  v_add_f32 v82, v82, v105
  v_add_f32 v82, v82, v106
  v_add_f32 v82, v82, v107
  v_add_f32 v82, v82, v108
  v_add_f32 v82, v82, v109
  v_add_f32 v82, v82, v110
  v_add_f32 v82, v82, v111
  v_cvt_pk_bf16_f32 v88, v96, v97
  v_cvt_pk_bf16_f32 v89, v98, v99
  v_cvt_pk_bf16_f32 v90, v100, v101
  v_cvt_pk_bf16_f32 v91, v102, v103
  v_cvt_pk_bf16_f32 v92, v104, v105
  v_cvt_pk_bf16_f32 v93, v106, v107
  v_cvt_pk_bf16_f32 v94, v108, v109
  v_cvt_pk_bf16_f32 v95, v110, v111
  ds_read_b64_tr_b16 v[112:113], v17 offset:16384
  ds_read_b64_tr_b16 v[114:115], v17 offset:18432
  ds_read_b64_tr_b16 v[116:117], v18 offset:16384
  ds_read_b64_tr_b16 v[118:119], v18 offset:18432
  ds_read_b64_tr_b16 v[120:121], v19 offset:16384
  ds_read_b64_tr_b16 v[122:123], v19 offset:18432
  ds_read_b64_tr_b16 v[124:125], v20 offset:16384
  ds_read_b64_tr_b16 v[126:127], v20 offset:18432
  s_waitcnt lgkmcnt(6)
  v_mfma_f32_32x32x16_bf16 v[128:143], v[112:115], v[88:91], v[128:143]
  s_waitcnt lgkmcnt(4)
  v_mfma_f32_32x32x16_bf16 v[144:159], v[116:119], v[88:91], v[144:159]
  s_waitcnt lgkmcnt(2)
  v_mfma_f32_32x32x16_bf16 v[160:175], v[120:123], v[88:91], v[160:175]
  s_waitcnt lgkmcnt(0)
  v_mfma_f32_32x32x16_bf16 v[176:191], v[124:127], v[88:91], v[176:191]
  s_nop 7
  ds_read_b64_tr_b16 v[112:113], v17 offset:20480
  ds_read_b64_tr_b16 v[114:115], v17 offset:22528
  ds_read_b64_tr_b16 v[116:117], v18 offset:20480
  ds_read_b64_tr_b16 v[118:119], v18 offset:22528
  ds_read_b64_tr_b16 v[120:121], v19 offset:20480
  ds_read_b64_tr_b16 v[122:123], v19 offset:22528
  ds_read_b64_tr_b16 v[124:125], v20 offset:20480
  ds_read_b64_tr_b16 v[126:127], v20 offset:22528
  s_waitcnt lgkmcnt(6)
  v_mfma_f32_32x32x16_bf16 v[128:143], v[112:115], v[92:95], v[128:143]
  s_waitcnt lgkmcnt(4)
  v_mfma_f32_32x32x16_bf16 v[144:159], v[116:119], v[92:95], v[144:159]
  s_waitcnt lgkmcnt(2)
  v_mfma_f32_32x32x16_bf16 v[160:175], v[120:123], v[92:95], v[160:175]
  s_waitcnt lgkmcnt(0)
  v_mfma_f32_32x32x16_bf16 v[176:191], v[124:127], v[92:95], v[176:191]
  s_nop 7
  ds_read_b128 v[112:115], v9 offset:24576
  ds_read_b128 v[116:119], v10 offset:24576
  ds_read_b128 v[120:123], v11 offset:24576
  ds_read_b128 v[124:127], v12 offset:24576
  s_waitcnt lgkmcnt(3)
  v_mfma_f32_32x32x16_bf16 v[96:111], v[112:115], a[192:195], 0
  s_waitcnt lgkmcnt(2)
  v_mfma_f32_32x32x16_bf16 v[96:111], v[116:119], a[196:199], v[96:111]
  s_waitcnt lgkmcnt(1)
  v_mfma_f32_32x32x16_bf16 v[96:111], v[120:123], a[200:203], v[96:111]
  s_waitcnt lgkmcnt(0)
  v_mfma_f32_32x32x16_bf16 v[96:111], v[124:127], a[204:207], v[96:111]
  s_nop 7
  ds_read_b128 v[112:115], v13 offset:24576
  ds_read_b128 v[116:119], v14 offset:24576
  ds_read_b128 v[120:123], v15 offset:24576
  ds_read_b128 v[124:127], v16 offset:24576
  s_waitcnt lgkmcnt(3)
  v_mfma_f32_32x32x16_bf16 v[96:111], v[112:115], a[208:211], v[96:111]
  s_waitcnt lgkmcnt(2)
  v_mfma_f32_32x32x16_bf16 v[96:111], v[116:119], a[212:215], v[96:111]
  s_waitcnt lgkmcnt(1)
  v_mfma_f32_32x32x16_bf16 v[96:111], v[120:123], a[216:219], v[96:111]
  s_waitcnt lgkmcnt(0)
  v_mfma_f32_32x32x16_bf16 v[96:111], v[124:127], a[220:223], v[96:111]
  s_nop 7
  s_nop 3
  v_fma_f32 v96, v96, s20, v81
  v_fma_f32 v97, v97, s20, v81
  v_fma_f32 v98, v98, s20, v81
  v_fma_f32 v99, v99, s20, v81
  v_fma_f32 v100, v100, s20, v81
  v_fma_f32 v101, v101, s20, v81
  v_fma_f32 v102, v102, s20, v81
  v_fma_f32 v103, v103, s20, v81
  v_fma_f32 v104, v104, s20, v81
  v_fma_f32 v105, v105, s20, v81
  v_fma_f32 v106, v106, s20, v81
  v_fma_f32 v107, v107, s20, v81
  v_fma_f32 v108, v108, s20, v81
  v_fma_f32 v109, v109, s20, v81
  v_fma_f32 v110, v110, s20, v81
  v_fma_f32 v111, v111, s20, v81
  v_exp_f32 v96, v96
  v_exp_f32 v97, v97
  v_exp_f32 v98, v98
  v_exp_f32 v99, v99
  v_exp_f32 v100, v100
  v_exp_f32 v101, v101
  v_exp_f32 v102, v102
  v_exp_f32 v103, v103
  v_exp_f32 v104, v104
  v_exp_f32 v105, v105
  v_exp_f32 v106, v106
  v_exp_f32 v107, v107
  v_exp_f32 v108, v108
  v_exp_f32 v109, v109
  v_exp_f32 v110, v110
  v_exp_f32 v111, v111
  v_add_f32 v82, v82, v96
  v_add_f32 v82, v82, v97
  v_add_f32 v82, v82, v98
  v_add_f32 v82, v82, v99
  v_add_f32 v82, v82, v100
  v_add_f32 v82, v82, v101
  v_add_f32 v82, v82, v102
  v_add_f32 v82, v82, v103
  v_add_f32 v82, v82, v104
  v_add_f32 v82, v82, v105
  v_add_f32 v82, v82, v106
  v_add_f32 v82, v82, v107
  v_add_f32 v82, v82, v108
  v_add_f32 v82, v82, v109
  v_add_f32 v82, v82, v110
  v_add_f32 v82, v82, v111
  v_cvt_pk_bf16_f32 v88, v96, v97
  v_cvt_pk_bf16_f32 v89, v98, v99
  v_cvt_pk_bf16_f32 v90, v100, v101
  v_cvt_pk_bf16_f32 v91, v102, v103
  v_cvt_pk_bf16_f32 v92, v104, v105
  v_cvt_pk_bf16_f32 v93, v106, v107
  v_cvt_pk_bf16_f32 v94, v108, v109
  v_cvt_pk_bf16_f32 v95, v110, v111
  ds_read_b64_tr_b16 v[112:113], v17 offset:24576
  ds_read_b64_tr_b16 v[114:115], v17 offset:26624
  ds_read_b64_tr_b16 v[116:117], v18 offset:24576
  ds_read_b64_tr_b16 v[118:119], v18 offset:26624
  ds_read_b64_tr_b16 v[120:121], v19 offset:24576
  ds_read_b64_tr_b16 v[122:123], v19 offset:26624
  ds_read_b64_tr_b16 v[124:125], v20 offset:24576
  ds_read_b64_tr_b16 v[126:127], v20 offset:26624
  s_waitcnt lgkmcnt(6)
  v_mfma_f32_32x32x16_bf16 v[128:143], v[112:115], v[88:91], v[128:143]
  s_waitcnt lgkmcnt(4)
  v_mfma_f32_32x32x16_bf16 v[144:159], v[116:119], v[88:91], v[144:159]
  s_waitcnt lgkmcnt(2)
  v_mfma_f32_32x32x16_bf16 v[160:175], v[120:123], v[88:91], v[160:175]
  s_waitcnt lgkmcnt(0)
  v_mfma_f32_32x32x16_bf16 v[176:191], v[124:127], v[88:91], v[176:191]
  s_nop 7
  ds_read_b64_tr_b16 v[112:113], v17 offset:28672
  ds_read_b64_tr_b16 v[114:115], v17 offset:30720
  ds_read_b64_tr_b16 v[116:117], v18 offset:28672
  ds_read_b64_tr_b16 v[118:119], v18 offset:30720
  ds_read_b64_tr_b16 v[120:121], v19 offset:28672
  ds_read_b64_tr_b16 v[122:123], v19 offset:30720
  ds_read_b64_tr_b16 v[124:125], v20 offset:28672
  ds_read_b64_tr_b16 v[126:127], v20 offset:30720
  s_waitcnt lgkmcnt(6)
  v_mfma_f32_32x32x16_bf16 v[128:143], v[112:115], v[92:95], v[128:143]
  s_waitcnt lgkmcnt(4)
  v_mfma_f32_32x32x16_bf16 v[144:159], v[116:119], v[92:95], v[144:159]
  s_waitcnt lgkmcnt(2)
  v_mfma_f32_32x32x16_bf16 v[160:175], v[120:123], v[92:95], v[160:175]
  s_waitcnt lgkmcnt(0)
  v_mfma_f32_32x32x16_bf16 v[176:191], v[124:127], v[92:95], v[176:191]
  s_nop 7
  v_mov_b32 v83, v82
  s_nop 1
  v_permlane32_swap_b32 v82, v83
  v_add_f32 v40, v82, v83
  v_rcp_f32 v40, v40
  s_nop 7
  s_nop 7
  buffer_load_dwordx4 v[80:83], v41, s[52:55], 0 offen
  buffer_load_dwordx4 v[84:87], v41, s[52:55], 0 offen offset:1024
  buffer_load_dwordx4 v[88:91], v41, s[52:55], 0 offen offset:2048
  buffer_load_dwordx4 v[92:95], v41, s[52:55], 0 offen offset:3072
  buffer_load_dwordx4 v[96:99], v41, s[52:55], s44 offen
  buffer_load_dwordx4 v[100:103], v41, s[52:55], s44 offen offset:1024
  buffer_load_dwordx4 v[104:107], v41, s[52:55], s44 offen offset:2048
  buffer_load_dwordx4 v[108:111], v41, s[52:55], s44 offen offset:3072
  buffer_load_dwordx4 v[112:115], v41, s[52:55], s35 offen
  buffer_load_dwordx4 v[116:119], v41, s[52:55], s35 offen offset:1024
  buffer_load_dwordx4 v[120:123], v41, s[52:55], s35 offen offset:2048
  buffer_load_dwordx4 v[124:127], v41, s[52:55], s35 offen offset:3072
  s_waitcnt vmcnt(0)
  s_setpc_b64 s[32:33]
L_SLOW1:
  s_waitcnt lgkmcnt(0)
  s_nop 7
  s_nop 7
  s_load_dwordx2 s[52:53], s[0:1], 40
  v_mbcnt_lo_u32_b32 v41, -1, 0
  v_mbcnt_hi_u32_b32 v41, -1, v41
  v_lshlrev_b32 v41, 4, v41
  s_lshl_b32 s34, s2, 2
  s_add_u32 s34, s34, s22
  s_mul_i32 s34, s34, 0x3000
  s_mov_b32 s54, 0x3000
  s_mov_b32 s55, 0x20000
  s_mov_b32 s35, 0x2000
  s_waitcnt lgkmcnt(0)
  s_add_u32 s52, s52, s34
  s_addc_u32 s53, s53, 0
  s_nop 3
  buffer_store_dwordx4 v[80:83], v41, s[52:55], 0 offen
  buffer_store_dwordx4 v[84:87], v41, s[52:55], 0 offen offset:1024
  buffer_store_dwordx4 v[88:91], v41, s[52:55], 0 offen offset:2048
  buffer_store_dwordx4 v[92:95], v41, s[52:55], 0 offen offset:3072
  buffer_store_dwordx4 v[96:99], v41, s[52:55], s44 offen
  buffer_store_dwordx4 v[100:103], v41, s[52:55], s44 offen offset:1024
  buffer_store_dwordx4 v[104:107], v41, s[52:55], s44 offen offset:2048
  buffer_store_dwordx4 v[108:111], v41, s[52:55], s44 offen offset:3072
  buffer_store_dwordx4 v[112:115], v41, s[52:55], s35 offen
  buffer_store_dwordx4 v[116:119], v41, s[52:55], s35 offen offset:1024
  buffer_store_dwordx4 v[120:123], v41, s[52:55], s35 offen offset:2048
  buffer_store_dwordx4 v[124:127], v41, s[52:55], s35 offen offset:3072
  s_waitcnt vmcnt(0)
  ds_read_b128 v[112:115], v1
  ds_read_b128 v[116:119], v2
  ds_read_b128 v[120:123], v3
  ds_read_b128 v[124:127], v4
  s_waitcnt lgkmcnt(3)
  v_mfma_f32_32x32x16_bf16 v[96:111], v[112:115], a[224:227], 0
  s_waitcnt lgkmcnt(2)
  v_mfma_f32_32x32x16_bf16 v[96:111], v[116:119], a[228:231], v[96:111]
  s_waitcnt lgkmcnt(1)
  v_mfma_f32_32x32x16_bf16 v[96:111], v[120:123], a[232:235], v[96:111]
  s_waitcnt lgkmcnt(0)
  v_mfma_f32_32x32x16_bf16 v[96:111], v[124:127], a[236:239], v[96:111]
  s_nop 7
  ds_read_b128 v[112:115], v5
  ds_read_b128 v[116:119], v6
  ds_read_b128 v[120:123], v7
  ds_read_b128 v[124:127], v8
  s_waitcnt lgkmcnt(3)
  v_mfma_f32_32x32x16_bf16 v[96:111], v[112:115], a[240:243], v[96:111]
  s_waitcnt lgkmcnt(2)
  v_mfma_f32_32x32x16_bf16 v[96:111], v[116:119], a[244:247], v[96:111]
  s_waitcnt lgkmcnt(1)
  v_mfma_f32_32x32x16_bf16 v[96:111], v[120:123], a[248:251], v[96:111]
  s_waitcnt lgkmcnt(0)
  v_mfma_f32_32x32x16_bf16 v[96:111], v[124:127], a[252:255], v[96:111]
  s_nop 7
  s_nop 3
  v_max_f32 v80, v96, v97
  v_max3_f32 v80, v80, v98, v99
  v_max3_f32 v80, v80, v100, v101
  v_max3_f32 v80, v80, v102, v103
  v_max3_f32 v80, v80, v104, v105
  v_max3_f32 v80, v80, v106, v107
  v_max3_f32 v80, v80, v108, v109
  v_max3_f32 v80, v80, v110, v111
  ds_read_b128 v[112:115], v1 offset:8192
  ds_read_b128 v[116:119], v2 offset:8192
  ds_read_b128 v[120:123], v3 offset:8192
  ds_read_b128 v[124:127], v4 offset:8192
  s_waitcnt lgkmcnt(3)
  v_mfma_f32_32x32x16_bf16 v[96:111], v[112:115], a[224:227], 0
  s_waitcnt lgkmcnt(2)
  v_mfma_f32_32x32x16_bf16 v[96:111], v[116:119], a[228:231], v[96:111]
  s_waitcnt lgkmcnt(1)
  v_mfma_f32_32x32x16_bf16 v[96:111], v[120:123], a[232:235], v[96:111]
  s_waitcnt lgkmcnt(0)
  v_mfma_f32_32x32x16_bf16 v[96:111], v[124:127], a[236:239], v[96:111]
  s_nop 7
  ds_read_b128 v[112:115], v5 offset:8192
  ds_read_b128 v[116:119], v6 offset:8192
  ds_read_b128 v[120:123], v7 offset:8192
  ds_read_b128 v[124:127], v8 offset:8192
  s_waitcnt lgkmcnt(3)
  v_mfma_f32_32x32x16_bf16 v[96:111], v[112:115], a[240:243], v[96:111]
  s_waitcnt lgkmcnt(2)
  v_mfma_f32_32x32x16_bf16 v[96:111], v[116:119], a[244:247], v[96:111]
  s_waitcnt lgkmcnt(1)
  v_mfma_f32_32x32x16_bf16 v[96:111], v[120:123], a[248:251], v[96:111]
  s_waitcnt lgkmcnt(0)
  v_mfma_f32_32x32x16_bf16 v[96:111], v[124:127], a[252:255], v[96:111]
  s_nop 7
  s_nop 3
  v_max3_f32 v80, v80, v96, v97
  v_max3_f32 v80, v80, v98, v99
  v_max3_f32 v80, v80, v100, v101
  v_max3_f32 v80, v80, v102, v103
  v_max3_f32 v80, v80, v104, v105
  v_max3_f32 v80, v80, v106, v107
  v_max3_f32 v80, v80, v108, v109
  v_max3_f32 v80, v80, v110, v111
  ds_read_b128 v[112:115], v1 offset:16384
  ds_read_b128 v[116:119], v2 offset:16384
  ds_read_b128 v[120:123], v3 offset:16384
  ds_read_b128 v[124:127], v4 offset:16384
  s_waitcnt lgkmcnt(3)
  v_mfma_f32_32x32x16_bf16 v[96:111], v[112:115], a[224:227], 0
  s_waitcnt lgkmcnt(2)
  v_mfma_f32_32x32x16_bf16 v[96:111], v[116:119], a[228:231], v[96:111]
  s_waitcnt lgkmcnt(1)
  v_mfma_f32_32x32x16_bf16 v[96:111], v[120:123], a[232:235], v[96:111]
  s_waitcnt lgkmcnt(0)
  v_mfma_f32_32x32x16_bf16 v[96:111], v[124:127], a[236:239], v[96:111]
  s_nop 7
  ds_read_b128 v[112:115], v5 offset:16384
  ds_read_b128 v[116:119], v6 offset:16384
  ds_read_b128 v[120:123], v7 offset:16384
  ds_read_b128 v[124:127], v8 offset:16384
  s_waitcnt lgkmcnt(3)
  v_mfma_f32_32x32x16_bf16 v[96:111], v[112:115], a[240:243], v[96:111]
  s_waitcnt lgkmcnt(2)
  v_mfma_f32_32x32x16_bf16 v[96:111], v[116:119], a[244:247], v[96:111]
  s_waitcnt lgkmcnt(1)
  v_mfma_f32_32x32x16_bf16 v[96:111], v[120:123], a[248:251], v[96:111]
  s_waitcnt lgkmcnt(0)
  v_mfma_f32_32x32x16_bf16 v[96:111], v[124:127], a[252:255], v[96:111]
  s_nop 7
  s_nop 3
  v_max3_f32 v80, v80, v96, v97
  v_max3_f32 v80, v80, v98, v99
  v_max3_f32 v80, v80, v100, v101
  v_max3_f32 v80, v80, v102, v103
  v_max3_f32 v80, v80, v104, v105
  v_max3_f32 v80, v80, v106, v107
  v_max3_f32 v80, v80, v108, v109
  v_max3_f32 v80, v80, v110, v111
  ds_read_b128 v[112:115], v1 offset:24576
  ds_read_b128 v[116:119], v2 offset:24576
  ds_read_b128 v[120:123], v3 offset:24576
  ds_read_b128 v[124:127], v4 offset:24576
  s_waitcnt lgkmcnt(3)
  v_mfma_f32_32x32x16_bf16 v[96:111], v[112:115], a[224:227], 0
  s_waitcnt lgkmcnt(2)
  v_mfma_f32_32x32x16_bf16 v[96:111], v[116:119], a[228:231], v[96:111]
  s_waitcnt lgkmcnt(1)
  v_mfma_f32_32x32x16_bf16 v[96:111], v[120:123], a[232:235], v[96:111]
  s_waitcnt lgkmcnt(0)
  v_mfma_f32_32x32x16_bf16 v[96:111], v[124:127], a[236:239], v[96:111]
  s_nop 7
  ds_read_b128 v[112:115], v5 offset:24576
  ds_read_b128 v[116:119], v6 offset:24576
  ds_read_b128 v[120:123], v7 offset:24576
  ds_read_b128 v[124:127], v8 offset:24576
  s_waitcnt lgkmcnt(3)
  v_mfma_f32_32x32x16_bf16 v[96:111], v[112:115], a[240:243], v[96:111]
  s_waitcnt lgkmcnt(2)
  v_mfma_f32_32x32x16_bf16 v[96:111], v[116:119], a[244:247], v[96:111]
  s_waitcnt lgkmcnt(1)
  v_mfma_f32_32x32x16_bf16 v[96:111], v[120:123], a[248:251], v[96:111]
  s_waitcnt lgkmcnt(0)
  v_mfma_f32_32x32x16_bf16 v[96:111], v[124:127], a[252:255], v[96:111]
  s_nop 7
  s_nop 3
  v_max3_f32 v80, v80, v96, v97
  v_max3_f32 v80, v80, v98, v99
  v_max3_f32 v80, v80, v100, v101
  v_max3_f32 v80, v80, v102, v103
  v_max3_f32 v80, v80, v104, v105
  v_max3_f32 v80, v80, v106, v107
  v_max3_f32 v80, v80, v108, v109
  v_max3_f32 v80, v80, v110, v111
  ds_read_b128 v[112:115], v1 offset:32768
  ds_read_b128 v[116:119], v2 offset:32768
  ds_read_b128 v[120:123], v3 offset:32768
  ds_read_b128 v[124:127], v4 offset:32768
  s_waitcnt lgkmcnt(3)
  v_mfma_f32_32x32x16_bf16 v[96:111], v[112:115], a[224:227], 0
  s_waitcnt lgkmcnt(2)
  v_mfma_f32_32x32x16_bf16 v[96:111], v[116:119], a[228:231], v[96:111]
  s_waitcnt lgkmcnt(1)
  v_mfma_f32_32x32x16_bf16 v[96:111], v[120:123], a[232:235], v[96:111]
  s_waitcnt lgkmcnt(0)
  v_mfma_f32_32x32x16_bf16 v[96:111], v[124:127], a[236:239], v[96:111]
  s_nop 7
  ds_read_b128 v[112:115], v5 offset:32768
  ds_read_b128 v[116:119], v6 offset:32768
  ds_read_b128 v[120:123], v7 offset:32768
  ds_read_b128 v[124:127], v8 offset:32768
  s_waitcnt lgkmcnt(3)
  v_mfma_f32_32x32x16_bf16 v[96:111], v[112:115], a[240:243], v[96:111]
  s_waitcnt lgkmcnt(2)
  v_mfma_f32_32x32x16_bf16 v[96:111], v[116:119], a[244:247], v[96:111]
  s_waitcnt lgkmcnt(1)
  v_mfma_f32_32x32x16_bf16 v[96:111], v[120:123], a[248:251], v[96:111]
  s_waitcnt lgkmcnt(0)
  v_mfma_f32_32x32x16_bf16 v[96:111], v[124:127], a[252:255], v[96:111]
  s_nop 7
  s_nop 3
  v_max3_f32 v80, v80, v96, v97
  v_max3_f32 v80, v80, v98, v99
  v_max3_f32 v80, v80, v100, v101
  v_max3_f32 v80, v80, v102, v103
  v_max3_f32 v80, v80, v104, v105
  v_max3_f32 v80, v80, v106, v107
  v_max3_f32 v80, v80, v108, v109
  v_max3_f32 v80, v80, v110, v111
  ds_read_b128 v[112:115], v1 offset:40960
  ds_read_b128 v[116:119], v2 offset:40960
  ds_read_b128 v[120:123], v3 offset:40960
  ds_read_b128 v[124:127], v4 offset:40960
  s_waitcnt lgkmcnt(3)
  v_mfma_f32_32x32x16_bf16 v[96:111], v[112:115], a[224:227], 0
  s_waitcnt lgkmcnt(2)
  v_mfma_f32_32x32x16_bf16 v[96:111], v[116:119], a[228:231], v[96:111]
  s_waitcnt lgkmcnt(1)
  v_mfma_f32_32x32x16_bf16 v[96:111], v[120:123], a[232:235], v[96:111]
  s_waitcnt lgkmcnt(0)
  v_mfma_f32_32x32x16_bf16 v[96:111], v[124:127], a[236:239], v[96:111]
  s_nop 7
  ds_read_b128 v[112:115], v5 offset:40960
  ds_read_b128 v[116:119], v6 offset:40960
  ds_read_b128 v[120:123], v7 offset:40960
  ds_read_b128 v[124:127], v8 offset:40960
  s_waitcnt lgkmcnt(3)
  v_mfma_f32_32x32x16_bf16 v[96:111], v[112:115], a[240:243], v[96:111]
  s_waitcnt lgkmcnt(2)
  v_mfma_f32_32x32x16_bf16 v[96:111], v[116:119], a[244:247], v[96:111]
  s_waitcnt lgkmcnt(1)
  v_mfma_f32_32x32x16_bf16 v[96:111], v[120:123], a[248:251], v[96:111]
  s_waitcnt lgkmcnt(0)
  v_mfma_f32_32x32x16_bf16 v[96:111], v[124:127], a[252:255], v[96:111]
  s_nop 7
  s_nop 3
  v_max3_f32 v80, v80, v96, v97
  v_max3_f32 v80, v80, v98, v99
  v_max3_f32 v80, v80, v100, v101
  v_max3_f32 v80, v80, v102, v103
  v_max3_f32 v80, v80, v104, v105
  v_max3_f32 v80, v80, v106, v107
  v_max3_f32 v80, v80, v108, v109
  v_max3_f32 v80, v80, v110, v111
  ds_read_b128 v[112:115], v1 offset:49152
  ds_read_b128 v[116:119], v2 offset:49152
  ds_read_b128 v[120:123], v3 offset:49152
  ds_read_b128 v[124:127], v4 offset:49152
  s_waitcnt lgkmcnt(3)
  v_mfma_f32_32x32x16_bf16 v[96:111], v[112:115], a[224:227], 0
  s_waitcnt lgkmcnt(2)
  v_mfma_f32_32x32x16_bf16 v[96:111], v[116:119], a[228:231], v[96:111]
  s_waitcnt lgkmcnt(1)
  v_mfma_f32_32x32x16_bf16 v[96:111], v[120:123], a[232:235], v[96:111]
  s_waitcnt lgkmcnt(0)
  v_mfma_f32_32x32x16_bf16 v[96:111], v[124:127], a[236:239], v[96:111]
  s_nop 7
  ds_read_b128 v[112:115], v5 offset:49152
  ds_read_b128 v[116:119], v6 offset:49152
  ds_read_b128 v[120:123], v7 offset:49152
  ds_read_b128 v[124:127], v8 offset:49152
  s_waitcnt lgkmcnt(3)
  v_mfma_f32_32x32x16_bf16 v[96:111], v[112:115], a[240:243], v[96:111]
  s_waitcnt lgkmcnt(2)
  v_mfma_f32_32x32x16_bf16 v[96:111], v[116:119], a[244:247], v[96:111]
  s_waitcnt lgkmcnt(1)
  v_mfma_f32_32x32x16_bf16 v[96:111], v[120:123], a[248:251], v[96:111]
  s_waitcnt lgkmcnt(0)
  v_mfma_f32_32x32x16_bf16 v[96:111], v[124:127], a[252:255], v[96:111]
  s_nop 7
  s_nop 3
  v_max3_f32 v80, v80, v96, v97
  v_max3_f32 v80, v80, v98, v99
  v_max3_f32 v80, v80, v100, v101
  v_max3_f32 v80, v80, v102, v103
  v_max3_f32 v80, v80, v104, v105
  v_max3_f32 v80, v80, v106, v107
  v_max3_f32 v80, v80, v108, v109
  v_max3_f32 v80, v80, v110, v111
  ds_read_b128 v[112:115], v1 offset:57344
  ds_read_b128 v[116:119], v2 offset:57344
  ds_read_b128 v[120:123], v3 offset:57344
  ds_read_b128 v[124:127], v4 offset:57344
  s_waitcnt lgkmcnt(3)
  v_mfma_f32_32x32x16_bf16 v[96:111], v[112:115], a[224:227], 0
  s_waitcnt lgkmcnt(2)
  v_mfma_f32_32x32x16_bf16 v[96:111], v[116:119], a[228:231], v[96:111]
  s_waitcnt lgkmcnt(1)
  v_mfma_f32_32x32x16_bf16 v[96:111], v[120:123], a[232:235], v[96:111]
  s_waitcnt lgkmcnt(0)
  v_mfma_f32_32x32x16_bf16 v[96:111], v[124:127], a[236:239], v[96:111]
  s_nop 7
  ds_read_b128 v[112:115], v5 offset:57344
  ds_read_b128 v[116:119], v6 offset:57344
  ds_read_b128 v[120:123], v7 offset:57344
  ds_read_b128 v[124:127], v8 offset:57344
  s_waitcnt lgkmcnt(3)
  v_mfma_f32_32x32x16_bf16 v[96:111], v[112:115], a[240:243], v[96:111]
  s_waitcnt lgkmcnt(2)
  v_mfma_f32_32x32x16_bf16 v[96:111], v[116:119], a[244:247], v[96:111]
  s_waitcnt lgkmcnt(1)
  v_mfma_f32_32x32x16_bf16 v[96:111], v[120:123], a[248:251], v[96:111]
  s_waitcnt lgkmcnt(0)
  v_mfma_f32_32x32x16_bf16 v[96:111], v[124:127], a[252:255], v[96:111]
  s_nop 7
  s_nop 3
  v_max3_f32 v80, v80, v96, v97
  v_max3_f32 v80, v80, v98, v99
  v_max3_f32 v80, v80, v100, v101
  v_max3_f32 v80, v80, v102, v103
  v_max3_f32 v80, v80, v104, v105
  v_max3_f32 v80, v80, v106, v107
  v_max3_f32 v80, v80, v108, v109
  v_max3_f32 v80, v80, v110, v111
  ds_read_b128 v[112:115], v9
  ds_read_b128 v[116:119], v10
  ds_read_b128 v[120:123], v11
  ds_read_b128 v[124:127], v12
  s_waitcnt lgkmcnt(3)
  v_mfma_f32_32x32x16_bf16 v[96:111], v[112:115], a[224:227], 0
  s_waitcnt lgkmcnt(2)
  v_mfma_f32_32x32x16_bf16 v[96:111], v[116:119], a[228:231], v[96:111]
  s_waitcnt lgkmcnt(1)
  v_mfma_f32_32x32x16_bf16 v[96:111], v[120:123], a[232:235], v[96:111]
  s_waitcnt lgkmcnt(0)
  v_mfma_f32_32x32x16_bf16 v[96:111], v[124:127], a[236:239], v[96:111]
  s_nop 7
  ds_read_b128 v[112:115], v13
  ds_read_b128 v[116:119], v14
  ds_read_b128 v[120:123], v15
  ds_read_b128 v[124:127], v16
  s_waitcnt lgkmcnt(3)
  v_mfma_f32_32x32x16_bf16 v[96:111], v[112:115], a[240:243], v[96:111]
  s_waitcnt lgkmcnt(2)
  v_mfma_f32_32x32x16_bf16 v[96:111], v[116:119], a[244:247], v[96:111]
  s_waitcnt lgkmcnt(1)
  v_mfma_f32_32x32x16_bf16 v[96:111], v[120:123], a[248:251], v[96:111]
  s_waitcnt lgkmcnt(0)
  v_mfma_f32_32x32x16_bf16 v[96:111], v[124:127], a[252:255], v[96:111]
  s_nop 7
  s_nop 3
  v_max3_f32 v80, v80, v96, v97
  v_max3_f32 v80, v80, v98, v99
  v_max3_f32 v80, v80, v100, v101
  v_max3_f32 v80, v80, v102, v103
  v_max3_f32 v80, v80, v104, v105
  v_max3_f32 v80, v80, v106, v107
  v_max3_f32 v80, v80, v108, v109
  v_max3_f32 v80, v80, v110, v111
  ds_read_b128 v[112:115], v9 offset:8192
  ds_read_b128 v[116:119], v10 offset:8192
  ds_read_b128 v[120:123], v11 offset:8192
  ds_read_b128 v[124:127], v12 offset:8192
  s_waitcnt lgkmcnt(3)
  v_mfma_f32_32x32x16_bf16 v[96:111], v[112:115], a[224:227], 0
  s_waitcnt lgkmcnt(2)
  v_mfma_f32_32x32x16_bf16 v[96:111], v[116:119], a[228:231], v[96:111]
  s_waitcnt lgkmcnt(1)
  v_mfma_f32_32x32x16_bf16 v[96:111], v[120:123], a[232:235], v[96:111]
  s_waitcnt lgkmcnt(0)
  v_mfma_f32_32x32x16_bf16 v[96:111], v[124:127], a[236:239], v[96:111]
  s_nop 7
  ds_read_b128 v[112:115], v13 offset:8192
  ds_read_b128 v[116:119], v14 offset:8192
  ds_read_b128 v[120:123], v15 offset:8192
  ds_read_b128 v[124:127], v16 offset:8192
  s_waitcnt lgkmcnt(3)
  v_mfma_f32_32x32x16_bf16 v[96:111], v[112:115], a[240:243], v[96:111]
  s_waitcnt lgkmcnt(2)
  v_mfma_f32_32x32x16_bf16 v[96:111], v[116:119], a[244:247], v[96:111]
  s_waitcnt lgkmcnt(1)
  v_mfma_f32_32x32x16_bf16 v[96:111], v[120:123], a[248:251], v[96:111]
  s_waitcnt lgkmcnt(0)
  v_mfma_f32_32x32x16_bf16 v[96:111], v[124:127], a[252:255], v[96:111]
  s_nop 7
  s_nop 3
  v_max3_f32 v80, v80, v96, v97
  v_max3_f32 v80, v80, v98, v99
  v_max3_f32 v80, v80, v100, v101
  v_max3_f32 v80, v80, v102, v103
  v_max3_f32 v80, v80, v104, v105
  v_max3_f32 v80, v80, v106, v107
  v_max3_f32 v80, v80, v108, v109
  v_max3_f32 v80, v80, v110, v111
  ds_read_b128 v[112:115], v9 offset:16384
  ds_read_b128 v[116:119], v10 offset:16384
  ds_read_b128 v[120:123], v11 offset:16384
  ds_read_b128 v[124:127], v12 offset:16384
  s_waitcnt lgkmcnt(3)
  v_mfma_f32_32x32x16_bf16 v[96:111], v[112:115], a[224:227], 0
  s_waitcnt lgkmcnt(2)
  v_mfma_f32_32x32x16_bf16 v[96:111], v[116:119], a[228:231], v[96:111]
  s_waitcnt lgkmcnt(1)
  v_mfma_f32_32x32x16_bf16 v[96:111], v[120:123], a[232:235], v[96:111]
  s_waitcnt lgkmcnt(0)
  v_mfma_f32_32x32x16_bf16 v[96:111], v[124:127], a[236:239], v[96:111]
  s_nop 7
  ds_read_b128 v[112:115], v13 offset:16384
  ds_read_b128 v[116:119], v14 offset:16384
  ds_read_b128 v[120:123], v15 offset:16384
  ds_read_b128 v[124:127], v16 offset:16384
  s_waitcnt lgkmcnt(3)
  v_mfma_f32_32x32x16_bf16 v[96:111], v[112:115], a[240:243], v[96:111]
  s_waitcnt lgkmcnt(2)
  v_mfma_f32_32x32x16_bf16 v[96:111], v[116:119], a[244:247], v[96:111]
  s_waitcnt lgkmcnt(1)
  v_mfma_f32_32x32x16_bf16 v[96:111], v[120:123], a[248:251], v[96:111]
  s_waitcnt lgkmcnt(0)
  v_mfma_f32_32x32x16_bf16 v[96:111], v[124:127], a[252:255], v[96:111]
  s_nop 7
  s_nop 3
  v_max3_f32 v80, v80, v96, v97
  v_max3_f32 v80, v80, v98, v99
  v_max3_f32 v80, v80, v100, v101
  v_max3_f32 v80, v80, v102, v103
  v_max3_f32 v80, v80, v104, v105
  v_max3_f32 v80, v80, v106, v107
  v_max3_f32 v80, v80, v108, v109
  v_max3_f32 v80, v80, v110, v111
  ds_read_b128 v[112:115], v9 offset:24576
  ds_read_b128 v[116:119], v10 offset:24576
  ds_read_b128 v[120:123], v11 offset:24576
  ds_read_b128 v[124:127], v12 offset:24576
  s_waitcnt lgkmcnt(3)
  v_mfma_f32_32x32x16_bf16 v[96:111], v[112:115], a[224:227], 0
  s_waitcnt lgkmcnt(2)
  v_mfma_f32_32x32x16_bf16 v[96:111], v[116:119], a[228:231], v[96:111]
  s_waitcnt lgkmcnt(1)
  v_mfma_f32_32x32x16_bf16 v[96:111], v[120:123], a[232:235], v[96:111]
  s_waitcnt lgkmcnt(0)
  v_mfma_f32_32x32x16_bf16 v[96:111], v[124:127], a[236:239], v[96:111]
  s_nop 7
  ds_read_b128 v[112:115], v13 offset:24576
  ds_read_b128 v[116:119], v14 offset:24576
  ds_read_b128 v[120:123], v15 offset:24576
  ds_read_b128 v[124:127], v16 offset:24576
  s_waitcnt lgkmcnt(3)
  v_mfma_f32_32x32x16_bf16 v[96:111], v[112:115], a[240:243], v[96:111]
  s_waitcnt lgkmcnt(2)
  v_mfma_f32_32x32x16_bf16 v[96:111], v[116:119], a[244:247], v[96:111]
  s_waitcnt lgkmcnt(1)
  v_mfma_f32_32x32x16_bf16 v[96:111], v[120:123], a[248:251], v[96:111]
  s_waitcnt lgkmcnt(0)
  v_mfma_f32_32x32x16_bf16 v[96:111], v[124:127], a[252:255], v[96:111]
  s_nop 7
  s_nop 3
  v_max3_f32 v80, v80, v96, v97
  v_max3_f32 v80, v80, v98, v99
  v_max3_f32 v80, v80, v100, v101
  v_max3_f32 v80, v80, v102, v103
  v_max3_f32 v80, v80, v104, v105
  v_max3_f32 v80, v80, v106, v107
  v_max3_f32 v80, v80, v108, v109
  v_max3_f32 v80, v80, v110, v111
  v_mov_b32 v83, v80
  s_nop 1
  v_permlane32_swap_b32 v80, v83
  v_max_f32 v80, v80, v83
  v_mul_f32 v81, s23, v80
  v_mov_b32 v82, 0
  ds_read_b128 v[112:115], v1
  ds_read_b128 v[116:119], v2
  ds_read_b128 v[120:123], v3
  ds_read_b128 v[124:127], v4
  s_waitcnt lgkmcnt(3)
  v_mfma_f32_32x32x16_bf16 v[96:111], v[112:115], a[224:227], 0
  s_waitcnt lgkmcnt(2)
  v_mfma_f32_32x32x16_bf16 v[96:111], v[116:119], a[228:231], v[96:111]
  s_waitcnt lgkmcnt(1)
  v_mfma_f32_32x32x16_bf16 v[96:111], v[120:123], a[232:235], v[96:111]
  s_waitcnt lgkmcnt(0)
  v_mfma_f32_32x32x16_bf16 v[96:111], v[124:127], a[236:239], v[96:111]
  s_nop 7
  ds_read_b128 v[112:115], v5
  ds_read_b128 v[116:119], v6
  ds_read_b128 v[120:123], v7
  ds_read_b128 v[124:127], v8
  s_waitcnt lgkmcnt(3)
  v_mfma_f32_32x32x16_bf16 v[96:111], v[112:115], a[240:243], v[96:111]
  s_waitcnt lgkmcnt(2)
  v_mfma_f32_32x32x16_bf16 v[96:111], v[116:119], a[244:247], v[96:111]
  s_waitcnt lgkmcnt(1)
  v_mfma_f32_32x32x16_bf16 v[96:111], v[120:123], a[248:251], v[96:111]
  s_waitcnt lgkmcnt(0)
  v_mfma_f32_32x32x16_bf16 v[96:111], v[124:127], a[252:255], v[96:111]
  s_nop 7
  s_nop 3
  v_fma_f32 v96, v96, s20, v81
  v_fma_f32 v97, v97, s20, v81
  v_fma_f32 v98, v98, s20, v81
  v_fma_f32 v99, v99, s20, v81
  v_fma_f32 v100, v100, s20, v81
  v_fma_f32 v101, v101, s20, v81
  v_fma_f32 v102, v102, s20, v81
  v_fma_f32 v103, v103, s20, v81
  v_fma_f32 v104, v104, s20, v81
  v_fma_f32 v105, v105, s20, v81
  v_fma_f32 v106, v106, s20, v81
  v_fma_f32 v107, v107, s20, v81
  v_fma_f32 v108, v108, s20, v81
  v_fma_f32 v109, v109, s20, v81
  v_fma_f32 v110, v110, s20, v81
  v_fma_f32 v111, v111, s20, v81
  v_exp_f32 v96, v96
  v_exp_f32 v97, v97
  v_exp_f32 v98, v98
  v_exp_f32 v99, v99
  v_exp_f32 v100, v100
  v_exp_f32 v101, v101
  v_exp_f32 v102, v102
  v_exp_f32 v103, v103
  v_exp_f32 v104, v104
  v_exp_f32 v105, v105
  v_exp_f32 v106, v106
  v_exp_f32 v107, v107
  v_exp_f32 v108, v108
  v_exp_f32 v109, v109
  v_exp_f32 v110, v110
  v_exp_f32 v111, v111
  v_add_f32 v82, v82, v96
  v_add_f32 v82, v82, v97
  v_add_f32 v82, v82, v98
  v_add_f32 v82, v82, v99
  v_add_f32 v82, v82, v100
  v_add_f32 v82, v82, v101
  v_add_f32 v82, v82, v102
  v_add_f32 v82, v82, v103
  v_add_f32 v82, v82, v104
  v_add_f32 v82, v82, v105
  v_add_f32 v82, v82, v106
  v_add_f32 v82, v82, v107
  v_add_f32 v82, v82, v108
  v_add_f32 v82, v82, v109
  v_add_f32 v82, v82, v110
  v_add_f32 v82, v82, v111
  v_cvt_pk_bf16_f32 v88, v96, v97
  v_cvt_pk_bf16_f32 v89, v98, v99
  v_cvt_pk_bf16_f32 v90, v100, v101
  v_cvt_pk_bf16_f32 v91, v102, v103
  v_cvt_pk_bf16_f32 v92, v104, v105
  v_cvt_pk_bf16_f32 v93, v106, v107
  v_cvt_pk_bf16_f32 v94, v108, v109
  v_cvt_pk_bf16_f32 v95, v110, v111
  v_mfma_f32_32x32x16_bf16 v[192:207], a[0:3], v[88:91], 0
  v_mfma_f32_32x32x16_bf16 v[208:223], a[4:7], v[88:91], 0
  v_mfma_f32_32x32x16_bf16 v[224:239], a[8:11], v[88:91], 0
  v_mfma_f32_32x32x16_bf16 v[240:255], a[12:15], v[88:91], 0
  s_nop 7
  v_mfma_f32_32x32x16_bf16 v[192:207], a[16:19], v[92:95], v[192:207]
  v_mfma_f32_32x32x16_bf16 v[208:223], a[20:23], v[92:95], v[208:223]
  v_mfma_f32_32x32x16_bf16 v[224:239], a[24:27], v[92:95], v[224:239]
  v_mfma_f32_32x32x16_bf16 v[240:255], a[28:31], v[92:95], v[240:255]
  s_nop 7
  ds_read_b128 v[112:115], v1 offset:8192
  ds_read_b128 v[116:119], v2 offset:8192
  ds_read_b128 v[120:123], v3 offset:8192
  ds_read_b128 v[124:127], v4 offset:8192
  s_waitcnt lgkmcnt(3)
  v_mfma_f32_32x32x16_bf16 v[96:111], v[112:115], a[224:227], 0
  s_waitcnt lgkmcnt(2)
  v_mfma_f32_32x32x16_bf16 v[96:111], v[116:119], a[228:231], v[96:111]
  s_waitcnt lgkmcnt(1)
  v_mfma_f32_32x32x16_bf16 v[96:111], v[120:123], a[232:235], v[96:111]
  s_waitcnt lgkmcnt(0)
  v_mfma_f32_32x32x16_bf16 v[96:111], v[124:127], a[236:239], v[96:111]
  s_nop 7
  ds_read_b128 v[112:115], v5 offset:8192
  ds_read_b128 v[116:119], v6 offset:8192
  ds_read_b128 v[120:123], v7 offset:8192
  ds_read_b128 v[124:127], v8 offset:8192
  s_waitcnt lgkmcnt(3)
  v_mfma_f32_32x32x16_bf16 v[96:111], v[112:115], a[240:243], v[96:111]
  s_waitcnt lgkmcnt(2)
  v_mfma_f32_32x32x16_bf16 v[96:111], v[116:119], a[244:247], v[96:111]
  s_waitcnt lgkmcnt(1)
  v_mfma_f32_32x32x16_bf16 v[96:111], v[120:123], a[248:251], v[96:111]
  s_waitcnt lgkmcnt(0)
  v_mfma_f32_32x32x16_bf16 v[96:111], v[124:127], a[252:255], v[96:111]
  s_nop 7
  s_nop 3
  v_fma_f32 v96, v96, s20, v81
  v_fma_f32 v97, v97, s20, v81
  v_fma_f32 v98, v98, s20, v81
  v_fma_f32 v99, v99, s20, v81
  v_fma_f32 v100, v100, s20, v81
  v_fma_f32 v101, v101, s20, v81
  v_fma_f32 v102, v102, s20, v81
  v_fma_f32 v103, v103, s20, v81
  v_fma_f32 v104, v104, s20, v81
  v_fma_f32 v105, v105, s20, v81
  v_fma_f32 v106, v106, s20, v81
  v_fma_f32 v107, v107, s20, v81
  v_fma_f32 v108, v108, s20, v81
  v_fma_f32 v109, v109, s20, v81
  v_fma_f32 v110, v110, s20, v81
  v_fma_f32 v111, v111, s20, v81
  v_exp_f32 v96, v96
  v_exp_f32 v97, v97
  v_exp_f32 v98, v98
  v_exp_f32 v99, v99
  v_exp_f32 v100, v100
  v_exp_f32 v101, v101
  v_exp_f32 v102, v102
  v_exp_f32 v103, v103
  v_exp_f32 v104, v104
  v_exp_f32 v105, v105
  v_exp_f32 v106, v106
  v_exp_f32 v107, v107
  v_exp_f32 v108, v108
  v_exp_f32 v109, v109
  v_exp_f32 v110, v110
  v_exp_f32 v111, v111
  v_add_f32 v82, v82, v96
  v_add_f32 v82, v82, v97
  v_add_f32 v82, v82, v98
  v_add_f32 v82, v82, v99
  v_add_f32 v82, v82, v100
  v_add_f32 v82, v82, v101
  v_add_f32 v82, v82, v102
  v_add_f32 v82, v82, v103
  v_add_f32 v82, v82, v104
  v_add_f32 v82, v82, v105
  v_add_f32 v82, v82, v106
  v_add_f32 v82, v82, v107
  v_add_f32 v82, v82, v108
  v_add_f32 v82, v82, v109
  v_add_f32 v82, v82, v110
  v_add_f32 v82, v82, v111
  v_cvt_pk_bf16_f32 v88, v96, v97
  v_cvt_pk_bf16_f32 v89, v98, v99
  v_cvt_pk_bf16_f32 v90, v100, v101
  v_cvt_pk_bf16_f32 v91, v102, v103
  v_cvt_pk_bf16_f32 v92, v104, v105
  v_cvt_pk_bf16_f32 v93, v106, v107
  v_cvt_pk_bf16_f32 v94, v108, v109
  v_cvt_pk_bf16_f32 v95, v110, v111
  v_mfma_f32_32x32x16_bf16 v[192:207], a[32:35], v[88:91], v[192:207]
  v_mfma_f32_32x32x16_bf16 v[208:223], a[36:39], v[88:91], v[208:223]
  v_mfma_f32_32x32x16_bf16 v[224:239], a[40:43], v[88:91], v[224:239]
  v_mfma_f32_32x32x16_bf16 v[240:255], a[44:47], v[88:91], v[240:255]
  s_nop 7
  v_mfma_f32_32x32x16_bf16 v[192:207], a[48:51], v[92:95], v[192:207]
  v_mfma_f32_32x32x16_bf16 v[208:223], a[52:55], v[92:95], v[208:223]
  v_mfma_f32_32x32x16_bf16 v[224:239], a[56:59], v[92:95], v[224:239]
  v_mfma_f32_32x32x16_bf16 v[240:255], a[60:63], v[92:95], v[240:255]
  s_nop 7
  ds_read_b128 v[112:115], v1 offset:16384
  ds_read_b128 v[116:119], v2 offset:16384
  ds_read_b128 v[120:123], v3 offset:16384
  ds_read_b128 v[124:127], v4 offset:16384
  s_waitcnt lgkmcnt(3)
  v_mfma_f32_32x32x16_bf16 v[96:111], v[112:115], a[224:227], 0
  s_waitcnt lgkmcnt(2)
  v_mfma_f32_32x32x16_bf16 v[96:111], v[116:119], a[228:231], v[96:111]
  s_waitcnt lgkmcnt(1)
  v_mfma_f32_32x32x16_bf16 v[96:111], v[120:123], a[232:235], v[96:111]
  s_waitcnt lgkmcnt(0)
  v_mfma_f32_32x32x16_bf16 v[96:111], v[124:127], a[236:239], v[96:111]
  s_nop 7
  ds_read_b128 v[112:115], v5 offset:16384
  ds_read_b128 v[116:119], v6 offset:16384
  ds_read_b128 v[120:123], v7 offset:16384
  ds_read_b128 v[124:127], v8 offset:16384
  s_waitcnt lgkmcnt(3)
  v_mfma_f32_32x32x16_bf16 v[96:111], v[112:115], a[240:243], v[96:111]
  s_waitcnt lgkmcnt(2)
  v_mfma_f32_32x32x16_bf16 v[96:111], v[116:119], a[244:247], v[96:111]
  s_waitcnt lgkmcnt(1)
  v_mfma_f32_32x32x16_bf16 v[96:111], v[120:123], a[248:251], v[96:111]
  s_waitcnt lgkmcnt(0)
  v_mfma_f32_32x32x16_bf16 v[96:111], v[124:127], a[252:255], v[96:111]
  s_nop 7
  s_nop 3
  v_fma_f32 v96, v96, s20, v81
  v_fma_f32 v97, v97, s20, v81
  v_fma_f32 v98, v98, s20, v81
  v_fma_f32 v99, v99, s20, v81
  v_fma_f32 v100, v100, s20, v81
  v_fma_f32 v101, v101, s20, v81
  v_fma_f32 v102, v102, s20, v81
  v_fma_f32 v103, v103, s20, v81
  v_fma_f32 v104, v104, s20, v81
  v_fma_f32 v105, v105, s20, v81
  v_fma_f32 v106, v106, s20, v81
  v_fma_f32 v107, v107, s20, v81
  v_fma_f32 v108, v108, s20, v81
  v_fma_f32 v109, v109, s20, v81
  v_fma_f32 v110, v110, s20, v81
  v_fma_f32 v111, v111, s20, v81
  v_exp_f32 v96, v96
  v_exp_f32 v97, v97
  v_exp_f32 v98, v98
  v_exp_f32 v99, v99
  v_exp_f32 v100, v100
  v_exp_f32 v101, v101
  v_exp_f32 v102, v102
  v_exp_f32 v103, v103
  v_exp_f32 v104, v104
  v_exp_f32 v105, v105
  v_exp_f32 v106, v106
  v_exp_f32 v107, v107
  v_exp_f32 v108, v108
  v_exp_f32 v109, v109
  v_exp_f32 v110, v110
  v_exp_f32 v111, v111
  v_add_f32 v82, v82, v96
  v_add_f32 v82, v82, v97
  v_add_f32 v82, v82, v98
  v_add_f32 v82, v82, v99
  v_add_f32 v82, v82, v100
  v_add_f32 v82, v82, v101
  v_add_f32 v82, v82, v102
  v_add_f32 v82, v82, v103
  v_add_f32 v82, v82, v104
  v_add_f32 v82, v82, v105
  v_add_f32 v82, v82, v106
  v_add_f32 v82, v82, v107
  v_add_f32 v82, v82, v108
  v_add_f32 v82, v82, v109
  v_add_f32 v82, v82, v110
  v_add_f32 v82, v82, v111
  v_cvt_pk_bf16_f32 v88, v96, v97
  v_cvt_pk_bf16_f32 v89, v98, v99
  v_cvt_pk_bf16_f32 v90, v100, v101
  v_cvt_pk_bf16_f32 v91, v102, v103
  v_cvt_pk_bf16_f32 v92, v104, v105
  v_cvt_pk_bf16_f32 v93, v106, v107
  v_cvt_pk_bf16_f32 v94, v108, v109
  v_cvt_pk_bf16_f32 v95, v110, v111
  v_mfma_f32_32x32x16_bf16 v[192:207], a[64:67], v[88:91], v[192:207]
  v_mfma_f32_32x32x16_bf16 v[208:223], a[68:71], v[88:91], v[208:223]
  v_mfma_f32_32x32x16_bf16 v[224:239], a[72:75], v[88:91], v[224:239]
  v_mfma_f32_32x32x16_bf16 v[240:255], a[76:79], v[88:91], v[240:255]
  s_nop 7
  v_mfma_f32_32x32x16_bf16 v[192:207], a[80:83], v[92:95], v[192:207]
  v_mfma_f32_32x32x16_bf16 v[208:223], a[84:87], v[92:95], v[208:223]
  v_mfma_f32_32x32x16_bf16 v[224:239], a[88:91], v[92:95], v[224:239]
  v_mfma_f32_32x32x16_bf16 v[240:255], a[92:95], v[92:95], v[240:255]
  s_nop 7
  ds_read_b128 v[112:115], v1 offset:24576
  ds_read_b128 v[116:119], v2 offset:24576
  ds_read_b128 v[120:123], v3 offset:24576
  ds_read_b128 v[124:127], v4 offset:24576
  s_waitcnt lgkmcnt(3)
  v_mfma_f32_32x32x16_bf16 v[96:111], v[112:115], a[224:227], 0
  s_waitcnt lgkmcnt(2)
  v_mfma_f32_32x32x16_bf16 v[96:111], v[116:119], a[228:231], v[96:111]
  s_waitcnt lgkmcnt(1)
  v_mfma_f32_32x32x16_bf16 v[96:111], v[120:123], a[232:235], v[96:111]
  s_waitcnt lgkmcnt(0)
  v_mfma_f32_32x32x16_bf16 v[96:111], v[124:127], a[236:239], v[96:111]
  s_nop 7
  ds_read_b128 v[112:115], v5 offset:24576
  ds_read_b128 v[116:119], v6 offset:24576
  ds_read_b128 v[120:123], v7 offset:24576
  ds_read_b128 v[124:127], v8 offset:24576
  s_waitcnt lgkmcnt(3)
  v_mfma_f32_32x32x16_bf16 v[96:111], v[112:115], a[240:243], v[96:111]
  s_waitcnt lgkmcnt(2)
  v_mfma_f32_32x32x16_bf16 v[96:111], v[116:119], a[244:247], v[96:111]
  s_waitcnt lgkmcnt(1)
  v_mfma_f32_32x32x16_bf16 v[96:111], v[120:123], a[248:251], v[96:111]
  s_waitcnt lgkmcnt(0)
  v_mfma_f32_32x32x16_bf16 v[96:111], v[124:127], a[252:255], v[96:111]
  s_nop 7
  s_nop 3
  v_fma_f32 v96, v96, s20, v81
  v_fma_f32 v97, v97, s20, v81
  v_fma_f32 v98, v98, s20, v81
  v_fma_f32 v99, v99, s20, v81
  v_fma_f32 v100, v100, s20, v81
  v_fma_f32 v101, v101, s20, v81
  v_fma_f32 v102, v102, s20, v81
  v_fma_f32 v103, v103, s20, v81
  v_fma_f32 v104, v104, s20, v81
  v_fma_f32 v105, v105, s20, v81
  v_fma_f32 v106, v106, s20, v81
  v_fma_f32 v107, v107, s20, v81
  v_fma_f32 v108, v108, s20, v81
  v_fma_f32 v109, v109, s20, v81
  v_fma_f32 v110, v110, s20, v81
  v_fma_f32 v111, v111, s20, v81
  v_exp_f32 v96, v96
  v_exp_f32 v97, v97
  v_exp_f32 v98, v98
  v_exp_f32 v99, v99
  v_exp_f32 v100, v100
  v_exp_f32 v101, v101
  v_exp_f32 v102, v102
  v_exp_f32 v103, v103
  v_exp_f32 v104, v104
  v_exp_f32 v105, v105
  v_exp_f32 v106, v106
  v_exp_f32 v107, v107
  v_exp_f32 v108, v108
  v_exp_f32 v109, v109
  v_exp_f32 v110, v110
  v_exp_f32 v111, v111
  v_add_f32 v82, v82, v96
  v_add_f32 v82, v82, v97
  v_add_f32 v82, v82, v98
  v_add_f32 v82, v82, v99
  v_add_f32 v82, v82, v100
  v_add_f32 v82, v82, v101
  v_add_f32 v82, v82, v102
  v_add_f32 v82, v82, v103
  v_add_f32 v82, v82, v104
  v_add_f32 v82, v82, v105
  v_add_f32 v82, v82, v106
  v_add_f32 v82, v82, v107
  v_add_f32 v82, v82, v108
  v_add_f32 v82, v82, v109
  v_add_f32 v82, v82, v110
  v_add_f32 v82, v82, v111
  v_cvt_pk_bf16_f32 v88, v96, v97
  v_cvt_pk_bf16_f32 v89, v98, v99
  v_cvt_pk_bf16_f32 v90, v100, v101
  v_cvt_pk_bf16_f32 v91, v102, v103
  v_cvt_pk_bf16_f32 v92, v104, v105
  v_cvt_pk_bf16_f32 v93, v106, v107
  v_cvt_pk_bf16_f32 v94, v108, v109
  v_cvt_pk_bf16_f32 v95, v110, v111
  v_mfma_f32_32x32x16_bf16 v[192:207], a[96:99], v[88:91], v[192:207]
  v_mfma_f32_32x32x16_bf16 v[208:223], a[100:103], v[88:91], v[208:223]
  v_mfma_f32_32x32x16_bf16 v[224:239], a[104:107], v[88:91], v[224:239]
  v_mfma_f32_32x32x16_bf16 v[240:255], a[108:111], v[88:91], v[240:255]
  s_nop 7
  v_mfma_f32_32x32x16_bf16 v[192:207], a[112:115], v[92:95], v[192:207]
  v_mfma_f32_32x32x16_bf16 v[208:223], a[116:119], v[92:95], v[208:223]
  v_mfma_f32_32x32x16_bf16 v[224:239], a[120:123], v[92:95], v[224:239]
  v_mfma_f32_32x32x16_bf16 v[240:255], a[124:127], v[92:95], v[240:255]
  s_nop 7
  ds_read_b128 v[112:115], v1 offset:32768
  ds_read_b128 v[116:119], v2 offset:32768
  ds_read_b128 v[120:123], v3 offset:32768
  ds_read_b128 v[124:127], v4 offset:32768
  s_waitcnt lgkmcnt(3)
  v_mfma_f32_32x32x16_bf16 v[96:111], v[112:115], a[224:227], 0
  s_waitcnt lgkmcnt(2)
  v_mfma_f32_32x32x16_bf16 v[96:111], v[116:119], a[228:231], v[96:111]
  s_waitcnt lgkmcnt(1)
  v_mfma_f32_32x32x16_bf16 v[96:111], v[120:123], a[232:235], v[96:111]
  s_waitcnt lgkmcnt(0)
  v_mfma_f32_32x32x16_bf16 v[96:111], v[124:127], a[236:239], v[96:111]
  s_nop 7
  ds_read_b128 v[112:115], v5 offset:32768
  ds_read_b128 v[116:119], v6 offset:32768
  ds_read_b128 v[120:123], v7 offset:32768
  ds_read_b128 v[124:127], v8 offset:32768
  s_waitcnt lgkmcnt(3)
  v_mfma_f32_32x32x16_bf16 v[96:111], v[112:115], a[240:243], v[96:111]
  s_waitcnt lgkmcnt(2)
  v_mfma_f32_32x32x16_bf16 v[96:111], v[116:119], a[244:247], v[96:111]
  s_waitcnt lgkmcnt(1)
  v_mfma_f32_32x32x16_bf16 v[96:111], v[120:123], a[248:251], v[96:111]
  s_waitcnt lgkmcnt(0)
  v_mfma_f32_32x32x16_bf16 v[96:111], v[124:127], a[252:255], v[96:111]
  s_nop 7
  s_nop 3
  v_fma_f32 v96, v96, s20, v81
  v_fma_f32 v97, v97, s20, v81
  v_fma_f32 v98, v98, s20, v81
  v_fma_f32 v99, v99, s20, v81
  v_fma_f32 v100, v100, s20, v81
  v_fma_f32 v101, v101, s20, v81
  v_fma_f32 v102, v102, s20, v81
  v_fma_f32 v103, v103, s20, v81
  v_fma_f32 v104, v104, s20, v81
  v_fma_f32 v105, v105, s20, v81
  v_fma_f32 v106, v106, s20, v81
  v_fma_f32 v107, v107, s20, v81
  v_fma_f32 v108, v108, s20, v81
  v_fma_f32 v109, v109, s20, v81
  v_fma_f32 v110, v110, s20, v81
  v_fma_f32 v111, v111, s20, v81
  v_exp_f32 v96, v96
  v_exp_f32 v97, v97
  v_exp_f32 v98, v98
  v_exp_f32 v99, v99
  v_exp_f32 v100, v100
  v_exp_f32 v101, v101
  v_exp_f32 v102, v102
  v_exp_f32 v103, v103
  v_exp_f32 v104, v104
  v_exp_f32 v105, v105
  v_exp_f32 v106, v106
  v_exp_f32 v107, v107
  v_exp_f32 v108, v108
  v_exp_f32 v109, v109
  v_exp_f32 v110, v110
  v_exp_f32 v111, v111
  v_add_f32 v82, v82, v96
  v_add_f32 v82, v82, v97
  v_add_f32 v82, v82, v98
  v_add_f32 v82, v82, v99
  v_add_f32 v82, v82, v100
  v_add_f32 v82, v82, v101
  v_add_f32 v82, v82, v102
  v_add_f32 v82, v82, v103
  v_add_f32 v82, v82, v104
  v_add_f32 v82, v82, v105
  v_add_f32 v82, v82, v106
  v_add_f32 v82, v82, v107
  v_add_f32 v82, v82, v108
  v_add_f32 v82, v82, v109
  v_add_f32 v82, v82, v110
  v_add_f32 v82, v82, v111
  v_cvt_pk_bf16_f32 v88, v96, v97
  v_cvt_pk_bf16_f32 v89, v98, v99
  v_cvt_pk_bf16_f32 v90, v100, v101
  v_cvt_pk_bf16_f32 v91, v102, v103
  v_cvt_pk_bf16_f32 v92, v104, v105
  v_cvt_pk_bf16_f32 v93, v106, v107
  v_cvt_pk_bf16_f32 v94, v108, v109
  v_cvt_pk_bf16_f32 v95, v110, v111
  v_mfma_f32_32x32x16_bf16 v[192:207], a[128:131], v[88:91], v[192:207]
  v_mfma_f32_32x32x16_bf16 v[208:223], a[132:135], v[88:91], v[208:223]
  v_mfma_f32_32x32x16_bf16 v[224:239], a[136:139], v[88:91], v[224:239]
  v_mfma_f32_32x32x16_bf16 v[240:255], a[140:143], v[88:91], v[240:255]
  s_nop 7
  v_mfma_f32_32x32x16_bf16 v[192:207], a[144:147], v[92:95], v[192:207]
  v_mfma_f32_32x32x16_bf16 v[208:223], a[148:151], v[92:95], v[208:223]
  v_mfma_f32_32x32x16_bf16 v[224:239], a[152:155], v[92:95], v[224:239]
  v_mfma_f32_32x32x16_bf16 v[240:255], a[156:159], v[92:95], v[240:255]
  s_nop 7
  ds_read_b128 v[112:115], v1 offset:40960
  ds_read_b128 v[116:119], v2 offset:40960
  ds_read_b128 v[120:123], v3 offset:40960
  ds_read_b128 v[124:127], v4 offset:40960
  s_waitcnt lgkmcnt(3)
  v_mfma_f32_32x32x16_bf16 v[96:111], v[112:115], a[224:227], 0
  s_waitcnt lgkmcnt(2)
  v_mfma_f32_32x32x16_bf16 v[96:111], v[116:119], a[228:231], v[96:111]
  s_waitcnt lgkmcnt(1)
  v_mfma_f32_32x32x16_bf16 v[96:111], v[120:123], a[232:235], v[96:111]
  s_waitcnt lgkmcnt(0)
  v_mfma_f32_32x32x16_bf16 v[96:111], v[124:127], a[236:239], v[96:111]
  s_nop 7
  ds_read_b128 v[112:115], v5 offset:40960
  ds_read_b128 v[116:119], v6 offset:40960
  ds_read_b128 v[120:123], v7 offset:40960
  ds_read_b128 v[124:127], v8 offset:40960
  s_waitcnt lgkmcnt(3)
  v_mfma_f32_32x32x16_bf16 v[96:111], v[112:115], a[240:243], v[96:111]
  s_waitcnt lgkmcnt(2)
  v_mfma_f32_32x32x16_bf16 v[96:111], v[116:119], a[244:247], v[96:111]
  s_waitcnt lgkmcnt(1)
  v_mfma_f32_32x32x16_bf16 v[96:111], v[120:123], a[248:251], v[96:111]
  s_waitcnt lgkmcnt(0)
  v_mfma_f32_32x32x16_bf16 v[96:111], v[124:127], a[252:255], v[96:111]
  s_nop 7
  s_nop 3
  v_fma_f32 v96, v96, s20, v81
  v_fma_f32 v97, v97, s20, v81
  v_fma_f32 v98, v98, s20, v81
  v_fma_f32 v99, v99, s20, v81
  v_fma_f32 v100, v100, s20, v81
  v_fma_f32 v101, v101, s20, v81
  v_fma_f32 v102, v102, s20, v81
  v_fma_f32 v103, v103, s20, v81
  v_fma_f32 v104, v104, s20, v81
  v_fma_f32 v105, v105, s20, v81
  v_fma_f32 v106, v106, s20, v81
  v_fma_f32 v107, v107, s20, v81
  v_fma_f32 v108, v108, s20, v81
  v_fma_f32 v109, v109, s20, v81
  v_fma_f32 v110, v110, s20, v81
  v_fma_f32 v111, v111, s20, v81
  v_exp_f32 v96, v96
  v_exp_f32 v97, v97
  v_exp_f32 v98, v98
  v_exp_f32 v99, v99
  v_exp_f32 v100, v100
  v_exp_f32 v101, v101
  v_exp_f32 v102, v102
  v_exp_f32 v103, v103
  v_exp_f32 v104, v104
  v_exp_f32 v105, v105
  v_exp_f32 v106, v106
  v_exp_f32 v107, v107
  v_exp_f32 v108, v108
  v_exp_f32 v109, v109
  v_exp_f32 v110, v110
  v_exp_f32 v111, v111
  v_add_f32 v82, v82, v96
  v_add_f32 v82, v82, v97
  v_add_f32 v82, v82, v98
  v_add_f32 v82, v82, v99
  v_add_f32 v82, v82, v100
  v_add_f32 v82, v82, v101
  v_add_f32 v82, v82, v102
  v_add_f32 v82, v82, v103
  v_add_f32 v82, v82, v104
  v_add_f32 v82, v82, v105
  v_add_f32 v82, v82, v106
  v_add_f32 v82, v82, v107
  v_add_f32 v82, v82, v108
  v_add_f32 v82, v82, v109
  v_add_f32 v82, v82, v110
  v_add_f32 v82, v82, v111
  v_cvt_pk_bf16_f32 v88, v96, v97
  v_cvt_pk_bf16_f32 v89, v98, v99
  v_cvt_pk_bf16_f32 v90, v100, v101
  v_cvt_pk_bf16_f32 v91, v102, v103
  v_cvt_pk_bf16_f32 v92, v104, v105
  v_cvt_pk_bf16_f32 v93, v106, v107
  v_cvt_pk_bf16_f32 v94, v108, v109
  v_cvt_pk_bf16_f32 v95, v110, v111
  v_mfma_f32_32x32x16_bf16 v[192:207], a[160:163], v[88:91], v[192:207]
  v_mfma_f32_32x32x16_bf16 v[208:223], a[164:167], v[88:91], v[208:223]
  v_mfma_f32_32x32x16_bf16 v[224:239], a[168:171], v[88:91], v[224:239]
  v_mfma_f32_32x32x16_bf16 v[240:255], a[172:175], v[88:91], v[240:255]
  s_nop 7
  v_mfma_f32_32x32x16_bf16 v[192:207], a[176:179], v[92:95], v[192:207]
  v_mfma_f32_32x32x16_bf16 v[208:223], a[180:183], v[92:95], v[208:223]
  v_mfma_f32_32x32x16_bf16 v[224:239], a[184:187], v[92:95], v[224:239]
  v_mfma_f32_32x32x16_bf16 v[240:255], a[188:191], v[92:95], v[240:255]
  s_nop 7
  ds_read_b128 v[112:115], v1 offset:49152
  ds_read_b128 v[116:119], v2 offset:49152
  ds_read_b128 v[120:123], v3 offset:49152
  ds_read_b128 v[124:127], v4 offset:49152
  s_waitcnt lgkmcnt(3)
  v_mfma_f32_32x32x16_bf16 v[96:111], v[112:115], a[224:227], 0
  s_waitcnt lgkmcnt(2)
  v_mfma_f32_32x32x16_bf16 v[96:111], v[116:119], a[228:231], v[96:111]
  s_waitcnt lgkmcnt(1)
  v_mfma_f32_32x32x16_bf16 v[96:111], v[120:123], a[232:235], v[96:111]
  s_waitcnt lgkmcnt(0)
  v_mfma_f32_32x32x16_bf16 v[96:111], v[124:127], a[236:239], v[96:111]
  s_nop 7
  ds_read_b128 v[112:115], v5 offset:49152
  ds_read_b128 v[116:119], v6 offset:49152
  ds_read_b128 v[120:123], v7 offset:49152
  ds_read_b128 v[124:127], v8 offset:49152
  s_waitcnt lgkmcnt(3)
  v_mfma_f32_32x32x16_bf16 v[96:111], v[112:115], a[240:243], v[96:111]
  s_waitcnt lgkmcnt(2)
  v_mfma_f32_32x32x16_bf16 v[96:111], v[116:119], a[244:247], v[96:111]
  s_waitcnt lgkmcnt(1)
  v_mfma_f32_32x32x16_bf16 v[96:111], v[120:123], a[248:251], v[96:111]
  s_waitcnt lgkmcnt(0)
  v_mfma_f32_32x32x16_bf16 v[96:111], v[124:127], a[252:255], v[96:111]
  s_nop 7
  s_nop 3
  v_fma_f32 v96, v96, s20, v81
  v_fma_f32 v97, v97, s20, v81
  v_fma_f32 v98, v98, s20, v81
  v_fma_f32 v99, v99, s20, v81
  v_fma_f32 v100, v100, s20, v81
  v_fma_f32 v101, v101, s20, v81
  v_fma_f32 v102, v102, s20, v81
  v_fma_f32 v103, v103, s20, v81
  v_fma_f32 v104, v104, s20, v81
  v_fma_f32 v105, v105, s20, v81
  v_fma_f32 v106, v106, s20, v81
  v_fma_f32 v107, v107, s20, v81
  v_fma_f32 v108, v108, s20, v81
  v_fma_f32 v109, v109, s20, v81
  v_fma_f32 v110, v110, s20, v81
  v_fma_f32 v111, v111, s20, v81
  v_exp_f32 v96, v96
  v_exp_f32 v97, v97
  v_exp_f32 v98, v98
  v_exp_f32 v99, v99
  v_exp_f32 v100, v100
  v_exp_f32 v101, v101
  v_exp_f32 v102, v102
  v_exp_f32 v103, v103
  v_exp_f32 v104, v104
  v_exp_f32 v105, v105
  v_exp_f32 v106, v106
  v_exp_f32 v107, v107
  v_exp_f32 v108, v108
  v_exp_f32 v109, v109
  v_exp_f32 v110, v110
  v_exp_f32 v111, v111
  v_add_f32 v82, v82, v96
  v_add_f32 v82, v82, v97
  v_add_f32 v82, v82, v98
  v_add_f32 v82, v82, v99
  v_add_f32 v82, v82, v100
  v_add_f32 v82, v82, v101
  v_add_f32 v82, v82, v102
  v_add_f32 v82, v82, v103
  v_add_f32 v82, v82, v104
  v_add_f32 v82, v82, v105
  v_add_f32 v82, v82, v106
  v_add_f32 v82, v82, v107
  v_add_f32 v82, v82, v108
  v_add_f32 v82, v82, v109
  v_add_f32 v82, v82, v110
  v_add_f32 v82, v82, v111
  v_cvt_pk_bf16_f32 v88, v96, v97
  v_cvt_pk_bf16_f32 v89, v98, v99
  v_cvt_pk_bf16_f32 v90, v100, v101
  v_cvt_pk_bf16_f32 v91, v102, v103
  v_cvt_pk_bf16_f32 v92, v104, v105
  v_cvt_pk_bf16_f32 v93, v106, v107
  v_cvt_pk_bf16_f32 v94, v108, v109
  v_cvt_pk_bf16_f32 v95, v110, v111
  ds_read_b64_tr_b16 v[112:113], v17 offset:49152
  ds_read_b64_tr_b16 v[114:115], v17 offset:51200
  ds_read_b64_tr_b16 v[116:117], v18 offset:49152
  ds_read_b64_tr_b16 v[118:119], v18 offset:51200
  ds_read_b64_tr_b16 v[120:121], v19 offset:49152
  ds_read_b64_tr_b16 v[122:123], v19 offset:51200
  ds_read_b64_tr_b16 v[124:125], v20 offset:49152
  ds_read_b64_tr_b16 v[126:127], v20 offset:51200
  s_waitcnt lgkmcnt(6)
  v_mfma_f32_32x32x16_bf16 v[192:207], v[112:115], v[88:91], v[192:207]
  s_waitcnt lgkmcnt(4)
  v_mfma_f32_32x32x16_bf16 v[208:223], v[116:119], v[88:91], v[208:223]
  s_waitcnt lgkmcnt(2)
  v_mfma_f32_32x32x16_bf16 v[224:239], v[120:123], v[88:91], v[224:239]
  s_waitcnt lgkmcnt(0)
  v_mfma_f32_32x32x16_bf16 v[240:255], v[124:127], v[88:91], v[240:255]
  s_nop 7
  ds_read_b64_tr_b16 v[112:113], v17 offset:53248
  ds_read_b64_tr_b16 v[114:115], v17 offset:55296
  ds_read_b64_tr_b16 v[116:117], v18 offset:53248
  ds_read_b64_tr_b16 v[118:119], v18 offset:55296
  ds_read_b64_tr_b16 v[120:121], v19 offset:53248
  ds_read_b64_tr_b16 v[122:123], v19 offset:55296
  ds_read_b64_tr_b16 v[124:125], v20 offset:53248
  ds_read_b64_tr_b16 v[126:127], v20 offset:55296
  s_waitcnt lgkmcnt(6)
  v_mfma_f32_32x32x16_bf16 v[192:207], v[112:115], v[92:95], v[192:207]
  s_waitcnt lgkmcnt(4)
  v_mfma_f32_32x32x16_bf16 v[208:223], v[116:119], v[92:95], v[208:223]
  s_waitcnt lgkmcnt(2)
  v_mfma_f32_32x32x16_bf16 v[224:239], v[120:123], v[92:95], v[224:239]
  s_waitcnt lgkmcnt(0)
  v_mfma_f32_32x32x16_bf16 v[240:255], v[124:127], v[92:95], v[240:255]
  s_nop 7
  ds_read_b128 v[112:115], v1 offset:57344
  ds_read_b128 v[116:119], v2 offset:57344
  ds_read_b128 v[120:123], v3 offset:57344
  ds_read_b128 v[124:127], v4 offset:57344
  s_waitcnt lgkmcnt(3)
  v_mfma_f32_32x32x16_bf16 v[96:111], v[112:115], a[224:227], 0
  s_waitcnt lgkmcnt(2)
  v_mfma_f32_32x32x16_bf16 v[96:111], v[116:119], a[228:231], v[96:111]
  s_waitcnt lgkmcnt(1)
  v_mfma_f32_32x32x16_bf16 v[96:111], v[120:123], a[232:235], v[96:111]
  s_waitcnt lgkmcnt(0)
  v_mfma_f32_32x32x16_bf16 v[96:111], v[124:127], a[236:239], v[96:111]
  s_nop 7
  ds_read_b128 v[112:115], v5 offset:57344
  ds_read_b128 v[116:119], v6 offset:57344
  ds_read_b128 v[120:123], v7 offset:57344
  ds_read_b128 v[124:127], v8 offset:57344
  s_waitcnt lgkmcnt(3)
  v_mfma_f32_32x32x16_bf16 v[96:111], v[112:115], a[240:243], v[96:111]
  s_waitcnt lgkmcnt(2)
  v_mfma_f32_32x32x16_bf16 v[96:111], v[116:119], a[244:247], v[96:111]
  s_waitcnt lgkmcnt(1)
  v_mfma_f32_32x32x16_bf16 v[96:111], v[120:123], a[248:251], v[96:111]
  s_waitcnt lgkmcnt(0)
  v_mfma_f32_32x32x16_bf16 v[96:111], v[124:127], a[252:255], v[96:111]
  s_nop 7
  s_nop 3
  v_fma_f32 v96, v96, s20, v81
  v_fma_f32 v97, v97, s20, v81
  v_fma_f32 v98, v98, s20, v81
  v_fma_f32 v99, v99, s20, v81
  v_fma_f32 v100, v100, s20, v81
  v_fma_f32 v101, v101, s20, v81
  v_fma_f32 v102, v102, s20, v81
  v_fma_f32 v103, v103, s20, v81
  v_fma_f32 v104, v104, s20, v81
  v_fma_f32 v105, v105, s20, v81
  v_fma_f32 v106, v106, s20, v81
  v_fma_f32 v107, v107, s20, v81
  v_fma_f32 v108, v108, s20, v81
  v_fma_f32 v109, v109, s20, v81
  v_fma_f32 v110, v110, s20, v81
  v_fma_f32 v111, v111, s20, v81
  v_exp_f32 v96, v96
  v_exp_f32 v97, v97
  v_exp_f32 v98, v98
  v_exp_f32 v99, v99
  v_exp_f32 v100, v100
  v_exp_f32 v101, v101
  v_exp_f32 v102, v102
  v_exp_f32 v103, v103
  v_exp_f32 v104, v104
  v_exp_f32 v105, v105
  v_exp_f32 v106, v106
  v_exp_f32 v107, v107
  v_exp_f32 v108, v108
  v_exp_f32 v109, v109
  v_exp_f32 v110, v110
  v_exp_f32 v111, v111
  v_add_f32 v82, v82, v96
  v_add_f32 v82, v82, v97
  v_add_f32 v82, v82, v98
  v_add_f32 v82, v82, v99
  v_add_f32 v82, v82, v100
  v_add_f32 v82, v82, v101
  v_add_f32 v82, v82, v102
  v_add_f32 v82, v82, v103
  v_add_f32 v82, v82, v104
  v_add_f32 v82, v82, v105
  v_add_f32 v82, v82, v106
  v_add_f32 v82, v82, v107
  v_add_f32 v82, v82, v108
  v_add_f32 v82, v82, v109
  v_add_f32 v82, v82, v110
  v_add_f32 v82, v82, v111
  v_cvt_pk_bf16_f32 v88, v96, v97
  v_cvt_pk_bf16_f32 v89, v98, v99
  v_cvt_pk_bf16_f32 v90, v100, v101
  v_cvt_pk_bf16_f32 v91, v102, v103
  v_cvt_pk_bf16_f32 v92, v104, v105
  v_cvt_pk_bf16_f32 v93, v106, v107
  v_cvt_pk_bf16_f32 v94, v108, v109
  v_cvt_pk_bf16_f32 v95, v110, v111
  ds_read_b64_tr_b16 v[112:113], v17 offset:57344
  ds_read_b64_tr_b16 v[114:115], v17 offset:59392
  ds_read_b64_tr_b16 v[116:117], v18 offset:57344
  ds_read_b64_tr_b16 v[118:119], v18 offset:59392
  ds_read_b64_tr_b16 v[120:121], v19 offset:57344
  ds_read_b64_tr_b16 v[122:123], v19 offset:59392
  ds_read_b64_tr_b16 v[124:125], v20 offset:57344
  ds_read_b64_tr_b16 v[126:127], v20 offset:59392
  s_waitcnt lgkmcnt(6)
  v_mfma_f32_32x32x16_bf16 v[192:207], v[112:115], v[88:91], v[192:207]
  s_waitcnt lgkmcnt(4)
  v_mfma_f32_32x32x16_bf16 v[208:223], v[116:119], v[88:91], v[208:223]
  s_waitcnt lgkmcnt(2)
  v_mfma_f32_32x32x16_bf16 v[224:239], v[120:123], v[88:91], v[224:239]
  s_waitcnt lgkmcnt(0)
  v_mfma_f32_32x32x16_bf16 v[240:255], v[124:127], v[88:91], v[240:255]
  s_nop 7
  ds_read_b64_tr_b16 v[112:113], v17 offset:61440
  ds_read_b64_tr_b16 v[114:115], v17 offset:63488
  ds_read_b64_tr_b16 v[116:117], v18 offset:61440
  ds_read_b64_tr_b16 v[118:119], v18 offset:63488
  ds_read_b64_tr_b16 v[120:121], v19 offset:61440
  ds_read_b64_tr_b16 v[122:123], v19 offset:63488
  ds_read_b64_tr_b16 v[124:125], v20 offset:61440
  ds_read_b64_tr_b16 v[126:127], v20 offset:63488
  s_waitcnt lgkmcnt(6)
  v_mfma_f32_32x32x16_bf16 v[192:207], v[112:115], v[92:95], v[192:207]
  s_waitcnt lgkmcnt(4)
  v_mfma_f32_32x32x16_bf16 v[208:223], v[116:119], v[92:95], v[208:223]
  s_waitcnt lgkmcnt(2)
  v_mfma_f32_32x32x16_bf16 v[224:239], v[120:123], v[92:95], v[224:239]
  s_waitcnt lgkmcnt(0)
  v_mfma_f32_32x32x16_bf16 v[240:255], v[124:127], v[92:95], v[240:255]
  s_nop 7
  ds_read_b128 v[112:115], v9
  ds_read_b128 v[116:119], v10
  ds_read_b128 v[120:123], v11
  ds_read_b128 v[124:127], v12
  s_waitcnt lgkmcnt(3)
  v_mfma_f32_32x32x16_bf16 v[96:111], v[112:115], a[224:227], 0
  s_waitcnt lgkmcnt(2)
  v_mfma_f32_32x32x16_bf16 v[96:111], v[116:119], a[228:231], v[96:111]
  s_waitcnt lgkmcnt(1)
  v_mfma_f32_32x32x16_bf16 v[96:111], v[120:123], a[232:235], v[96:111]
  s_waitcnt lgkmcnt(0)
  v_mfma_f32_32x32x16_bf16 v[96:111], v[124:127], a[236:239], v[96:111]
  s_nop 7
  ds_read_b128 v[112:115], v13
  ds_read_b128 v[116:119], v14
  ds_read_b128 v[120:123], v15
  ds_read_b128 v[124:127], v16
  s_waitcnt lgkmcnt(3)
  v_mfma_f32_32x32x16_bf16 v[96:111], v[112:115], a[240:243], v[96:111]
  s_waitcnt lgkmcnt(2)
  v_mfma_f32_32x32x16_bf16 v[96:111], v[116:119], a[244:247], v[96:111]
  s_waitcnt lgkmcnt(1)
  v_mfma_f32_32x32x16_bf16 v[96:111], v[120:123], a[248:251], v[96:111]
  s_waitcnt lgkmcnt(0)
  v_mfma_f32_32x32x16_bf16 v[96:111], v[124:127], a[252:255], v[96:111]
  s_nop 7
  s_nop 3
  v_fma_f32 v96, v96, s20, v81
  v_fma_f32 v97, v97, s20, v81
  v_fma_f32 v98, v98, s20, v81
  v_fma_f32 v99, v99, s20, v81
  v_fma_f32 v100, v100, s20, v81
  v_fma_f32 v101, v101, s20, v81
  v_fma_f32 v102, v102, s20, v81
  v_fma_f32 v103, v103, s20, v81
  v_fma_f32 v104, v104, s20, v81
  v_fma_f32 v105, v105, s20, v81
  v_fma_f32 v106, v106, s20, v81
  v_fma_f32 v107, v107, s20, v81
  v_fma_f32 v108, v108, s20, v81
  v_fma_f32 v109, v109, s20, v81
  v_fma_f32 v110, v110, s20, v81
  v_fma_f32 v111, v111, s20, v81
  v_exp_f32 v96, v96
  v_exp_f32 v97, v97
  v_exp_f32 v98, v98
  v_exp_f32 v99, v99
  v_exp_f32 v100, v100
  v_exp_f32 v101, v101
  v_exp_f32 v102, v102
  v_exp_f32 v103, v103
  v_exp_f32 v104, v104
  v_exp_f32 v105, v105
  v_exp_f32 v106, v106
  v_exp_f32 v107, v107
  v_exp_f32 v108, v108
  v_exp_f32 v109, v109
  v_exp_f32 v110, v110
  v_exp_f32 v111, v111
  v_add_f32 v82, v82, v96
  v_add_f32 v82, v82, v97
  v_add_f32 v82, v82, v98
  v_add_f32 v82, v82, v99
  v_add_f32 v82, v82, v100
  v_add_f32 v82, v82, v101
  v_add_f32 v82, v82, v102
  v_add_f32 v82, v82, v103
  v_add_f32 v82, v82, v104
  v_add_f32 v82, v82, v105
  v_add_f32 v82, v82, v106
  v_add_f32 v82, v82, v107
  v_add_f32 v82, v82, v108
  v_add_f32 v82, v82, v109
  v_add_f32 v82, v82, v110
  v_add_f32 v82, v82, v111
  v_cvt_pk_bf16_f32 v88, v96, v97
  v_cvt_pk_bf16_f32 v89, v98, v99
  v_cvt_pk_bf16_f32 v90, v100, v101
  v_cvt_pk_bf16_f32 v91, v102, v103
  v_cvt_pk_bf16_f32 v92, v104, v105
  v_cvt_pk_bf16_f32 v93, v106, v107
  v_cvt_pk_bf16_f32 v94, v108, v109
  v_cvt_pk_bf16_f32 v95, v110, v111
  ds_read_b64_tr_b16 v[112:113], v17
  ds_read_b64_tr_b16 v[114:115], v17 offset:2048
  ds_read_b64_tr_b16 v[116:117], v18
  ds_read_b64_tr_b16 v[118:119], v18 offset:2048
  ds_read_b64_tr_b16 v[120:121], v19
  ds_read_b64_tr_b16 v[122:123], v19 offset:2048
  ds_read_b64_tr_b16 v[124:125], v20
  ds_read_b64_tr_b16 v[126:127], v20 offset:2048
  s_waitcnt lgkmcnt(6)
  v_mfma_f32_32x32x16_bf16 v[192:207], v[112:115], v[88:91], v[192:207]
  s_waitcnt lgkmcnt(4)
  v_mfma_f32_32x32x16_bf16 v[208:223], v[116:119], v[88:91], v[208:223]
  s_waitcnt lgkmcnt(2)
  v_mfma_f32_32x32x16_bf16 v[224:239], v[120:123], v[88:91], v[224:239]
  s_waitcnt lgkmcnt(0)
  v_mfma_f32_32x32x16_bf16 v[240:255], v[124:127], v[88:91], v[240:255]
  s_nop 7
  ds_read_b64_tr_b16 v[112:113], v17 offset:4096
  ds_read_b64_tr_b16 v[114:115], v17 offset:6144
  ds_read_b64_tr_b16 v[116:117], v18 offset:4096
  ds_read_b64_tr_b16 v[118:119], v18 offset:6144
  ds_read_b64_tr_b16 v[120:121], v19 offset:4096
  ds_read_b64_tr_b16 v[122:123], v19 offset:6144
  ds_read_b64_tr_b16 v[124:125], v20 offset:4096
  ds_read_b64_tr_b16 v[126:127], v20 offset:6144
  s_waitcnt lgkmcnt(6)
  v_mfma_f32_32x32x16_bf16 v[192:207], v[112:115], v[92:95], v[192:207]
  s_waitcnt lgkmcnt(4)
  v_mfma_f32_32x32x16_bf16 v[208:223], v[116:119], v[92:95], v[208:223]
  s_waitcnt lgkmcnt(2)
  v_mfma_f32_32x32x16_bf16 v[224:239], v[120:123], v[92:95], v[224:239]
  s_waitcnt lgkmcnt(0)
  v_mfma_f32_32x32x16_bf16 v[240:255], v[124:127], v[92:95], v[240:255]
  s_nop 7
  ds_read_b128 v[112:115], v9 offset:8192
  ds_read_b128 v[116:119], v10 offset:8192
  ds_read_b128 v[120:123], v11 offset:8192
  ds_read_b128 v[124:127], v12 offset:8192
  s_waitcnt lgkmcnt(3)
  v_mfma_f32_32x32x16_bf16 v[96:111], v[112:115], a[224:227], 0
  s_waitcnt lgkmcnt(2)
  v_mfma_f32_32x32x16_bf16 v[96:111], v[116:119], a[228:231], v[96:111]
  s_waitcnt lgkmcnt(1)
  v_mfma_f32_32x32x16_bf16 v[96:111], v[120:123], a[232:235], v[96:111]
  s_waitcnt lgkmcnt(0)
  v_mfma_f32_32x32x16_bf16 v[96:111], v[124:127], a[236:239], v[96:111]
  s_nop 7
  ds_read_b128 v[112:115], v13 offset:8192
  ds_read_b128 v[116:119], v14 offset:8192
  ds_read_b128 v[120:123], v15 offset:8192
  ds_read_b128 v[124:127], v16 offset:8192
  s_waitcnt lgkmcnt(3)
  v_mfma_f32_32x32x16_bf16 v[96:111], v[112:115], a[240:243], v[96:111]
  s_waitcnt lgkmcnt(2)
  v_mfma_f32_32x32x16_bf16 v[96:111], v[116:119], a[244:247], v[96:111]
  s_waitcnt lgkmcnt(1)
  v_mfma_f32_32x32x16_bf16 v[96:111], v[120:123], a[248:251], v[96:111]
  s_waitcnt lgkmcnt(0)
  v_mfma_f32_32x32x16_bf16 v[96:111], v[124:127], a[252:255], v[96:111]
  s_nop 7
  s_nop 3
  v_fma_f32 v96, v96, s20, v81
  v_fma_f32 v97, v97, s20, v81
  v_fma_f32 v98, v98, s20, v81
  v_fma_f32 v99, v99, s20, v81
  v_fma_f32 v100, v100, s20, v81
  v_fma_f32 v101, v101, s20, v81
  v_fma_f32 v102, v102, s20, v81
  v_fma_f32 v103, v103, s20, v81
  v_fma_f32 v104, v104, s20, v81
  v_fma_f32 v105, v105, s20, v81
  v_fma_f32 v106, v106, s20, v81
  v_fma_f32 v107, v107, s20, v81
  v_fma_f32 v108, v108, s20, v81
  v_fma_f32 v109, v109, s20, v81
  v_fma_f32 v110, v110, s20, v81
  v_fma_f32 v111, v111, s20, v81
  v_exp_f32 v96, v96
  v_exp_f32 v97, v97
  v_exp_f32 v98, v98
  v_exp_f32 v99, v99
  v_exp_f32 v100, v100
  v_exp_f32 v101, v101
  v_exp_f32 v102, v102
  v_exp_f32 v103, v103
  v_exp_f32 v104, v104
  v_exp_f32 v105, v105
  v_exp_f32 v106, v106
  v_exp_f32 v107, v107
  v_exp_f32 v108, v108
  v_exp_f32 v109, v109
  v_exp_f32 v110, v110
  v_exp_f32 v111, v111
  v_add_f32 v82, v82, v96
  v_add_f32 v82, v82, v97
  v_add_f32 v82, v82, v98
  v_add_f32 v82, v82, v99
  v_add_f32 v82, v82, v100
  v_add_f32 v82, v82, v101
  v_add_f32 v82, v82, v102
  v_add_f32 v82, v82, v103
  v_add_f32 v82, v82, v104
  v_add_f32 v82, v82, v105
  v_add_f32 v82, v82, v106
  v_add_f32 v82, v82, v107
  v_add_f32 v82, v82, v108
  v_add_f32 v82, v82, v109
  v_add_f32 v82, v82, v110
  v_add_f32 v82, v82, v111
  v_cvt_pk_bf16_f32 v88, v96, v97
  v_cvt_pk_bf16_f32 v89, v98, v99
  v_cvt_pk_bf16_f32 v90, v100, v101
  v_cvt_pk_bf16_f32 v91, v102, v103
  v_cvt_pk_bf16_f32 v92, v104, v105
  v_cvt_pk_bf16_f32 v93, v106, v107
  v_cvt_pk_bf16_f32 v94, v108, v109
  v_cvt_pk_bf16_f32 v95, v110, v111
  ds_read_b64_tr_b16 v[112:113], v17 offset:8192
  ds_read_b64_tr_b16 v[114:115], v17 offset:10240
  ds_read_b64_tr_b16 v[116:117], v18 offset:8192
  ds_read_b64_tr_b16 v[118:119], v18 offset:10240
  ds_read_b64_tr_b16 v[120:121], v19 offset:8192
  ds_read_b64_tr_b16 v[122:123], v19 offset:10240
  ds_read_b64_tr_b16 v[124:125], v20 offset:8192
  ds_read_b64_tr_b16 v[126:127], v20 offset:10240
  s_waitcnt lgkmcnt(6)
  v_mfma_f32_32x32x16_bf16 v[192:207], v[112:115], v[88:91], v[192:207]
  s_waitcnt lgkmcnt(4)
  v_mfma_f32_32x32x16_bf16 v[208:223], v[116:119], v[88:91], v[208:223]
  s_waitcnt lgkmcnt(2)
  v_mfma_f32_32x32x16_bf16 v[224:239], v[120:123], v[88:91], v[224:239]
  s_waitcnt lgkmcnt(0)
  v_mfma_f32_32x32x16_bf16 v[240:255], v[124:127], v[88:91], v[240:255]
  s_nop 7
  ds_read_b64_tr_b16 v[112:113], v17 offset:12288
  ds_read_b64_tr_b16 v[114:115], v17 offset:14336
  ds_read_b64_tr_b16 v[116:117], v18 offset:12288
  ds_read_b64_tr_b16 v[118:119], v18 offset:14336
  ds_read_b64_tr_b16 v[120:121], v19 offset:12288
  ds_read_b64_tr_b16 v[122:123], v19 offset:14336
  ds_read_b64_tr_b16 v[124:125], v20 offset:12288
  ds_read_b64_tr_b16 v[126:127], v20 offset:14336
  s_waitcnt lgkmcnt(6)
  v_mfma_f32_32x32x16_bf16 v[192:207], v[112:115], v[92:95], v[192:207]
  s_waitcnt lgkmcnt(4)
  v_mfma_f32_32x32x16_bf16 v[208:223], v[116:119], v[92:95], v[208:223]
  s_waitcnt lgkmcnt(2)
  v_mfma_f32_32x32x16_bf16 v[224:239], v[120:123], v[92:95], v[224:239]
  s_waitcnt lgkmcnt(0)
  v_mfma_f32_32x32x16_bf16 v[240:255], v[124:127], v[92:95], v[240:255]
  s_nop 7
  ds_read_b128 v[112:115], v9 offset:16384
  ds_read_b128 v[116:119], v10 offset:16384
  ds_read_b128 v[120:123], v11 offset:16384
  ds_read_b128 v[124:127], v12 offset:16384
  s_waitcnt lgkmcnt(3)
  v_mfma_f32_32x32x16_bf16 v[96:111], v[112:115], a[224:227], 0
  s_waitcnt lgkmcnt(2)
  v_mfma_f32_32x32x16_bf16 v[96:111], v[116:119], a[228:231], v[96:111]
  s_waitcnt lgkmcnt(1)
  v_mfma_f32_32x32x16_bf16 v[96:111], v[120:123], a[232:235], v[96:111]
  s_waitcnt lgkmcnt(0)
  v_mfma_f32_32x32x16_bf16 v[96:111], v[124:127], a[236:239], v[96:111]
  s_nop 7
  ds_read_b128 v[112:115], v13 offset:16384
  ds_read_b128 v[116:119], v14 offset:16384
  ds_read_b128 v[120:123], v15 offset:16384
  ds_read_b128 v[124:127], v16 offset:16384
  s_waitcnt lgkmcnt(3)
  v_mfma_f32_32x32x16_bf16 v[96:111], v[112:115], a[240:243], v[96:111]
  s_waitcnt lgkmcnt(2)
  v_mfma_f32_32x32x16_bf16 v[96:111], v[116:119], a[244:247], v[96:111]
  s_waitcnt lgkmcnt(1)
  v_mfma_f32_32x32x16_bf16 v[96:111], v[120:123], a[248:251], v[96:111]
  s_waitcnt lgkmcnt(0)
  v_mfma_f32_32x32x16_bf16 v[96:111], v[124:127], a[252:255], v[96:111]
  s_nop 7
  s_nop 3
  v_fma_f32 v96, v96, s20, v81
  v_fma_f32 v97, v97, s20, v81
  v_fma_f32 v98, v98, s20, v81
  v_fma_f32 v99, v99, s20, v81
  v_fma_f32 v100, v100, s20, v81
  v_fma_f32 v101, v101, s20, v81
  v_fma_f32 v102, v102, s20, v81
  v_fma_f32 v103, v103, s20, v81
  v_fma_f32 v104, v104, s20, v81
  v_fma_f32 v105, v105, s20, v81
  v_fma_f32 v106, v106, s20, v81
  v_fma_f32 v107, v107, s20, v81
  v_fma_f32 v108, v108, s20, v81
  v_fma_f32 v109, v109, s20, v81
  v_fma_f32 v110, v110, s20, v81
  v_fma_f32 v111, v111, s20, v81
  v_exp_f32 v96, v96
  v_exp_f32 v97, v97
  v_exp_f32 v98, v98
  v_exp_f32 v99, v99
  v_exp_f32 v100, v100
  v_exp_f32 v101, v101
  v_exp_f32 v102, v102
  v_exp_f32 v103, v103
  v_exp_f32 v104, v104
  v_exp_f32 v105, v105
  v_exp_f32 v106, v106
  v_exp_f32 v107, v107
  v_exp_f32 v108, v108
  v_exp_f32 v109, v109
  v_exp_f32 v110, v110
  v_exp_f32 v111, v111
  v_add_f32 v82, v82, v96
  v_add_f32 v82, v82, v97
  v_add_f32 v82, v82, v98
  v_add_f32 v82, v82, v99
  v_add_f32 v82, v82, v100
  v_add_f32 v82, v82, v101
  v_add_f32 v82, v82, v102
  v_add_f32 v82, v82, v103
  v_add_f32 v82, v82, v104
  v_add_f32 v82, v82, v105
  v_add_f32 v82, v82, v106
  v_add_f32 v82, v82, v107
  v_add_f32 v82, v82, v108
  v_add_f32 v82, v82, v109
  v_add_f32 v82, v82, v110
  v_add_f32 v82, v82, v111
  v_cvt_pk_bf16_f32 v88, v96, v97
  v_cvt_pk_bf16_f32 v89, v98, v99
  v_cvt_pk_bf16_f32 v90, v100, v101
  v_cvt_pk_bf16_f32 v91, v102, v103
  v_cvt_pk_bf16_f32 v92, v104, v105
  v_cvt_pk_bf16_f32 v93, v106, v107
  v_cvt_pk_bf16_f32 v94, v108, v109
  v_cvt_pk_bf16_f32 v95, v110, v111
  ds_read_b64_tr_b16 v[112:113], v17 offset:16384
  ds_read_b64_tr_b16 v[114:115], v17 offset:18432
  ds_read_b64_tr_b16 v[116:117], v18 offset:16384
  ds_read_b64_tr_b16 v[118:119], v18 offset:18432
  ds_read_b64_tr_b16 v[120:121], v19 offset:16384
  ds_read_b64_tr_b16 v[122:123], v19 offset:18432
  ds_read_b64_tr_b16 v[124:125], v20 offset:16384
  ds_read_b64_tr_b16 v[126:127], v20 offset:18432
  s_waitcnt lgkmcnt(6)
  v_mfma_f32_32x32x16_bf16 v[192:207], v[112:115], v[88:91], v[192:207]
  s_waitcnt lgkmcnt(4)
  v_mfma_f32_32x32x16_bf16 v[208:223], v[116:119], v[88:91], v[208:223]
  s_waitcnt lgkmcnt(2)
  v_mfma_f32_32x32x16_bf16 v[224:239], v[120:123], v[88:91], v[224:239]
  s_waitcnt lgkmcnt(0)
  v_mfma_f32_32x32x16_bf16 v[240:255], v[124:127], v[88:91], v[240:255]
  s_nop 7
  ds_read_b64_tr_b16 v[112:113], v17 offset:20480
  ds_read_b64_tr_b16 v[114:115], v17 offset:22528
  ds_read_b64_tr_b16 v[116:117], v18 offset:20480
  ds_read_b64_tr_b16 v[118:119], v18 offset:22528
  ds_read_b64_tr_b16 v[120:121], v19 offset:20480
  ds_read_b64_tr_b16 v[122:123], v19 offset:22528
  ds_read_b64_tr_b16 v[124:125], v20 offset:20480
  ds_read_b64_tr_b16 v[126:127], v20 offset:22528
  s_waitcnt lgkmcnt(6)
  v_mfma_f32_32x32x16_bf16 v[192:207], v[112:115], v[92:95], v[192:207]
  s_waitcnt lgkmcnt(4)
  v_mfma_f32_32x32x16_bf16 v[208:223], v[116:119], v[92:95], v[208:223]
  s_waitcnt lgkmcnt(2)
  v_mfma_f32_32x32x16_bf16 v[224:239], v[120:123], v[92:95], v[224:239]
  s_waitcnt lgkmcnt(0)
  v_mfma_f32_32x32x16_bf16 v[240:255], v[124:127], v[92:95], v[240:255]
  s_nop 7
  ds_read_b128 v[112:115], v9 offset:24576
  ds_read_b128 v[116:119], v10 offset:24576
  ds_read_b128 v[120:123], v11 offset:24576
  ds_read_b128 v[124:127], v12 offset:24576
  s_waitcnt lgkmcnt(3)
  v_mfma_f32_32x32x16_bf16 v[96:111], v[112:115], a[224:227], 0
  s_waitcnt lgkmcnt(2)
  v_mfma_f32_32x32x16_bf16 v[96:111], v[116:119], a[228:231], v[96:111]
  s_waitcnt lgkmcnt(1)
  v_mfma_f32_32x32x16_bf16 v[96:111], v[120:123], a[232:235], v[96:111]
  s_waitcnt lgkmcnt(0)
  v_mfma_f32_32x32x16_bf16 v[96:111], v[124:127], a[236:239], v[96:111]
  s_nop 7
  ds_read_b128 v[112:115], v13 offset:24576
  ds_read_b128 v[116:119], v14 offset:24576
  ds_read_b128 v[120:123], v15 offset:24576
  ds_read_b128 v[124:127], v16 offset:24576
  s_waitcnt lgkmcnt(3)
  v_mfma_f32_32x32x16_bf16 v[96:111], v[112:115], a[240:243], v[96:111]
  s_waitcnt lgkmcnt(2)
  v_mfma_f32_32x32x16_bf16 v[96:111], v[116:119], a[244:247], v[96:111]
  s_waitcnt lgkmcnt(1)
  v_mfma_f32_32x32x16_bf16 v[96:111], v[120:123], a[248:251], v[96:111]
  s_waitcnt lgkmcnt(0)
  v_mfma_f32_32x32x16_bf16 v[96:111], v[124:127], a[252:255], v[96:111]
  s_nop 7
  s_nop 3
  v_fma_f32 v96, v96, s20, v81
  v_fma_f32 v97, v97, s20, v81
  v_fma_f32 v98, v98, s20, v81
  v_fma_f32 v99, v99, s20, v81
  v_fma_f32 v100, v100, s20, v81
  v_fma_f32 v101, v101, s20, v81
  v_fma_f32 v102, v102, s20, v81
  v_fma_f32 v103, v103, s20, v81
  v_fma_f32 v104, v104, s20, v81
  v_fma_f32 v105, v105, s20, v81
  v_fma_f32 v106, v106, s20, v81
  v_fma_f32 v107, v107, s20, v81
  v_fma_f32 v108, v108, s20, v81
  v_fma_f32 v109, v109, s20, v81
  v_fma_f32 v110, v110, s20, v81
  v_fma_f32 v111, v111, s20, v81
  v_exp_f32 v96, v96
  v_exp_f32 v97, v97
  v_exp_f32 v98, v98
  v_exp_f32 v99, v99
  v_exp_f32 v100, v100
  v_exp_f32 v101, v101
  v_exp_f32 v102, v102
  v_exp_f32 v103, v103
  v_exp_f32 v104, v104
  v_exp_f32 v105, v105
  v_exp_f32 v106, v106
  v_exp_f32 v107, v107
  v_exp_f32 v108, v108
  v_exp_f32 v109, v109
  v_exp_f32 v110, v110
  v_exp_f32 v111, v111
  v_add_f32 v82, v82, v96
  v_add_f32 v82, v82, v97
  v_add_f32 v82, v82, v98
  v_add_f32 v82, v82, v99
  v_add_f32 v82, v82, v100
  v_add_f32 v82, v82, v101
  v_add_f32 v82, v82, v102
  v_add_f32 v82, v82, v103
  v_add_f32 v82, v82, v104
  v_add_f32 v82, v82, v105
  v_add_f32 v82, v82, v106
  v_add_f32 v82, v82, v107
  v_add_f32 v82, v82, v108
  v_add_f32 v82, v82, v109
  v_add_f32 v82, v82, v110
  v_add_f32 v82, v82, v111
  v_cvt_pk_bf16_f32 v88, v96, v97
  v_cvt_pk_bf16_f32 v89, v98, v99
  v_cvt_pk_bf16_f32 v90, v100, v101
  v_cvt_pk_bf16_f32 v91, v102, v103
  v_cvt_pk_bf16_f32 v92, v104, v105
  v_cvt_pk_bf16_f32 v93, v106, v107
  v_cvt_pk_bf16_f32 v94, v108, v109
  v_cvt_pk_bf16_f32 v95, v110, v111
  ds_read_b64_tr_b16 v[112:113], v17 offset:24576
  ds_read_b64_tr_b16 v[114:115], v17 offset:26624
  ds_read_b64_tr_b16 v[116:117], v18 offset:24576
  ds_read_b64_tr_b16 v[118:119], v18 offset:26624
  ds_read_b64_tr_b16 v[120:121], v19 offset:24576
  ds_read_b64_tr_b16 v[122:123], v19 offset:26624
  ds_read_b64_tr_b16 v[124:125], v20 offset:24576
  ds_read_b64_tr_b16 v[126:127], v20 offset:26624
  s_waitcnt lgkmcnt(6)
  v_mfma_f32_32x32x16_bf16 v[192:207], v[112:115], v[88:91], v[192:207]
  s_waitcnt lgkmcnt(4)
  v_mfma_f32_32x32x16_bf16 v[208:223], v[116:119], v[88:91], v[208:223]
  s_waitcnt lgkmcnt(2)
  v_mfma_f32_32x32x16_bf16 v[224:239], v[120:123], v[88:91], v[224:239]
  s_waitcnt lgkmcnt(0)
  v_mfma_f32_32x32x16_bf16 v[240:255], v[124:127], v[88:91], v[240:255]
  s_nop 7
  ds_read_b64_tr_b16 v[112:113], v17 offset:28672
  ds_read_b64_tr_b16 v[114:115], v17 offset:30720
  ds_read_b64_tr_b16 v[116:117], v18 offset:28672
  ds_read_b64_tr_b16 v[118:119], v18 offset:30720
  ds_read_b64_tr_b16 v[120:121], v19 offset:28672
  ds_read_b64_tr_b16 v[122:123], v19 offset:30720
  ds_read_b64_tr_b16 v[124:125], v20 offset:28672
  ds_read_b64_tr_b16 v[126:127], v20 offset:30720
  s_waitcnt lgkmcnt(6)
  v_mfma_f32_32x32x16_bf16 v[192:207], v[112:115], v[92:95], v[192:207]
  s_waitcnt lgkmcnt(4)
  v_mfma_f32_32x32x16_bf16 v[208:223], v[116:119], v[92:95], v[208:223]
  s_waitcnt lgkmcnt(2)
  v_mfma_f32_32x32x16_bf16 v[224:239], v[120:123], v[92:95], v[224:239]
  s_waitcnt lgkmcnt(0)
  v_mfma_f32_32x32x16_bf16 v[240:255], v[124:127], v[92:95], v[240:255]
  s_nop 7
  v_mov_b32 v83, v82
  s_nop 1
  v_permlane32_swap_b32 v82, v83
  v_add_f32 v40, v82, v83
  v_rcp_f32 v40, v40
  s_nop 7
  s_nop 7
  buffer_load_dwordx4 v[80:83], v41, s[52:55], 0 offen
  buffer_load_dwordx4 v[84:87], v41, s[52:55], 0 offen offset:1024
  buffer_load_dwordx4 v[88:91], v41, s[52:55], 0 offen offset:2048
  buffer_load_dwordx4 v[92:95], v41, s[52:55], 0 offen offset:3072
  buffer_load_dwordx4 v[96:99], v41, s[52:55], s44 offen
  buffer_load_dwordx4 v[100:103], v41, s[52:55], s44 offen offset:1024
  buffer_load_dwordx4 v[104:107], v41, s[52:55], s44 offen offset:2048
  buffer_load_dwordx4 v[108:111], v41, s[52:55], s44 offen offset:3072
  buffer_load_dwordx4 v[112:115], v41, s[52:55], s35 offen
  buffer_load_dwordx4 v[116:119], v41, s[52:55], s35 offen offset:1024
  buffer_load_dwordx4 v[120:123], v41, s[52:55], s35 offen offset:2048
  buffer_load_dwordx4 v[124:127], v41, s[52:55], s35 offen offset:3072
  s_waitcnt vmcnt(0)
  s_setpc_b64 s[32:33]
L_SLOW2:
  s_waitcnt lgkmcnt(0)
  s_nop 7
  s_nop 7
  ds_read_b128 v[112:115], v1
  ds_read_b128 v[116:119], v2
  ds_read_b128 v[120:123], v3
  ds_read_b128 v[124:127], v4
  s_waitcnt lgkmcnt(3)
  v_mfma_f32_32x32x16_bf16 v[96:111], v[112:115], a[192:195], 0
  s_waitcnt lgkmcnt(2)
  v_mfma_f32_32x32x16_bf16 v[96:111], v[116:119], a[196:199], v[96:111]
  s_waitcnt lgkmcnt(1)
  v_mfma_f32_32x32x16_bf16 v[96:111], v[120:123], a[200:203], v[96:111]
  s_waitcnt lgkmcnt(0)
  v_mfma_f32_32x32x16_bf16 v[96:111], v[124:127], a[204:207], v[96:111]
  s_nop 7
  ds_read_b128 v[112:115], v5
  ds_read_b128 v[116:119], v6
  ds_read_b128 v[120:123], v7
  ds_read_b128 v[124:127], v8
  s_waitcnt lgkmcnt(3)
  v_mfma_f32_32x32x16_bf16 v[96:111], v[112:115], a[208:211], v[96:111]
  s_waitcnt lgkmcnt(2)
  v_mfma_f32_32x32x16_bf16 v[96:111], v[116:119], a[212:215], v[96:111]
  s_waitcnt lgkmcnt(1)
  v_mfma_f32_32x32x16_bf16 v[96:111], v[120:123], a[216:219], v[96:111]
  s_waitcnt lgkmcnt(0)
  v_mfma_f32_32x32x16_bf16 v[96:111], v[124:127], a[220:223], v[96:111]
  s_nop 7
  s_nop 3
  v_max_f32 v26, v96, v97
  v_max3_f32 v26, v26, v98, v99
  v_max3_f32 v26, v26, v100, v101
  v_max3_f32 v26, v26, v102, v103
  v_max3_f32 v26, v26, v104, v105
  v_max3_f32 v26, v26, v106, v107
  v_max3_f32 v26, v26, v108, v109
  v_max3_f32 v26, v26, v110, v111
  ds_read_b128 v[112:115], v1 offset:8192
  ds_read_b128 v[116:119], v2 offset:8192
  ds_read_b128 v[120:123], v3 offset:8192
  ds_read_b128 v[124:127], v4 offset:8192
  s_waitcnt lgkmcnt(3)
  v_mfma_f32_32x32x16_bf16 v[96:111], v[112:115], a[192:195], 0
  s_waitcnt lgkmcnt(2)
  v_mfma_f32_32x32x16_bf16 v[96:111], v[116:119], a[196:199], v[96:111]
  s_waitcnt lgkmcnt(1)
  v_mfma_f32_32x32x16_bf16 v[96:111], v[120:123], a[200:203], v[96:111]
  s_waitcnt lgkmcnt(0)
  v_mfma_f32_32x32x16_bf16 v[96:111], v[124:127], a[204:207], v[96:111]
  s_nop 7
  ds_read_b128 v[112:115], v5 offset:8192
  ds_read_b128 v[116:119], v6 offset:8192
  ds_read_b128 v[120:123], v7 offset:8192
  ds_read_b128 v[124:127], v8 offset:8192
  s_waitcnt lgkmcnt(3)
  v_mfma_f32_32x32x16_bf16 v[96:111], v[112:115], a[208:211], v[96:111]
  s_waitcnt lgkmcnt(2)
  v_mfma_f32_32x32x16_bf16 v[96:111], v[116:119], a[212:215], v[96:111]
  s_waitcnt lgkmcnt(1)
  v_mfma_f32_32x32x16_bf16 v[96:111], v[120:123], a[216:219], v[96:111]
  s_waitcnt lgkmcnt(0)
  v_mfma_f32_32x32x16_bf16 v[96:111], v[124:127], a[220:223], v[96:111]
  s_nop 7
  s_nop 3
  v_max3_f32 v26, v26, v96, v97
  v_max3_f32 v26, v26, v98, v99
  v_max3_f32 v26, v26, v100, v101
  v_max3_f32 v26, v26, v102, v103
  v_max3_f32 v26, v26, v104, v105
  v_max3_f32 v26, v26, v106, v107
  v_max3_f32 v26, v26, v108, v109
  v_max3_f32 v26, v26, v110, v111
  ds_read_b128 v[112:115], v1 offset:16384
  ds_read_b128 v[116:119], v2 offset:16384
  ds_read_b128 v[120:123], v3 offset:16384
  ds_read_b128 v[124:127], v4 offset:16384
  s_waitcnt lgkmcnt(3)
  v_mfma_f32_32x32x16_bf16 v[96:111], v[112:115], a[192:195], 0
  s_waitcnt lgkmcnt(2)
  v_mfma_f32_32x32x16_bf16 v[96:111], v[116:119], a[196:199], v[96:111]
  s_waitcnt lgkmcnt(1)
  v_mfma_f32_32x32x16_bf16 v[96:111], v[120:123], a[200:203], v[96:111]
  s_waitcnt lgkmcnt(0)
  v_mfma_f32_32x32x16_bf16 v[96:111], v[124:127], a[204:207], v[96:111]
  s_nop 7
  ds_read_b128 v[112:115], v5 offset:16384
  ds_read_b128 v[116:119], v6 offset:16384
  ds_read_b128 v[120:123], v7 offset:16384
  ds_read_b128 v[124:127], v8 offset:16384
  s_waitcnt lgkmcnt(3)
  v_mfma_f32_32x32x16_bf16 v[96:111], v[112:115], a[208:211], v[96:111]
  s_waitcnt lgkmcnt(2)
  v_mfma_f32_32x32x16_bf16 v[96:111], v[116:119], a[212:215], v[96:111]
  s_waitcnt lgkmcnt(1)
  v_mfma_f32_32x32x16_bf16 v[96:111], v[120:123], a[216:219], v[96:111]
  s_waitcnt lgkmcnt(0)
  v_mfma_f32_32x32x16_bf16 v[96:111], v[124:127], a[220:223], v[96:111]
  s_nop 7
  s_nop 3
  v_max3_f32 v26, v26, v96, v97
  v_max3_f32 v26, v26, v98, v99
  v_max3_f32 v26, v26, v100, v101
  v_max3_f32 v26, v26, v102, v103
  v_max3_f32 v26, v26, v104, v105
  v_max3_f32 v26, v26, v106, v107
  v_max3_f32 v26, v26, v108, v109
  v_max3_f32 v26, v26, v110, v111
  ds_read_b128 v[112:115], v1 offset:24576
  ds_read_b128 v[116:119], v2 offset:24576
  ds_read_b128 v[120:123], v3 offset:24576
  ds_read_b128 v[124:127], v4 offset:24576
  s_waitcnt lgkmcnt(3)
  v_mfma_f32_32x32x16_bf16 v[96:111], v[112:115], a[192:195], 0
  s_waitcnt lgkmcnt(2)
  v_mfma_f32_32x32x16_bf16 v[96:111], v[116:119], a[196:199], v[96:111]
  s_waitcnt lgkmcnt(1)
  v_mfma_f32_32x32x16_bf16 v[96:111], v[120:123], a[200:203], v[96:111]
  s_waitcnt lgkmcnt(0)
  v_mfma_f32_32x32x16_bf16 v[96:111], v[124:127], a[204:207], v[96:111]
  s_nop 7
  ds_read_b128 v[112:115], v5 offset:24576
  ds_read_b128 v[116:119], v6 offset:24576
  ds_read_b128 v[120:123], v7 offset:24576
  ds_read_b128 v[124:127], v8 offset:24576
  s_waitcnt lgkmcnt(3)
  v_mfma_f32_32x32x16_bf16 v[96:111], v[112:115], a[208:211], v[96:111]
  s_waitcnt lgkmcnt(2)
  v_mfma_f32_32x32x16_bf16 v[96:111], v[116:119], a[212:215], v[96:111]
  s_waitcnt lgkmcnt(1)
  v_mfma_f32_32x32x16_bf16 v[96:111], v[120:123], a[216:219], v[96:111]
  s_waitcnt lgkmcnt(0)
  v_mfma_f32_32x32x16_bf16 v[96:111], v[124:127], a[220:223], v[96:111]
  s_nop 7
  s_nop 3
  v_max3_f32 v26, v26, v96, v97
  v_max3_f32 v26, v26, v98, v99
  v_max3_f32 v26, v26, v100, v101
  v_max3_f32 v26, v26, v102, v103
  v_max3_f32 v26, v26, v104, v105
  v_max3_f32 v26, v26, v106, v107
  v_max3_f32 v26, v26, v108, v109
  v_max3_f32 v26, v26, v110, v111
  ds_read_b128 v[112:115], v1 offset:32768
  ds_read_b128 v[116:119], v2 offset:32768
  ds_read_b128 v[120:123], v3 offset:32768
  ds_read_b128 v[124:127], v4 offset:32768
  s_waitcnt lgkmcnt(3)
  v_mfma_f32_32x32x16_bf16 v[96:111], v[112:115], a[192:195], 0
  s_waitcnt lgkmcnt(2)
  v_mfma_f32_32x32x16_bf16 v[96:111], v[116:119], a[196:199], v[96:111]
  s_waitcnt lgkmcnt(1)
  v_mfma_f32_32x32x16_bf16 v[96:111], v[120:123], a[200:203], v[96:111]
  s_waitcnt lgkmcnt(0)
  v_mfma_f32_32x32x16_bf16 v[96:111], v[124:127], a[204:207], v[96:111]
  s_nop 7
  ds_read_b128 v[112:115], v5 offset:32768
  ds_read_b128 v[116:119], v6 offset:32768
  ds_read_b128 v[120:123], v7 offset:32768
  ds_read_b128 v[124:127], v8 offset:32768
  s_waitcnt lgkmcnt(3)
  v_mfma_f32_32x32x16_bf16 v[96:111], v[112:115], a[208:211], v[96:111]
  s_waitcnt lgkmcnt(2)
  v_mfma_f32_32x32x16_bf16 v[96:111], v[116:119], a[212:215], v[96:111]
  s_waitcnt lgkmcnt(1)
  v_mfma_f32_32x32x16_bf16 v[96:111], v[120:123], a[216:219], v[96:111]
  s_waitcnt lgkmcnt(0)
  v_mfma_f32_32x32x16_bf16 v[96:111], v[124:127], a[220:223], v[96:111]
  s_nop 7
  s_nop 3
  v_max3_f32 v26, v26, v96, v97
  v_max3_f32 v26, v26, v98, v99
  v_max3_f32 v26, v26, v100, v101
  v_max3_f32 v26, v26, v102, v103
  v_max3_f32 v26, v26, v104, v105
  v_max3_f32 v26, v26, v106, v107
  v_max3_f32 v26, v26, v108, v109
  v_max3_f32 v26, v26, v110, v111
  ds_read_b128 v[112:115], v1 offset:49152
  ds_read_b128 v[116:119], v2 offset:49152
  ds_read_b128 v[120:123], v3 offset:49152
  ds_read_b128 v[124:127], v4 offset:49152
  s_waitcnt lgkmcnt(3)
  v_mfma_f32_32x32x16_bf16 v[96:111], v[112:115], a[192:195], 0
  s_waitcnt lgkmcnt(2)
  v_mfma_f32_32x32x16_bf16 v[96:111], v[116:119], a[196:199], v[96:111]
  s_waitcnt lgkmcnt(1)
  v_mfma_f32_32x32x16_bf16 v[96:111], v[120:123], a[200:203], v[96:111]
  s_waitcnt lgkmcnt(0)
  v_mfma_f32_32x32x16_bf16 v[96:111], v[124:127], a[204:207], v[96:111]
  s_nop 7
  ds_read_b128 v[112:115], v5 offset:49152
  ds_read_b128 v[116:119], v6 offset:49152
  ds_read_b128 v[120:123], v7 offset:49152
  ds_read_b128 v[124:127], v8 offset:49152
  s_waitcnt lgkmcnt(3)
  v_mfma_f32_32x32x16_bf16 v[96:111], v[112:115], a[208:211], v[96:111]
  s_waitcnt lgkmcnt(2)
  v_mfma_f32_32x32x16_bf16 v[96:111], v[116:119], a[212:215], v[96:111]
  s_waitcnt lgkmcnt(1)
  v_mfma_f32_32x32x16_bf16 v[96:111], v[120:123], a[216:219], v[96:111]
  s_waitcnt lgkmcnt(0)
  v_mfma_f32_32x32x16_bf16 v[96:111], v[124:127], a[220:223], v[96:111]
  s_nop 7
  s_nop 3
  v_max3_f32 v26, v26, v96, v97
  v_max3_f32 v26, v26, v98, v99
  v_max3_f32 v26, v26, v100, v101
  v_max3_f32 v26, v26, v102, v103
  v_max3_f32 v26, v26, v104, v105
  v_max3_f32 v26, v26, v106, v107
  v_max3_f32 v26, v26, v108, v109
  v_max3_f32 v26, v26, v110, v111
  ds_read_b128 v[112:115], v1 offset:57344
  ds_read_b128 v[116:119], v2 offset:57344
  ds_read_b128 v[120:123], v3 offset:57344
  ds_read_b128 v[124:127], v4 offset:57344
  s_waitcnt lgkmcnt(3)
  v_mfma_f32_32x32x16_bf16 v[96:111], v[112:115], a[192:195], 0
  s_waitcnt lgkmcnt(2)
  v_mfma_f32_32x32x16_bf16 v[96:111], v[116:119], a[196:199], v[96:111]
  s_waitcnt lgkmcnt(1)
  v_mfma_f32_32x32x16_bf16 v[96:111], v[120:123], a[200:203], v[96:111]
  s_waitcnt lgkmcnt(0)
  v_mfma_f32_32x32x16_bf16 v[96:111], v[124:127], a[204:207], v[96:111]
  s_nop 7
  ds_read_b128 v[112:115], v5 offset:57344
  ds_read_b128 v[116:119], v6 offset:57344
  ds_read_b128 v[120:123], v7 offset:57344
  ds_read_b128 v[124:127], v8 offset:57344
  s_waitcnt lgkmcnt(3)
  v_mfma_f32_32x32x16_bf16 v[96:111], v[112:115], a[208:211], v[96:111]
  s_waitcnt lgkmcnt(2)
  v_mfma_f32_32x32x16_bf16 v[96:111], v[116:119], a[212:215], v[96:111]
  s_waitcnt lgkmcnt(1)
  v_mfma_f32_32x32x16_bf16 v[96:111], v[120:123], a[216:219], v[96:111]
  s_waitcnt lgkmcnt(0)
  v_mfma_f32_32x32x16_bf16 v[96:111], v[124:127], a[220:223], v[96:111]
  s_nop 7
  s_nop 3
  v_max3_f32 v26, v26, v96, v97
  v_max3_f32 v26, v26, v98, v99
  v_max3_f32 v26, v26, v100, v101
  v_max3_f32 v26, v26, v102, v103
  v_max3_f32 v26, v26, v104, v105
  v_max3_f32 v26, v26, v106, v107
  v_max3_f32 v26, v26, v108, v109
  v_max3_f32 v26, v26, v110, v111
  ds_read_b128 v[112:115], v9
  ds_read_b128 v[116:119], v10
  ds_read_b128 v[120:123], v11
  ds_read_b128 v[124:127], v12
  s_waitcnt lgkmcnt(3)
  v_mfma_f32_32x32x16_bf16 v[96:111], v[112:115], a[192:195], 0
  s_waitcnt lgkmcnt(2)
  v_mfma_f32_32x32x16_bf16 v[96:111], v[116:119], a[196:199], v[96:111]
  s_waitcnt lgkmcnt(1)
  v_mfma_f32_32x32x16_bf16 v[96:111], v[120:123], a[200:203], v[96:111]
  s_waitcnt lgkmcnt(0)
  v_mfma_f32_32x32x16_bf16 v[96:111], v[124:127], a[204:207], v[96:111]
  s_nop 7
  ds_read_b128 v[112:115], v13
  ds_read_b128 v[116:119], v14
  ds_read_b128 v[120:123], v15
  ds_read_b128 v[124:127], v16
  s_waitcnt lgkmcnt(3)
  v_mfma_f32_32x32x16_bf16 v[96:111], v[112:115], a[208:211], v[96:111]
  s_waitcnt lgkmcnt(2)
  v_mfma_f32_32x32x16_bf16 v[96:111], v[116:119], a[212:215], v[96:111]
  s_waitcnt lgkmcnt(1)
  v_mfma_f32_32x32x16_bf16 v[96:111], v[120:123], a[216:219], v[96:111]
  s_waitcnt lgkmcnt(0)
  v_mfma_f32_32x32x16_bf16 v[96:111], v[124:127], a[220:223], v[96:111]
  s_nop 7
  s_nop 3
  v_max3_f32 v26, v26, v96, v97
  v_max3_f32 v26, v26, v98, v99
  v_max3_f32 v26, v26, v100, v101
  v_max3_f32 v26, v26, v102, v103
  v_max3_f32 v26, v26, v104, v105
  v_max3_f32 v26, v26, v106, v107
  v_max3_f32 v26, v26, v108, v109
  v_max3_f32 v26, v26, v110, v111
  ds_read_b128 v[112:115], v9 offset:8192
  ds_read_b128 v[116:119], v10 offset:8192
  ds_read_b128 v[120:123], v11 offset:8192
  ds_read_b128 v[124:127], v12 offset:8192
  s_waitcnt lgkmcnt(3)
  v_mfma_f32_32x32x16_bf16 v[96:111], v[112:115], a[192:195], 0
  s_waitcnt lgkmcnt(2)
  v_mfma_f32_32x32x16_bf16 v[96:111], v[116:119], a[196:199], v[96:111]
  s_waitcnt lgkmcnt(1)
  v_mfma_f32_32x32x16_bf16 v[96:111], v[120:123], a[200:203], v[96:111]
  s_waitcnt lgkmcnt(0)
  v_mfma_f32_32x32x16_bf16 v[96:111], v[124:127], a[204:207], v[96:111]
  s_nop 7
  ds_read_b128 v[112:115], v13 offset:8192
  ds_read_b128 v[116:119], v14 offset:8192
  ds_read_b128 v[120:123], v15 offset:8192
  ds_read_b128 v[124:127], v16 offset:8192
  s_waitcnt lgkmcnt(3)
  v_mfma_f32_32x32x16_bf16 v[96:111], v[112:115], a[208:211], v[96:111]
  s_waitcnt lgkmcnt(2)
  v_mfma_f32_32x32x16_bf16 v[96:111], v[116:119], a[212:215], v[96:111]
  s_waitcnt lgkmcnt(1)
  v_mfma_f32_32x32x16_bf16 v[96:111], v[120:123], a[216:219], v[96:111]
  s_waitcnt lgkmcnt(0)
  v_mfma_f32_32x32x16_bf16 v[96:111], v[124:127], a[220:223], v[96:111]
  s_nop 7
  s_nop 3
  v_max3_f32 v26, v26, v96, v97
  v_max3_f32 v26, v26, v98, v99
  v_max3_f32 v26, v26, v100, v101
  v_max3_f32 v26, v26, v102, v103
  v_max3_f32 v26, v26, v104, v105
  v_max3_f32 v26, v26, v106, v107
  v_max3_f32 v26, v26, v108, v109
  v_max3_f32 v26, v26, v110, v111
  ds_read_b128 v[112:115], v9 offset:16384
  ds_read_b128 v[116:119], v10 offset:16384
  ds_read_b128 v[120:123], v11 offset:16384
  ds_read_b128 v[124:127], v12 offset:16384
  s_waitcnt lgkmcnt(3)
  v_mfma_f32_32x32x16_bf16 v[96:111], v[112:115], a[192:195], 0
  s_waitcnt lgkmcnt(2)
  v_mfma_f32_32x32x16_bf16 v[96:111], v[116:119], a[196:199], v[96:111]
  s_waitcnt lgkmcnt(1)
  v_mfma_f32_32x32x16_bf16 v[96:111], v[120:123], a[200:203], v[96:111]
  s_waitcnt lgkmcnt(0)
  v_mfma_f32_32x32x16_bf16 v[96:111], v[124:127], a[204:207], v[96:111]
  s_nop 7
  ds_read_b128 v[112:115], v13 offset:16384
  ds_read_b128 v[116:119], v14 offset:16384
  ds_read_b128 v[120:123], v15 offset:16384
  ds_read_b128 v[124:127], v16 offset:16384
  s_waitcnt lgkmcnt(3)
  v_mfma_f32_32x32x16_bf16 v[96:111], v[112:115], a[208:211], v[96:111]
  s_waitcnt lgkmcnt(2)
  v_mfma_f32_32x32x16_bf16 v[96:111], v[116:119], a[212:215], v[96:111]
  s_waitcnt lgkmcnt(1)
  v_mfma_f32_32x32x16_bf16 v[96:111], v[120:123], a[216:219], v[96:111]
  s_waitcnt lgkmcnt(0)
  v_mfma_f32_32x32x16_bf16 v[96:111], v[124:127], a[220:223], v[96:111]
  s_nop 7
  s_nop 3
  v_max3_f32 v26, v26, v96, v97
  v_max3_f32 v26, v26, v98, v99
  v_max3_f32 v26, v26, v100, v101
  v_max3_f32 v26, v26, v102, v103
  v_max3_f32 v26, v26, v104, v105
  v_max3_f32 v26, v26, v106, v107
  v_max3_f32 v26, v26, v108, v109
  v_max3_f32 v26, v26, v110, v111
  ds_read_b128 v[112:115], v9 offset:24576
  ds_read_b128 v[116:119], v10 offset:24576
  ds_read_b128 v[120:123], v11 offset:24576
  ds_read_b128 v[124:127], v12 offset:24576
  s_waitcnt lgkmcnt(3)
  v_mfma_f32_32x32x16_bf16 v[96:111], v[112:115], a[192:195], 0
  s_waitcnt lgkmcnt(2)
  v_mfma_f32_32x32x16_bf16 v[96:111], v[116:119], a[196:199], v[96:111]
  s_waitcnt lgkmcnt(1)
  v_mfma_f32_32x32x16_bf16 v[96:111], v[120:123], a[200:203], v[96:111]
  s_waitcnt lgkmcnt(0)
  v_mfma_f32_32x32x16_bf16 v[96:111], v[124:127], a[204:207], v[96:111]
  s_nop 7
  ds_read_b128 v[112:115], v13 offset:24576
  ds_read_b128 v[116:119], v14 offset:24576
  ds_read_b128 v[120:123], v15 offset:24576
  ds_read_b128 v[124:127], v16 offset:24576
  s_waitcnt lgkmcnt(3)
  v_mfma_f32_32x32x16_bf16 v[96:111], v[112:115], a[208:211], v[96:111]
  s_waitcnt lgkmcnt(2)
  v_mfma_f32_32x32x16_bf16 v[96:111], v[116:119], a[212:215], v[96:111]
  s_waitcnt lgkmcnt(1)
  v_mfma_f32_32x32x16_bf16 v[96:111], v[120:123], a[216:219], v[96:111]
  s_waitcnt lgkmcnt(0)
  v_mfma_f32_32x32x16_bf16 v[96:111], v[124:127], a[220:223], v[96:111]
  s_nop 7
  s_nop 3
  v_max3_f32 v26, v26, v96, v97
  v_max3_f32 v26, v26, v98, v99
  v_max3_f32 v26, v26, v100, v101
  v_max3_f32 v26, v26, v102, v103
  v_max3_f32 v26, v26, v104, v105
  v_max3_f32 v26, v26, v106, v107
  v_max3_f32 v26, v26, v108, v109
  v_max3_f32 v26, v26, v110, v111
  ds_read_b128 v[112:115], v1 offset:40960
  ds_read_b128 v[116:119], v2 offset:40960
  ds_read_b128 v[120:123], v3 offset:40960
  ds_read_b128 v[124:127], v4 offset:40960
  s_waitcnt lgkmcnt(3)
  v_mfma_f32_32x32x16_bf16 v[96:111], v[112:115], a[192:195], 0
  s_waitcnt lgkmcnt(2)
  v_mfma_f32_32x32x16_bf16 v[96:111], v[116:119], a[196:199], v[96:111]
  s_waitcnt lgkmcnt(1)
  v_mfma_f32_32x32x16_bf16 v[96:111], v[120:123], a[200:203], v[96:111]
  s_waitcnt lgkmcnt(0)
  v_mfma_f32_32x32x16_bf16 v[96:111], v[124:127], a[204:207], v[96:111]
  s_nop 7
  ds_read_b128 v[112:115], v5 offset:40960
  ds_read_b128 v[116:119], v6 offset:40960
  ds_read_b128 v[120:123], v7 offset:40960
  ds_read_b128 v[124:127], v8 offset:40960
  s_waitcnt lgkmcnt(3)
  v_mfma_f32_32x32x16_bf16 v[96:111], v[112:115], a[208:211], v[96:111]
  s_waitcnt lgkmcnt(2)
  v_mfma_f32_32x32x16_bf16 v[96:111], v[116:119], a[212:215], v[96:111]
  s_waitcnt lgkmcnt(1)
  v_mfma_f32_32x32x16_bf16 v[96:111], v[120:123], a[216:219], v[96:111]
  s_waitcnt lgkmcnt(0)
  v_mfma_f32_32x32x16_bf16 v[96:111], v[124:127], a[220:223], v[96:111]
  s_nop 7
  s_nop 3
  v_max3_f32 v26, v26, v96, v97
  v_max3_f32 v26, v26, v98, v99
  v_max3_f32 v26, v26, v100, v101
  v_max3_f32 v26, v26, v102, v103
  v_max3_f32 v26, v26, v104, v105
  v_max3_f32 v26, v26, v106, v107
  v_max3_f32 v26, v26, v108, v109
  v_max3_f32 v26, v26, v110, v111
  v_mov_b32 v29, v26
  s_nop 1
  v_permlane32_swap_b32 v26, v29
  v_max_f32 v26, v26, v29
  v_mul_f32 v27, s23, v26
  v_mov_b32 v28, 0
  ds_read_b128 v[112:115], v1
  ds_read_b128 v[116:119], v2
  ds_read_b128 v[120:123], v3
  ds_read_b128 v[124:127], v4
  s_waitcnt lgkmcnt(3)
  v_mfma_f32_32x32x16_bf16 v[96:111], v[112:115], a[192:195], 0
  s_waitcnt lgkmcnt(2)
  v_mfma_f32_32x32x16_bf16 v[96:111], v[116:119], a[196:199], v[96:111]
  s_waitcnt lgkmcnt(1)
  v_mfma_f32_32x32x16_bf16 v[96:111], v[120:123], a[200:203], v[96:111]
  s_waitcnt lgkmcnt(0)
  v_mfma_f32_32x32x16_bf16 v[96:111], v[124:127], a[204:207], v[96:111]
  s_nop 7
  ds_read_b128 v[112:115], v5
  ds_read_b128 v[116:119], v6
  ds_read_b128 v[120:123], v7
  ds_read_b128 v[124:127], v8
  s_waitcnt lgkmcnt(3)
  v_mfma_f32_32x32x16_bf16 v[96:111], v[112:115], a[208:211], v[96:111]
  s_waitcnt lgkmcnt(2)
  v_mfma_f32_32x32x16_bf16 v[96:111], v[116:119], a[212:215], v[96:111]
  s_waitcnt lgkmcnt(1)
  v_mfma_f32_32x32x16_bf16 v[96:111], v[120:123], a[216:219], v[96:111]
  s_waitcnt lgkmcnt(0)
  v_mfma_f32_32x32x16_bf16 v[96:111], v[124:127], a[220:223], v[96:111]
  s_nop 7
  s_nop 3
  v_fma_f32 v96, v96, s20, v27
  v_fma_f32 v97, v97, s20, v27
  v_fma_f32 v98, v98, s20, v27
  v_fma_f32 v99, v99, s20, v27
  v_fma_f32 v100, v100, s20, v27
  v_fma_f32 v101, v101, s20, v27
  v_fma_f32 v102, v102, s20, v27
  v_fma_f32 v103, v103, s20, v27
  v_fma_f32 v104, v104, s20, v27
  v_fma_f32 v105, v105, s20, v27
  v_fma_f32 v106, v106, s20, v27
  v_fma_f32 v107, v107, s20, v27
  v_fma_f32 v108, v108, s20, v27
  v_fma_f32 v109, v109, s20, v27
  v_fma_f32 v110, v110, s20, v27
  v_fma_f32 v111, v111, s20, v27
  v_exp_f32 v96, v96
  v_exp_f32 v97, v97
  v_exp_f32 v98, v98
  v_exp_f32 v99, v99
  v_exp_f32 v100, v100
  v_exp_f32 v101, v101
  v_exp_f32 v102, v102
  v_exp_f32 v103, v103
  v_exp_f32 v104, v104
  v_exp_f32 v105, v105
  v_exp_f32 v106, v106
  v_exp_f32 v107, v107
  v_exp_f32 v108, v108
  v_exp_f32 v109, v109
  v_exp_f32 v110, v110
  v_exp_f32 v111, v111
  v_add_f32 v28, v28, v96
  v_add_f32 v28, v28, v97
  v_add_f32 v28, v28, v98
  v_add_f32 v28, v28, v99
  v_add_f32 v28, v28, v100
  v_add_f32 v28, v28, v101
  v_add_f32 v28, v28, v102
  v_add_f32 v28, v28, v103
  v_add_f32 v28, v28, v104
  v_add_f32 v28, v28, v105
  v_add_f32 v28, v28, v106
  v_add_f32 v28, v28, v107
  v_add_f32 v28, v28, v108
  v_add_f32 v28, v28, v109
  v_add_f32 v28, v28, v110
  v_add_f32 v28, v28, v111
  v_cvt_pk_bf16_f32 v248, v96, v97
  v_cvt_pk_bf16_f32 v249, v98, v99
  v_cvt_pk_bf16_f32 v250, v100, v101
  v_cvt_pk_bf16_f32 v251, v102, v103
  v_cvt_pk_bf16_f32 v252, v104, v105
  v_cvt_pk_bf16_f32 v253, v106, v107
  v_cvt_pk_bf16_f32 v254, v108, v109
  v_cvt_pk_bf16_f32 v255, v110, v111
  v_mfma_f32_32x32x16_bf16 v[128:143], a[0:3], v[248:251], 0
  v_mfma_f32_32x32x16_bf16 v[144:159], a[4:7], v[248:251], 0
  v_mfma_f32_32x32x16_bf16 v[160:175], a[8:11], v[248:251], 0
  v_mfma_f32_32x32x16_bf16 v[176:191], a[12:15], v[248:251], 0
  s_nop 7
  v_mfma_f32_32x32x16_bf16 v[128:143], a[16:19], v[252:255], v[128:143]
  v_mfma_f32_32x32x16_bf16 v[144:159], a[20:23], v[252:255], v[144:159]
  v_mfma_f32_32x32x16_bf16 v[160:175], a[24:27], v[252:255], v[160:175]
  v_mfma_f32_32x32x16_bf16 v[176:191], a[28:31], v[252:255], v[176:191]
  s_nop 7
  ds_read_b128 v[112:115], v1 offset:8192
  ds_read_b128 v[116:119], v2 offset:8192
  ds_read_b128 v[120:123], v3 offset:8192
  ds_read_b128 v[124:127], v4 offset:8192
  s_waitcnt lgkmcnt(3)
  v_mfma_f32_32x32x16_bf16 v[96:111], v[112:115], a[192:195], 0
  s_waitcnt lgkmcnt(2)
  v_mfma_f32_32x32x16_bf16 v[96:111], v[116:119], a[196:199], v[96:111]
  s_waitcnt lgkmcnt(1)
  v_mfma_f32_32x32x16_bf16 v[96:111], v[120:123], a[200:203], v[96:111]
  s_waitcnt lgkmcnt(0)
  v_mfma_f32_32x32x16_bf16 v[96:111], v[124:127], a[204:207], v[96:111]
  s_nop 7
  ds_read_b128 v[112:115], v5 offset:8192
  ds_read_b128 v[116:119], v6 offset:8192
  ds_read_b128 v[120:123], v7 offset:8192
  ds_read_b128 v[124:127], v8 offset:8192
  s_waitcnt lgkmcnt(3)
  v_mfma_f32_32x32x16_bf16 v[96:111], v[112:115], a[208:211], v[96:111]
  s_waitcnt lgkmcnt(2)
  v_mfma_f32_32x32x16_bf16 v[96:111], v[116:119], a[212:215], v[96:111]
  s_waitcnt lgkmcnt(1)
  v_mfma_f32_32x32x16_bf16 v[96:111], v[120:123], a[216:219], v[96:111]
  s_waitcnt lgkmcnt(0)
  v_mfma_f32_32x32x16_bf16 v[96:111], v[124:127], a[220:223], v[96:111]
  s_nop 7
  s_nop 3
  v_fma_f32 v96, v96, s20, v27
  v_fma_f32 v97, v97, s20, v27
  v_fma_f32 v98, v98, s20, v27
  v_fma_f32 v99, v99, s20, v27
  v_fma_f32 v100, v100, s20, v27
  v_fma_f32 v101, v101, s20, v27
  v_fma_f32 v102, v102, s20, v27
  v_fma_f32 v103, v103, s20, v27
  v_fma_f32 v104, v104, s20, v27
  v_fma_f32 v105, v105, s20, v27
  v_fma_f32 v106, v106, s20, v27
  v_fma_f32 v107, v107, s20, v27
  v_fma_f32 v108, v108, s20, v27
  v_fma_f32 v109, v109, s20, v27
  v_fma_f32 v110, v110, s20, v27
  v_fma_f32 v111, v111, s20, v27
  v_exp_f32 v96, v96
  v_exp_f32 v97, v97
  v_exp_f32 v98, v98
  v_exp_f32 v99, v99
  v_exp_f32 v100, v100
  v_exp_f32 v101, v101
  v_exp_f32 v102, v102
  v_exp_f32 v103, v103
  v_exp_f32 v104, v104
  v_exp_f32 v105, v105
  v_exp_f32 v106, v106
  v_exp_f32 v107, v107
  v_exp_f32 v108, v108
  v_exp_f32 v109, v109
  v_exp_f32 v110, v110
  v_exp_f32 v111, v111
  v_add_f32 v28, v28, v96
  v_add_f32 v28, v28, v97
  v_add_f32 v28, v28, v98
  v_add_f32 v28, v28, v99
  v_add_f32 v28, v28, v100
  v_add_f32 v28, v28, v101
  v_add_f32 v28, v28, v102
  v_add_f32 v28, v28, v103
  v_add_f32 v28, v28, v104
  v_add_f32 v28, v28, v105
  v_add_f32 v28, v28, v106
  v_add_f32 v28, v28, v107
  v_add_f32 v28, v28, v108
  v_add_f32 v28, v28, v109
  v_add_f32 v28, v28, v110
  v_add_f32 v28, v28, v111
  v_cvt_pk_bf16_f32 v248, v96, v97
  v_cvt_pk_bf16_f32 v249, v98, v99
  v_cvt_pk_bf16_f32 v250, v100, v101
  v_cvt_pk_bf16_f32 v251, v102, v103
  v_cvt_pk_bf16_f32 v252, v104, v105
  v_cvt_pk_bf16_f32 v253, v106, v107
  v_cvt_pk_bf16_f32 v254, v108, v109
  v_cvt_pk_bf16_f32 v255, v110, v111
  v_mfma_f32_32x32x16_bf16 v[128:143], a[32:35], v[248:251], v[128:143]
  v_mfma_f32_32x32x16_bf16 v[144:159], a[36:39], v[248:251], v[144:159]
  v_mfma_f32_32x32x16_bf16 v[160:175], a[40:43], v[248:251], v[160:175]
  v_mfma_f32_32x32x16_bf16 v[176:191], a[44:47], v[248:251], v[176:191]
  s_nop 7
  v_mfma_f32_32x32x16_bf16 v[128:143], a[48:51], v[252:255], v[128:143]
  v_mfma_f32_32x32x16_bf16 v[144:159], a[52:55], v[252:255], v[144:159]
  v_mfma_f32_32x32x16_bf16 v[160:175], a[56:59], v[252:255], v[160:175]
  v_mfma_f32_32x32x16_bf16 v[176:191], a[60:63], v[252:255], v[176:191]
  s_nop 7
  ds_read_b128 v[112:115], v1 offset:16384
  ds_read_b128 v[116:119], v2 offset:16384
  ds_read_b128 v[120:123], v3 offset:16384
  ds_read_b128 v[124:127], v4 offset:16384
  s_waitcnt lgkmcnt(3)
  v_mfma_f32_32x32x16_bf16 v[96:111], v[112:115], a[192:195], 0
  s_waitcnt lgkmcnt(2)
  v_mfma_f32_32x32x16_bf16 v[96:111], v[116:119], a[196:199], v[96:111]
  s_waitcnt lgkmcnt(1)
  v_mfma_f32_32x32x16_bf16 v[96:111], v[120:123], a[200:203], v[96:111]
  s_waitcnt lgkmcnt(0)
  v_mfma_f32_32x32x16_bf16 v[96:111], v[124:127], a[204:207], v[96:111]
  s_nop 7
  ds_read_b128 v[112:115], v5 offset:16384
  ds_read_b128 v[116:119], v6 offset:16384
  ds_read_b128 v[120:123], v7 offset:16384
  ds_read_b128 v[124:127], v8 offset:16384
  s_waitcnt lgkmcnt(3)
  v_mfma_f32_32x32x16_bf16 v[96:111], v[112:115], a[208:211], v[96:111]
  s_waitcnt lgkmcnt(2)
  v_mfma_f32_32x32x16_bf16 v[96:111], v[116:119], a[212:215], v[96:111]
  s_waitcnt lgkmcnt(1)
  v_mfma_f32_32x32x16_bf16 v[96:111], v[120:123], a[216:219], v[96:111]
  s_waitcnt lgkmcnt(0)
  v_mfma_f32_32x32x16_bf16 v[96:111], v[124:127], a[220:223], v[96:111]
  s_nop 7
  s_nop 3
  v_fma_f32 v96, v96, s20, v27
  v_fma_f32 v97, v97, s20, v27
  v_fma_f32 v98, v98, s20, v27
  v_fma_f32 v99, v99, s20, v27
  v_fma_f32 v100, v100, s20, v27
  v_fma_f32 v101, v101, s20, v27
  v_fma_f32 v102, v102, s20, v27
  v_fma_f32 v103, v103, s20, v27
  v_fma_f32 v104, v104, s20, v27
  v_fma_f32 v105, v105, s20, v27
  v_fma_f32 v106, v106, s20, v27
  v_fma_f32 v107, v107, s20, v27
  v_fma_f32 v108, v108, s20, v27
  v_fma_f32 v109, v109, s20, v27
  v_fma_f32 v110, v110, s20, v27
  v_fma_f32 v111, v111, s20, v27
  v_exp_f32 v96, v96
  v_exp_f32 v97, v97
  v_exp_f32 v98, v98
  v_exp_f32 v99, v99
  v_exp_f32 v100, v100
  v_exp_f32 v101, v101
  v_exp_f32 v102, v102
  v_exp_f32 v103, v103
  v_exp_f32 v104, v104
  v_exp_f32 v105, v105
  v_exp_f32 v106, v106
  v_exp_f32 v107, v107
  v_exp_f32 v108, v108
  v_exp_f32 v109, v109
  v_exp_f32 v110, v110
  v_exp_f32 v111, v111
  v_add_f32 v28, v28, v96
  v_add_f32 v28, v28, v97
  v_add_f32 v28, v28, v98
  v_add_f32 v28, v28, v99
  v_add_f32 v28, v28, v100
  v_add_f32 v28, v28, v101
  v_add_f32 v28, v28, v102
  v_add_f32 v28, v28, v103
  v_add_f32 v28, v28, v104
  v_add_f32 v28, v28, v105
  v_add_f32 v28, v28, v106
  v_add_f32 v28, v28, v107
  v_add_f32 v28, v28, v108
  v_add_f32 v28, v28, v109
  v_add_f32 v28, v28, v110
  v_add_f32 v28, v28, v111
  v_cvt_pk_bf16_f32 v80, v96, v97
  v_cvt_pk_bf16_f32 v81, v98, v99
  v_cvt_pk_bf16_f32 v82, v100, v101
  v_cvt_pk_bf16_f32 v83, v102, v103
  v_cvt_pk_bf16_f32 v84, v104, v105
  v_cvt_pk_bf16_f32 v85, v106, v107
  v_cvt_pk_bf16_f32 v86, v108, v109
  v_cvt_pk_bf16_f32 v87, v110, v111
  v_mfma_f32_32x32x16_bf16 v[128:143], a[64:67], v[80:83], v[128:143]
  v_mfma_f32_32x32x16_bf16 v[144:159], a[68:71], v[80:83], v[144:159]
  v_mfma_f32_32x32x16_bf16 v[160:175], a[72:75], v[80:83], v[160:175]
  s_nop 7
  v_mfma_f32_32x32x16_bf16 v[128:143], a[80:83], v[84:87], v[128:143]
  v_mfma_f32_32x32x16_bf16 v[144:159], a[84:87], v[84:87], v[144:159]
  v_mfma_f32_32x32x16_bf16 v[160:175], a[88:91], v[84:87], v[160:175]
  s_nop 7
  ds_read_b128 v[112:115], v1 offset:24576
  ds_read_b128 v[116:119], v2 offset:24576
  ds_read_b128 v[120:123], v3 offset:24576
  ds_read_b128 v[124:127], v4 offset:24576
  s_waitcnt lgkmcnt(3)
  v_mfma_f32_32x32x16_bf16 v[96:111], v[112:115], a[192:195], 0
  s_waitcnt lgkmcnt(2)
  v_mfma_f32_32x32x16_bf16 v[96:111], v[116:119], a[196:199], v[96:111]
  s_waitcnt lgkmcnt(1)
  v_mfma_f32_32x32x16_bf16 v[96:111], v[120:123], a[200:203], v[96:111]
  s_waitcnt lgkmcnt(0)
  v_mfma_f32_32x32x16_bf16 v[96:111], v[124:127], a[204:207], v[96:111]
  s_nop 7
  ds_read_b128 v[112:115], v5 offset:24576
  ds_read_b128 v[116:119], v6 offset:24576
  ds_read_b128 v[120:123], v7 offset:24576
  ds_read_b128 v[124:127], v8 offset:24576
  s_waitcnt lgkmcnt(3)
  v_mfma_f32_32x32x16_bf16 v[96:111], v[112:115], a[208:211], v[96:111]
  s_waitcnt lgkmcnt(2)
  v_mfma_f32_32x32x16_bf16 v[96:111], v[116:119], a[212:215], v[96:111]
  s_waitcnt lgkmcnt(1)
  v_mfma_f32_32x32x16_bf16 v[96:111], v[120:123], a[216:219], v[96:111]
  s_waitcnt lgkmcnt(0)
  v_mfma_f32_32x32x16_bf16 v[96:111], v[124:127], a[220:223], v[96:111]
  s_nop 7
  s_nop 3
  v_fma_f32 v96, v96, s20, v27
  v_fma_f32 v97, v97, s20, v27
  v_fma_f32 v98, v98, s20, v27
  v_fma_f32 v99, v99, s20, v27
  v_fma_f32 v100, v100, s20, v27
  v_fma_f32 v101, v101, s20, v27
  v_fma_f32 v102, v102, s20, v27
  v_fma_f32 v103, v103, s20, v27
  v_fma_f32 v104, v104, s20, v27
  v_fma_f32 v105, v105, s20, v27
  v_fma_f32 v106, v106, s20, v27
  v_fma_f32 v107, v107, s20, v27
  v_fma_f32 v108, v108, s20, v27
  v_fma_f32 v109, v109, s20, v27
  v_fma_f32 v110, v110, s20, v27
  v_fma_f32 v111, v111, s20, v27
  v_exp_f32 v96, v96
  v_exp_f32 v97, v97
  v_exp_f32 v98, v98
  v_exp_f32 v99, v99
  v_exp_f32 v100, v100
  v_exp_f32 v101, v101
  v_exp_f32 v102, v102
  v_exp_f32 v103, v103
  v_exp_f32 v104, v104
  v_exp_f32 v105, v105
  v_exp_f32 v106, v106
  v_exp_f32 v107, v107
  v_exp_f32 v108, v108
  v_exp_f32 v109, v109
  v_exp_f32 v110, v110
  v_exp_f32 v111, v111
  v_add_f32 v28, v28, v96
  v_add_f32 v28, v28, v97
  v_add_f32 v28, v28, v98
  v_add_f32 v28, v28, v99
  v_add_f32 v28, v28, v100
  v_add_f32 v28, v28, v101
  v_add_f32 v28, v28, v102
  v_add_f32 v28, v28, v103
  v_add_f32 v28, v28, v104
  v_add_f32 v28, v28, v105
  v_add_f32 v28, v28, v106
  v_add_f32 v28, v28, v107
  v_add_f32 v28, v28, v108
  v_add_f32 v28, v28, v109
  v_add_f32 v28, v28, v110
  v_add_f32 v28, v28, v111
  v_cvt_pk_bf16_f32 v88, v96, v97
  v_cvt_pk_bf16_f32 v89, v98, v99
  v_cvt_pk_bf16_f32 v90, v100, v101
  v_cvt_pk_bf16_f32 v91, v102, v103
  v_cvt_pk_bf16_f32 v92, v104, v105
  v_cvt_pk_bf16_f32 v93, v106, v107
  v_cvt_pk_bf16_f32 v94, v108, v109
  v_cvt_pk_bf16_f32 v95, v110, v111
  v_mfma_f32_32x32x16_bf16 v[128:143], a[96:99], v[88:91], v[128:143]
  v_mfma_f32_32x32x16_bf16 v[144:159], a[100:103], v[88:91], v[144:159]
  s_nop 7
  v_mfma_f32_32x32x16_bf16 v[128:143], a[112:115], v[92:95], v[128:143]
  v_mfma_f32_32x32x16_bf16 v[144:159], a[116:119], v[92:95], v[144:159]
  s_nop 7
  ds_read_b128 v[112:115], v1 offset:32768
  ds_read_b128 v[116:119], v2 offset:32768
  ds_read_b128 v[120:123], v3 offset:32768
  ds_read_b128 v[124:127], v4 offset:32768
  s_waitcnt lgkmcnt(3)
  v_mfma_f32_32x32x16_bf16 v[96:111], v[112:115], a[192:195], 0
  s_waitcnt lgkmcnt(2)
  v_mfma_f32_32x32x16_bf16 v[96:111], v[116:119], a[196:199], v[96:111]
  s_waitcnt lgkmcnt(1)
  v_mfma_f32_32x32x16_bf16 v[96:111], v[120:123], a[200:203], v[96:111]
  s_waitcnt lgkmcnt(0)
  v_mfma_f32_32x32x16_bf16 v[96:111], v[124:127], a[204:207], v[96:111]
  s_nop 7
  ds_read_b128 v[112:115], v5 offset:32768
  ds_read_b128 v[116:119], v6 offset:32768
  ds_read_b128 v[120:123], v7 offset:32768
  ds_read_b128 v[124:127], v8 offset:32768
  s_waitcnt lgkmcnt(3)
  v_mfma_f32_32x32x16_bf16 v[96:111], v[112:115], a[208:211], v[96:111]
  s_waitcnt lgkmcnt(2)
  v_mfma_f32_32x32x16_bf16 v[96:111], v[116:119], a[212:215], v[96:111]
  s_waitcnt lgkmcnt(1)
  v_mfma_f32_32x32x16_bf16 v[96:111], v[120:123], a[216:219], v[96:111]
  s_waitcnt lgkmcnt(0)
  v_mfma_f32_32x32x16_bf16 v[96:111], v[124:127], a[220:223], v[96:111]
  s_nop 7
  s_nop 3
  v_fma_f32 v96, v96, s20, v27
  v_fma_f32 v97, v97, s20, v27
  v_fma_f32 v98, v98, s20, v27
  v_fma_f32 v99, v99, s20, v27
  v_fma_f32 v100, v100, s20, v27
  v_fma_f32 v101, v101, s20, v27
  v_fma_f32 v102, v102, s20, v27
  v_fma_f32 v103, v103, s20, v27
  v_fma_f32 v104, v104, s20, v27
  v_fma_f32 v105, v105, s20, v27
  v_fma_f32 v106, v106, s20, v27
  v_fma_f32 v107, v107, s20, v27
  v_fma_f32 v108, v108, s20, v27
  v_fma_f32 v109, v109, s20, v27
  v_fma_f32 v110, v110, s20, v27
  v_fma_f32 v111, v111, s20, v27
  v_exp_f32 v96, v96
  v_exp_f32 v97, v97
  v_exp_f32 v98, v98
  v_exp_f32 v99, v99
  v_exp_f32 v100, v100
  v_exp_f32 v101, v101
  v_exp_f32 v102, v102
  v_exp_f32 v103, v103
  v_exp_f32 v104, v104
  v_exp_f32 v105, v105
  v_exp_f32 v106, v106
  v_exp_f32 v107, v107
  v_exp_f32 v108, v108
  v_exp_f32 v109, v109
  v_exp_f32 v110, v110
  v_exp_f32 v111, v111
  v_add_f32 v28, v28, v96
  v_add_f32 v28, v28, v97
  v_add_f32 v28, v28, v98
  v_add_f32 v28, v28, v99
  v_add_f32 v28, v28, v100
  v_add_f32 v28, v28, v101
  v_add_f32 v28, v28, v102
  v_add_f32 v28, v28, v103
  v_add_f32 v28, v28, v104
  v_add_f32 v28, v28, v105
  v_add_f32 v28, v28, v106
  v_add_f32 v28, v28, v107
  v_add_f32 v28, v28, v108
  v_add_f32 v28, v28, v109
  v_add_f32 v28, v28, v110
  v_add_f32 v28, v28, v111
  v_cvt_pk_bf16_f32 v192, v96, v97
  v_cvt_pk_bf16_f32 v193, v98, v99
  v_cvt_pk_bf16_f32 v194, v100, v101
  v_cvt_pk_bf16_f32 v195, v102, v103
  v_cvt_pk_bf16_f32 v196, v104, v105
  v_cvt_pk_bf16_f32 v197, v106, v107
  v_cvt_pk_bf16_f32 v198, v108, v109
  v_cvt_pk_bf16_f32 v199, v110, v111
  v_mfma_f32_32x32x16_bf16 v[128:143], a[128:131], v[192:195], v[128:143]
  v_mfma_f32_32x32x16_bf16 v[144:159], a[132:135], v[192:195], v[144:159]
  s_nop 7
  v_mfma_f32_32x32x16_bf16 v[128:143], a[144:147], v[196:199], v[128:143]
  v_mfma_f32_32x32x16_bf16 v[144:159], a[148:151], v[196:199], v[144:159]
  s_nop 7
  ds_read_b128 v[112:115], v1 offset:49152
  ds_read_b128 v[116:119], v2 offset:49152
  ds_read_b128 v[120:123], v3 offset:49152
  ds_read_b128 v[124:127], v4 offset:49152
  s_waitcnt lgkmcnt(3)
  v_mfma_f32_32x32x16_bf16 v[96:111], v[112:115], a[192:195], 0
  s_waitcnt lgkmcnt(2)
  v_mfma_f32_32x32x16_bf16 v[96:111], v[116:119], a[196:199], v[96:111]
  s_waitcnt lgkmcnt(1)
  v_mfma_f32_32x32x16_bf16 v[96:111], v[120:123], a[200:203], v[96:111]
  s_waitcnt lgkmcnt(0)
  v_mfma_f32_32x32x16_bf16 v[96:111], v[124:127], a[204:207], v[96:111]
  s_nop 7
  ds_read_b128 v[112:115], v5 offset:49152
  ds_read_b128 v[116:119], v6 offset:49152
  ds_read_b128 v[120:123], v7 offset:49152
  ds_read_b128 v[124:127], v8 offset:49152
  s_waitcnt lgkmcnt(3)
  v_mfma_f32_32x32x16_bf16 v[96:111], v[112:115], a[208:211], v[96:111]
  s_waitcnt lgkmcnt(2)
  v_mfma_f32_32x32x16_bf16 v[96:111], v[116:119], a[212:215], v[96:111]
  s_waitcnt lgkmcnt(1)
  v_mfma_f32_32x32x16_bf16 v[96:111], v[120:123], a[216:219], v[96:111]
  s_waitcnt lgkmcnt(0)
  v_mfma_f32_32x32x16_bf16 v[96:111], v[124:127], a[220:223], v[96:111]
  s_nop 7
  s_nop 3
  v_fma_f32 v96, v96, s20, v27
  v_fma_f32 v97, v97, s20, v27
  v_fma_f32 v98, v98, s20, v27
  v_fma_f32 v99, v99, s20, v27
  v_fma_f32 v100, v100, s20, v27
  v_fma_f32 v101, v101, s20, v27
  v_fma_f32 v102, v102, s20, v27
  v_fma_f32 v103, v103, s20, v27
  v_fma_f32 v104, v104, s20, v27
  v_fma_f32 v105, v105, s20, v27
  v_fma_f32 v106, v106, s20, v27
  v_fma_f32 v107, v107, s20, v27
  v_fma_f32 v108, v108, s20, v27
  v_fma_f32 v109, v109, s20, v27
  v_fma_f32 v110, v110, s20, v27
  v_fma_f32 v111, v111, s20, v27
  v_exp_f32 v96, v96
  v_exp_f32 v97, v97
  v_exp_f32 v98, v98
  v_exp_f32 v99, v99
  v_exp_f32 v100, v100
  v_exp_f32 v101, v101
  v_exp_f32 v102, v102
  v_exp_f32 v103, v103
  v_exp_f32 v104, v104
  v_exp_f32 v105, v105
  v_exp_f32 v106, v106
  v_exp_f32 v107, v107
  v_exp_f32 v108, v108
  v_exp_f32 v109, v109
  v_exp_f32 v110, v110
  v_exp_f32 v111, v111
  v_add_f32 v28, v28, v96
  v_add_f32 v28, v28, v97
  v_add_f32 v28, v28, v98
  v_add_f32 v28, v28, v99
  v_add_f32 v28, v28, v100
  v_add_f32 v28, v28, v101
  v_add_f32 v28, v28, v102
  v_add_f32 v28, v28, v103
  v_add_f32 v28, v28, v104
  v_add_f32 v28, v28, v105
  v_add_f32 v28, v28, v106
  v_add_f32 v28, v28, v107
  v_add_f32 v28, v28, v108
  v_add_f32 v28, v28, v109
  v_add_f32 v28, v28, v110
  v_add_f32 v28, v28, v111
  v_cvt_pk_bf16_f32 v200, v96, v97
  v_cvt_pk_bf16_f32 v201, v98, v99
  v_cvt_pk_bf16_f32 v202, v100, v101
  v_cvt_pk_bf16_f32 v203, v102, v103
  v_cvt_pk_bf16_f32 v204, v104, v105
  v_cvt_pk_bf16_f32 v205, v106, v107
  v_cvt_pk_bf16_f32 v206, v108, v109
  v_cvt_pk_bf16_f32 v207, v110, v111
  ds_read_b64_tr_b16 v[112:113], v17 offset:49152
  ds_read_b64_tr_b16 v[114:115], v17 offset:51200
  ds_read_b64_tr_b16 v[116:117], v18 offset:49152
  ds_read_b64_tr_b16 v[118:119], v18 offset:51200
  ds_read_b64_tr_b16 v[120:121], v19 offset:49152
  ds_read_b64_tr_b16 v[122:123], v19 offset:51200
  ds_read_b64_tr_b16 v[124:125], v20 offset:49152
  ds_read_b64_tr_b16 v[126:127], v20 offset:51200
  s_waitcnt lgkmcnt(6)
  v_mfma_f32_32x32x16_bf16 v[128:143], v[112:115], v[200:203], v[128:143]
  s_waitcnt lgkmcnt(4)
  v_mfma_f32_32x32x16_bf16 v[144:159], v[116:119], v[200:203], v[144:159]
  s_waitcnt lgkmcnt(2)
  v_mfma_f32_32x32x16_bf16 v[160:175], v[120:123], v[200:203], v[160:175]
  s_nop 7
  ds_read_b64_tr_b16 v[112:113], v17 offset:53248
  ds_read_b64_tr_b16 v[114:115], v17 offset:55296
  ds_read_b64_tr_b16 v[116:117], v18 offset:53248
  ds_read_b64_tr_b16 v[118:119], v18 offset:55296
  ds_read_b64_tr_b16 v[120:121], v19 offset:53248
  ds_read_b64_tr_b16 v[122:123], v19 offset:55296
  ds_read_b64_tr_b16 v[124:125], v20 offset:53248
  ds_read_b64_tr_b16 v[126:127], v20 offset:55296
  s_waitcnt lgkmcnt(6)
  v_mfma_f32_32x32x16_bf16 v[128:143], v[112:115], v[204:207], v[128:143]
  s_waitcnt lgkmcnt(4)
  v_mfma_f32_32x32x16_bf16 v[144:159], v[116:119], v[204:207], v[144:159]
  s_waitcnt lgkmcnt(2)
  v_mfma_f32_32x32x16_bf16 v[160:175], v[120:123], v[204:207], v[160:175]
  s_nop 7
  ds_read_b128 v[112:115], v1 offset:57344
  ds_read_b128 v[116:119], v2 offset:57344
  ds_read_b128 v[120:123], v3 offset:57344
  ds_read_b128 v[124:127], v4 offset:57344
  s_waitcnt lgkmcnt(3)
  v_mfma_f32_32x32x16_bf16 v[96:111], v[112:115], a[192:195], 0
  s_waitcnt lgkmcnt(2)
  v_mfma_f32_32x32x16_bf16 v[96:111], v[116:119], a[196:199], v[96:111]
  s_waitcnt lgkmcnt(1)
  v_mfma_f32_32x32x16_bf16 v[96:111], v[120:123], a[200:203], v[96:111]
  s_waitcnt lgkmcnt(0)
  v_mfma_f32_32x32x16_bf16 v[96:111], v[124:127], a[204:207], v[96:111]
  s_nop 7
  ds_read_b128 v[112:115], v5 offset:57344
  ds_read_b128 v[116:119], v6 offset:57344
  ds_read_b128 v[120:123], v7 offset:57344
  ds_read_b128 v[124:127], v8 offset:57344
  s_waitcnt lgkmcnt(3)
  v_mfma_f32_32x32x16_bf16 v[96:111], v[112:115], a[208:211], v[96:111]
  s_waitcnt lgkmcnt(2)
  v_mfma_f32_32x32x16_bf16 v[96:111], v[116:119], a[212:215], v[96:111]
  s_waitcnt lgkmcnt(1)
  v_mfma_f32_32x32x16_bf16 v[96:111], v[120:123], a[216:219], v[96:111]
  s_waitcnt lgkmcnt(0)
  v_mfma_f32_32x32x16_bf16 v[96:111], v[124:127], a[220:223], v[96:111]
  s_nop 7
  s_nop 3
  v_fma_f32 v96, v96, s20, v27
  v_fma_f32 v97, v97, s20, v27
  v_fma_f32 v98, v98, s20, v27
  v_fma_f32 v99, v99, s20, v27
  v_fma_f32 v100, v100, s20, v27
  v_fma_f32 v101, v101, s20, v27
  v_fma_f32 v102, v102, s20, v27
  v_fma_f32 v103, v103, s20, v27
  v_fma_f32 v104, v104, s20, v27
  v_fma_f32 v105, v105, s20, v27
  v_fma_f32 v106, v106, s20, v27
  v_fma_f32 v107, v107, s20, v27
  v_fma_f32 v108, v108, s20, v27
  v_fma_f32 v109, v109, s20, v27
  v_fma_f32 v110, v110, s20, v27
  v_fma_f32 v111, v111, s20, v27
  v_exp_f32 v96, v96
  v_exp_f32 v97, v97
  v_exp_f32 v98, v98
  v_exp_f32 v99, v99
  v_exp_f32 v100, v100
  v_exp_f32 v101, v101
  v_exp_f32 v102, v102
  v_exp_f32 v103, v103
  v_exp_f32 v104, v104
  v_exp_f32 v105, v105
  v_exp_f32 v106, v106
  v_exp_f32 v107, v107
  v_exp_f32 v108, v108
  v_exp_f32 v109, v109
  v_exp_f32 v110, v110
  v_exp_f32 v111, v111
  v_add_f32 v28, v28, v96
  v_add_f32 v28, v28, v97
  v_add_f32 v28, v28, v98
  v_add_f32 v28, v28, v99
  v_add_f32 v28, v28, v100
  v_add_f32 v28, v28, v101
  v_add_f32 v28, v28, v102
  v_add_f32 v28, v28, v103
  v_add_f32 v28, v28, v104
  v_add_f32 v28, v28, v105
  v_add_f32 v28, v28, v106
  v_add_f32 v28, v28, v107
  v_add_f32 v28, v28, v108
  v_add_f32 v28, v28, v109
  v_add_f32 v28, v28, v110
  v_add_f32 v28, v28, v111
  v_cvt_pk_bf16_f32 v208, v96, v97
  v_cvt_pk_bf16_f32 v209, v98, v99
  v_cvt_pk_bf16_f32 v210, v100, v101
  v_cvt_pk_bf16_f32 v211, v102, v103
  v_cvt_pk_bf16_f32 v212, v104, v105
  v_cvt_pk_bf16_f32 v213, v106, v107
  v_cvt_pk_bf16_f32 v214, v108, v109
  v_cvt_pk_bf16_f32 v215, v110, v111
  ds_read_b64_tr_b16 v[112:113], v17 offset:57344
  ds_read_b64_tr_b16 v[114:115], v17 offset:59392
  ds_read_b64_tr_b16 v[116:117], v18 offset:57344
  ds_read_b64_tr_b16 v[118:119], v18 offset:59392
  ds_read_b64_tr_b16 v[120:121], v19 offset:57344
  ds_read_b64_tr_b16 v[122:123], v19 offset:59392
  ds_read_b64_tr_b16 v[124:125], v20 offset:57344
  ds_read_b64_tr_b16 v[126:127], v20 offset:59392
  s_waitcnt lgkmcnt(6)
  v_mfma_f32_32x32x16_bf16 v[128:143], v[112:115], v[208:211], v[128:143]
  s_waitcnt lgkmcnt(4)
  v_mfma_f32_32x32x16_bf16 v[144:159], v[116:119], v[208:211], v[144:159]
  s_waitcnt lgkmcnt(2)
  v_mfma_f32_32x32x16_bf16 v[160:175], v[120:123], v[208:211], v[160:175]
  s_nop 7
  ds_read_b64_tr_b16 v[112:113], v17 offset:61440
  ds_read_b64_tr_b16 v[114:115], v17 offset:63488
  ds_read_b64_tr_b16 v[116:117], v18 offset:61440
  ds_read_b64_tr_b16 v[118:119], v18 offset:63488
  ds_read_b64_tr_b16 v[120:121], v19 offset:61440
  ds_read_b64_tr_b16 v[122:123], v19 offset:63488
  ds_read_b64_tr_b16 v[124:125], v20 offset:61440
  ds_read_b64_tr_b16 v[126:127], v20 offset:63488
  s_waitcnt lgkmcnt(6)
  v_mfma_f32_32x32x16_bf16 v[128:143], v[112:115], v[212:215], v[128:143]
  s_waitcnt lgkmcnt(4)
  v_mfma_f32_32x32x16_bf16 v[144:159], v[116:119], v[212:215], v[144:159]
  s_waitcnt lgkmcnt(2)
  v_mfma_f32_32x32x16_bf16 v[160:175], v[120:123], v[212:215], v[160:175]
  s_nop 7
  ds_read_b128 v[112:115], v9
  ds_read_b128 v[116:119], v10
  ds_read_b128 v[120:123], v11
  ds_read_b128 v[124:127], v12
  s_waitcnt lgkmcnt(3)
  v_mfma_f32_32x32x16_bf16 v[96:111], v[112:115], a[192:195], 0
  s_waitcnt lgkmcnt(2)
  v_mfma_f32_32x32x16_bf16 v[96:111], v[116:119], a[196:199], v[96:111]
  s_waitcnt lgkmcnt(1)
  v_mfma_f32_32x32x16_bf16 v[96:111], v[120:123], a[200:203], v[96:111]
  s_waitcnt lgkmcnt(0)
  v_mfma_f32_32x32x16_bf16 v[96:111], v[124:127], a[204:207], v[96:111]
  s_nop 7
  ds_read_b128 v[112:115], v13
  ds_read_b128 v[116:119], v14
  ds_read_b128 v[120:123], v15
  ds_read_b128 v[124:127], v16
  s_waitcnt lgkmcnt(3)
  v_mfma_f32_32x32x16_bf16 v[96:111], v[112:115], a[208:211], v[96:111]
  s_waitcnt lgkmcnt(2)
  v_mfma_f32_32x32x16_bf16 v[96:111], v[116:119], a[212:215], v[96:111]
  s_waitcnt lgkmcnt(1)
  v_mfma_f32_32x32x16_bf16 v[96:111], v[120:123], a[216:219], v[96:111]
  s_waitcnt lgkmcnt(0)
  v_mfma_f32_32x32x16_bf16 v[96:111], v[124:127], a[220:223], v[96:111]
  s_nop 7
  s_nop 3
  v_fma_f32 v96, v96, s20, v27
  v_fma_f32 v97, v97, s20, v27
  v_fma_f32 v98, v98, s20, v27
  v_fma_f32 v99, v99, s20, v27
  v_fma_f32 v100, v100, s20, v27
  v_fma_f32 v101, v101, s20, v27
  v_fma_f32 v102, v102, s20, v27
  v_fma_f32 v103, v103, s20, v27
  v_fma_f32 v104, v104, s20, v27
  v_fma_f32 v105, v105, s20, v27
  v_fma_f32 v106, v106, s20, v27
  v_fma_f32 v107, v107, s20, v27
  v_fma_f32 v108, v108, s20, v27
  v_fma_f32 v109, v109, s20, v27
  v_fma_f32 v110, v110, s20, v27
  v_fma_f32 v111, v111, s20, v27
  v_exp_f32 v96, v96
  v_exp_f32 v97, v97
  v_exp_f32 v98, v98
  v_exp_f32 v99, v99
  v_exp_f32 v100, v100
  v_exp_f32 v101, v101
  v_exp_f32 v102, v102
  v_exp_f32 v103, v103
  v_exp_f32 v104, v104
  v_exp_f32 v105, v105
  v_exp_f32 v106, v106
  v_exp_f32 v107, v107
  v_exp_f32 v108, v108
  v_exp_f32 v109, v109
  v_exp_f32 v110, v110
  v_exp_f32 v111, v111
  v_add_f32 v28, v28, v96
  v_add_f32 v28, v28, v97
  v_add_f32 v28, v28, v98
  v_add_f32 v28, v28, v99
  v_add_f32 v28, v28, v100
  v_add_f32 v28, v28, v101
  v_add_f32 v28, v28, v102
  v_add_f32 v28, v28, v103
  v_add_f32 v28, v28, v104
  v_add_f32 v28, v28, v105
  v_add_f32 v28, v28, v106
  v_add_f32 v28, v28, v107
  v_add_f32 v28, v28, v108
  v_add_f32 v28, v28, v109
  v_add_f32 v28, v28, v110
  v_add_f32 v28, v28, v111
  v_cvt_pk_bf16_f32 v216, v96, v97
  v_cvt_pk_bf16_f32 v217, v98, v99
  v_cvt_pk_bf16_f32 v218, v100, v101
  v_cvt_pk_bf16_f32 v219, v102, v103
  v_cvt_pk_bf16_f32 v220, v104, v105
  v_cvt_pk_bf16_f32 v221, v106, v107
  v_cvt_pk_bf16_f32 v222, v108, v109
  v_cvt_pk_bf16_f32 v223, v110, v111
  ds_read_b64_tr_b16 v[112:113], v17
  ds_read_b64_tr_b16 v[114:115], v17 offset:2048
  ds_read_b64_tr_b16 v[116:117], v18
  ds_read_b64_tr_b16 v[118:119], v18 offset:2048
  ds_read_b64_tr_b16 v[120:121], v19
  ds_read_b64_tr_b16 v[122:123], v19 offset:2048
  ds_read_b64_tr_b16 v[124:125], v20
  ds_read_b64_tr_b16 v[126:127], v20 offset:2048
  s_waitcnt lgkmcnt(6)
  v_mfma_f32_32x32x16_bf16 v[128:143], v[112:115], v[216:219], v[128:143]
  s_waitcnt lgkmcnt(4)
  v_mfma_f32_32x32x16_bf16 v[144:159], v[116:119], v[216:219], v[144:159]
  s_nop 7
  ds_read_b64_tr_b16 v[112:113], v17 offset:4096
  ds_read_b64_tr_b16 v[114:115], v17 offset:6144
  ds_read_b64_tr_b16 v[116:117], v18 offset:4096
  ds_read_b64_tr_b16 v[118:119], v18 offset:6144
  ds_read_b64_tr_b16 v[120:121], v19 offset:4096
  ds_read_b64_tr_b16 v[122:123], v19 offset:6144
  ds_read_b64_tr_b16 v[124:125], v20 offset:4096
  ds_read_b64_tr_b16 v[126:127], v20 offset:6144
  s_waitcnt lgkmcnt(6)
  v_mfma_f32_32x32x16_bf16 v[128:143], v[112:115], v[220:223], v[128:143]
  s_waitcnt lgkmcnt(4)
  v_mfma_f32_32x32x16_bf16 v[144:159], v[116:119], v[220:223], v[144:159]
  s_nop 7
  ds_read_b128 v[112:115], v9 offset:8192
  ds_read_b128 v[116:119], v10 offset:8192
  ds_read_b128 v[120:123], v11 offset:8192
  ds_read_b128 v[124:127], v12 offset:8192
  s_waitcnt lgkmcnt(3)
  v_mfma_f32_32x32x16_bf16 v[96:111], v[112:115], a[192:195], 0
  s_waitcnt lgkmcnt(2)
  v_mfma_f32_32x32x16_bf16 v[96:111], v[116:119], a[196:199], v[96:111]
  s_waitcnt lgkmcnt(1)
  v_mfma_f32_32x32x16_bf16 v[96:111], v[120:123], a[200:203], v[96:111]
  s_waitcnt lgkmcnt(0)
  v_mfma_f32_32x32x16_bf16 v[96:111], v[124:127], a[204:207], v[96:111]
  s_nop 7
  ds_read_b128 v[112:115], v13 offset:8192
  ds_read_b128 v[116:119], v14 offset:8192
  ds_read_b128 v[120:123], v15 offset:8192
  ds_read_b128 v[124:127], v16 offset:8192
  s_waitcnt lgkmcnt(3)
  v_mfma_f32_32x32x16_bf16 v[96:111], v[112:115], a[208:211], v[96:111]
  s_waitcnt lgkmcnt(2)
  v_mfma_f32_32x32x16_bf16 v[96:111], v[116:119], a[212:215], v[96:111]
  s_waitcnt lgkmcnt(1)
  v_mfma_f32_32x32x16_bf16 v[96:111], v[120:123], a[216:219], v[96:111]
  s_waitcnt lgkmcnt(0)
  v_mfma_f32_32x32x16_bf16 v[96:111], v[124:127], a[220:223], v[96:111]
  s_nop 7
  s_nop 3
  v_fma_f32 v96, v96, s20, v27
  v_fma_f32 v97, v97, s20, v27
  v_fma_f32 v98, v98, s20, v27
  v_fma_f32 v99, v99, s20, v27
  v_fma_f32 v100, v100, s20, v27
  v_fma_f32 v101, v101, s20, v27
  v_fma_f32 v102, v102, s20, v27
  v_fma_f32 v103, v103, s20, v27
  v_fma_f32 v104, v104, s20, v27
  v_fma_f32 v105, v105, s20, v27
  v_fma_f32 v106, v106, s20, v27
  v_fma_f32 v107, v107, s20, v27
  v_fma_f32 v108, v108, s20, v27
  v_fma_f32 v109, v109, s20, v27
  v_fma_f32 v110, v110, s20, v27
  v_fma_f32 v111, v111, s20, v27
  v_exp_f32 v96, v96
  v_exp_f32 v97, v97
  v_exp_f32 v98, v98
  v_exp_f32 v99, v99
  v_exp_f32 v100, v100
  v_exp_f32 v101, v101
  v_exp_f32 v102, v102
  v_exp_f32 v103, v103
  v_exp_f32 v104, v104
  v_exp_f32 v105, v105
  v_exp_f32 v106, v106
  v_exp_f32 v107, v107
  v_exp_f32 v108, v108
  v_exp_f32 v109, v109
  v_exp_f32 v110, v110
  v_exp_f32 v111, v111
  v_add_f32 v28, v28, v96
  v_add_f32 v28, v28, v97
  v_add_f32 v28, v28, v98
  v_add_f32 v28, v28, v99
  v_add_f32 v28, v28, v100
  v_add_f32 v28, v28, v101
  v_add_f32 v28, v28, v102
  v_add_f32 v28, v28, v103
  v_add_f32 v28, v28, v104
  v_add_f32 v28, v28, v105
  v_add_f32 v28, v28, v106
  v_add_f32 v28, v28, v107
  v_add_f32 v28, v28, v108
  v_add_f32 v28, v28, v109
  v_add_f32 v28, v28, v110
  v_add_f32 v28, v28, v111
  v_cvt_pk_bf16_f32 v224, v96, v97
  v_cvt_pk_bf16_f32 v225, v98, v99
  v_cvt_pk_bf16_f32 v226, v100, v101
  v_cvt_pk_bf16_f32 v227, v102, v103
  v_cvt_pk_bf16_f32 v228, v104, v105
  v_cvt_pk_bf16_f32 v229, v106, v107
  v_cvt_pk_bf16_f32 v230, v108, v109
  v_cvt_pk_bf16_f32 v231, v110, v111
  ds_read_b64_tr_b16 v[112:113], v17 offset:8192
  ds_read_b64_tr_b16 v[114:115], v17 offset:10240
  ds_read_b64_tr_b16 v[116:117], v18 offset:8192
  ds_read_b64_tr_b16 v[118:119], v18 offset:10240
  ds_read_b64_tr_b16 v[120:121], v19 offset:8192
  ds_read_b64_tr_b16 v[122:123], v19 offset:10240
  ds_read_b64_tr_b16 v[124:125], v20 offset:8192
  ds_read_b64_tr_b16 v[126:127], v20 offset:10240
  s_waitcnt lgkmcnt(6)
  v_mfma_f32_32x32x16_bf16 v[128:143], v[112:115], v[224:227], v[128:143]
  s_waitcnt lgkmcnt(4)
  v_mfma_f32_32x32x16_bf16 v[144:159], v[116:119], v[224:227], v[144:159]
  s_nop 7
  ds_read_b64_tr_b16 v[112:113], v17 offset:12288
  ds_read_b64_tr_b16 v[114:115], v17 offset:14336
  ds_read_b64_tr_b16 v[116:117], v18 offset:12288
  ds_read_b64_tr_b16 v[118:119], v18 offset:14336
  ds_read_b64_tr_b16 v[120:121], v19 offset:12288
  ds_read_b64_tr_b16 v[122:123], v19 offset:14336
  ds_read_b64_tr_b16 v[124:125], v20 offset:12288
  ds_read_b64_tr_b16 v[126:127], v20 offset:14336
  s_waitcnt lgkmcnt(6)
  v_mfma_f32_32x32x16_bf16 v[128:143], v[112:115], v[228:231], v[128:143]
  s_waitcnt lgkmcnt(4)
  v_mfma_f32_32x32x16_bf16 v[144:159], v[116:119], v[228:231], v[144:159]
  s_nop 7
  ds_read_b128 v[112:115], v9 offset:16384
  ds_read_b128 v[116:119], v10 offset:16384
  ds_read_b128 v[120:123], v11 offset:16384
  ds_read_b128 v[124:127], v12 offset:16384
  s_waitcnt lgkmcnt(3)
  v_mfma_f32_32x32x16_bf16 v[96:111], v[112:115], a[192:195], 0
  s_waitcnt lgkmcnt(2)
  v_mfma_f32_32x32x16_bf16 v[96:111], v[116:119], a[196:199], v[96:111]
  s_waitcnt lgkmcnt(1)
  v_mfma_f32_32x32x16_bf16 v[96:111], v[120:123], a[200:203], v[96:111]
  s_waitcnt lgkmcnt(0)
  v_mfma_f32_32x32x16_bf16 v[96:111], v[124:127], a[204:207], v[96:111]
  s_nop 7
  ds_read_b128 v[112:115], v13 offset:16384
  ds_read_b128 v[116:119], v14 offset:16384
  ds_read_b128 v[120:123], v15 offset:16384
  ds_read_b128 v[124:127], v16 offset:16384
  s_waitcnt lgkmcnt(3)
  v_mfma_f32_32x32x16_bf16 v[96:111], v[112:115], a[208:211], v[96:111]
  s_waitcnt lgkmcnt(2)
  v_mfma_f32_32x32x16_bf16 v[96:111], v[116:119], a[212:215], v[96:111]
  s_waitcnt lgkmcnt(1)
  v_mfma_f32_32x32x16_bf16 v[96:111], v[120:123], a[216:219], v[96:111]
  s_waitcnt lgkmcnt(0)
  v_mfma_f32_32x32x16_bf16 v[96:111], v[124:127], a[220:223], v[96:111]
  s_nop 7
  s_nop 3
  v_fma_f32 v96, v96, s20, v27
  v_fma_f32 v97, v97, s20, v27
  v_fma_f32 v98, v98, s20, v27
  v_fma_f32 v99, v99, s20, v27
  v_fma_f32 v100, v100, s20, v27
  v_fma_f32 v101, v101, s20, v27
  v_fma_f32 v102, v102, s20, v27
  v_fma_f32 v103, v103, s20, v27
  v_fma_f32 v104, v104, s20, v27
  v_fma_f32 v105, v105, s20, v27
  v_fma_f32 v106, v106, s20, v27
  v_fma_f32 v107, v107, s20, v27
  v_fma_f32 v108, v108, s20, v27
  v_fma_f32 v109, v109, s20, v27
  v_fma_f32 v110, v110, s20, v27
  v_fma_f32 v111, v111, s20, v27
  v_exp_f32 v96, v96
  v_exp_f32 v97, v97
  v_exp_f32 v98, v98
  v_exp_f32 v99, v99
  v_exp_f32 v100, v100
  v_exp_f32 v101, v101
  v_exp_f32 v102, v102
  v_exp_f32 v103, v103
  v_exp_f32 v104, v104
  v_exp_f32 v105, v105
  v_exp_f32 v106, v106
  v_exp_f32 v107, v107
  v_exp_f32 v108, v108
  v_exp_f32 v109, v109
  v_exp_f32 v110, v110
  v_exp_f32 v111, v111
  v_add_f32 v28, v28, v96
  v_add_f32 v28, v28, v97
  v_add_f32 v28, v28, v98
  v_add_f32 v28, v28, v99
  v_add_f32 v28, v28, v100
  v_add_f32 v28, v28, v101
  v_add_f32 v28, v28, v102
  v_add_f32 v28, v28, v103
  v_add_f32 v28, v28, v104
  v_add_f32 v28, v28, v105
  v_add_f32 v28, v28, v106
  v_add_f32 v28, v28, v107
  v_add_f32 v28, v28, v108
  v_add_f32 v28, v28, v109
  v_add_f32 v28, v28, v110
  v_add_f32 v28, v28, v111
  v_cvt_pk_bf16_f32 v232, v96, v97
  v_cvt_pk_bf16_f32 v233, v98, v99
  v_cvt_pk_bf16_f32 v234, v100, v101
  v_cvt_pk_bf16_f32 v235, v102, v103
  v_cvt_pk_bf16_f32 v236, v104, v105
  v_cvt_pk_bf16_f32 v237, v106, v107
  v_cvt_pk_bf16_f32 v238, v108, v109
  v_cvt_pk_bf16_f32 v239, v110, v111
  ds_read_b64_tr_b16 v[112:113], v17 offset:16384
  ds_read_b64_tr_b16 v[114:115], v17 offset:18432
  ds_read_b64_tr_b16 v[116:117], v18 offset:16384
  ds_read_b64_tr_b16 v[118:119], v18 offset:18432
  ds_read_b64_tr_b16 v[120:121], v19 offset:16384
  ds_read_b64_tr_b16 v[122:123], v19 offset:18432
  ds_read_b64_tr_b16 v[124:125], v20 offset:16384
  ds_read_b64_tr_b16 v[126:127], v20 offset:18432
  s_waitcnt lgkmcnt(6)
  v_mfma_f32_32x32x16_bf16 v[128:143], v[112:115], v[232:235], v[128:143]
  s_waitcnt lgkmcnt(4)
  v_mfma_f32_32x32x16_bf16 v[144:159], v[116:119], v[232:235], v[144:159]
  s_nop 7
  ds_read_b64_tr_b16 v[112:113], v17 offset:20480
  ds_read_b64_tr_b16 v[114:115], v17 offset:22528
  ds_read_b64_tr_b16 v[116:117], v18 offset:20480
  ds_read_b64_tr_b16 v[118:119], v18 offset:22528
  ds_read_b64_tr_b16 v[120:121], v19 offset:20480
  ds_read_b64_tr_b16 v[122:123], v19 offset:22528
  ds_read_b64_tr_b16 v[124:125], v20 offset:20480
  ds_read_b64_tr_b16 v[126:127], v20 offset:22528
  s_waitcnt lgkmcnt(6)
  v_mfma_f32_32x32x16_bf16 v[128:143], v[112:115], v[236:239], v[128:143]
  s_waitcnt lgkmcnt(4)
  v_mfma_f32_32x32x16_bf16 v[144:159], v[116:119], v[236:239], v[144:159]
  s_nop 7
  ds_read_b128 v[112:115], v9 offset:24576
  ds_read_b128 v[116:119], v10 offset:24576
  ds_read_b128 v[120:123], v11 offset:24576
  ds_read_b128 v[124:127], v12 offset:24576
  s_waitcnt lgkmcnt(3)
  v_mfma_f32_32x32x16_bf16 v[96:111], v[112:115], a[192:195], 0
  s_waitcnt lgkmcnt(2)
  v_mfma_f32_32x32x16_bf16 v[96:111], v[116:119], a[196:199], v[96:111]
  s_waitcnt lgkmcnt(1)
  v_mfma_f32_32x32x16_bf16 v[96:111], v[120:123], a[200:203], v[96:111]
  s_waitcnt lgkmcnt(0)
  v_mfma_f32_32x32x16_bf16 v[96:111], v[124:127], a[204:207], v[96:111]
  s_nop 7
  ds_read_b128 v[112:115], v13 offset:24576
  ds_read_b128 v[116:119], v14 offset:24576
  ds_read_b128 v[120:123], v15 offset:24576
  ds_read_b128 v[124:127], v16 offset:24576
  s_waitcnt lgkmcnt(3)
  v_mfma_f32_32x32x16_bf16 v[96:111], v[112:115], a[208:211], v[96:111]
  s_waitcnt lgkmcnt(2)
  v_mfma_f32_32x32x16_bf16 v[96:111], v[116:119], a[212:215], v[96:111]
  s_waitcnt lgkmcnt(1)
  v_mfma_f32_32x32x16_bf16 v[96:111], v[120:123], a[216:219], v[96:111]
  s_waitcnt lgkmcnt(0)
  v_mfma_f32_32x32x16_bf16 v[96:111], v[124:127], a[220:223], v[96:111]
  s_nop 7
  s_nop 3
  v_fma_f32 v96, v96, s20, v27
  v_fma_f32 v97, v97, s20, v27
  v_fma_f32 v98, v98, s20, v27
  v_fma_f32 v99, v99, s20, v27
  v_fma_f32 v100, v100, s20, v27
  v_fma_f32 v101, v101, s20, v27
  v_fma_f32 v102, v102, s20, v27
  v_fma_f32 v103, v103, s20, v27
  v_fma_f32 v104, v104, s20, v27
  v_fma_f32 v105, v105, s20, v27
  v_fma_f32 v106, v106, s20, v27
  v_fma_f32 v107, v107, s20, v27
  v_fma_f32 v108, v108, s20, v27
  v_fma_f32 v109, v109, s20, v27
  v_fma_f32 v110, v110, s20, v27
  v_fma_f32 v111, v111, s20, v27
  v_exp_f32 v96, v96
  v_exp_f32 v97, v97
  v_exp_f32 v98, v98
  v_exp_f32 v99, v99
  v_exp_f32 v100, v100
  v_exp_f32 v101, v101
  v_exp_f32 v102, v102
  v_exp_f32 v103, v103
  v_exp_f32 v104, v104
  v_exp_f32 v105, v105
  v_exp_f32 v106, v106
  v_exp_f32 v107, v107
  v_exp_f32 v108, v108
  v_exp_f32 v109, v109
  v_exp_f32 v110, v110
  v_exp_f32 v111, v111
  v_add_f32 v28, v28, v96
  v_add_f32 v28, v28, v97
  v_add_f32 v28, v28, v98
  v_add_f32 v28, v28, v99
  v_add_f32 v28, v28, v100
  v_add_f32 v28, v28, v101
  v_add_f32 v28, v28, v102
  v_add_f32 v28, v28, v103
  v_add_f32 v28, v28, v104
  v_add_f32 v28, v28, v105
  v_add_f32 v28, v28, v106
  v_add_f32 v28, v28, v107
  v_add_f32 v28, v28, v108
  v_add_f32 v28, v28, v109
  v_add_f32 v28, v28, v110
  v_add_f32 v28, v28, v111
  v_cvt_pk_bf16_f32 v240, v96, v97
  v_cvt_pk_bf16_f32 v241, v98, v99
  v_cvt_pk_bf16_f32 v242, v100, v101
  v_cvt_pk_bf16_f32 v243, v102, v103
  v_cvt_pk_bf16_f32 v244, v104, v105
  v_cvt_pk_bf16_f32 v245, v106, v107
  v_cvt_pk_bf16_f32 v246, v108, v109
  v_cvt_pk_bf16_f32 v247, v110, v111
  ds_read_b64_tr_b16 v[112:113], v17 offset:24576
  ds_read_b64_tr_b16 v[114:115], v17 offset:26624
  ds_read_b64_tr_b16 v[116:117], v18 offset:24576
  ds_read_b64_tr_b16 v[118:119], v18 offset:26624
  ds_read_b64_tr_b16 v[120:121], v19 offset:24576
  ds_read_b64_tr_b16 v[122:123], v19 offset:26624
  ds_read_b64_tr_b16 v[124:125], v20 offset:24576
  ds_read_b64_tr_b16 v[126:127], v20 offset:26624
  s_waitcnt lgkmcnt(6)
  v_mfma_f32_32x32x16_bf16 v[128:143], v[112:115], v[240:243], v[128:143]
  s_waitcnt lgkmcnt(4)
  v_mfma_f32_32x32x16_bf16 v[144:159], v[116:119], v[240:243], v[144:159]
  s_nop 7
  ds_read_b64_tr_b16 v[112:113], v17 offset:28672
  ds_read_b64_tr_b16 v[114:115], v17 offset:30720
  ds_read_b64_tr_b16 v[116:117], v18 offset:28672
  ds_read_b64_tr_b16 v[118:119], v18 offset:30720
  ds_read_b64_tr_b16 v[120:121], v19 offset:28672
  ds_read_b64_tr_b16 v[122:123], v19 offset:30720
  ds_read_b64_tr_b16 v[124:125], v20 offset:28672
  ds_read_b64_tr_b16 v[126:127], v20 offset:30720
  s_waitcnt lgkmcnt(6)
  v_mfma_f32_32x32x16_bf16 v[128:143], v[112:115], v[244:247], v[128:143]
  s_waitcnt lgkmcnt(4)
  v_mfma_f32_32x32x16_bf16 v[144:159], v[116:119], v[244:247], v[144:159]
  s_nop 7
  ds_read_b128 v[112:115], v1 offset:40960
  ds_read_b128 v[116:119], v2 offset:40960
  ds_read_b128 v[120:123], v3 offset:40960
  ds_read_b128 v[124:127], v4 offset:40960
  s_waitcnt lgkmcnt(3)
  v_mfma_f32_32x32x16_bf16 v[96:111], v[112:115], a[192:195], 0
  s_waitcnt lgkmcnt(2)
  v_mfma_f32_32x32x16_bf16 v[96:111], v[116:119], a[196:199], v[96:111]
  s_waitcnt lgkmcnt(1)
  v_mfma_f32_32x32x16_bf16 v[96:111], v[120:123], a[200:203], v[96:111]
  s_waitcnt lgkmcnt(0)
  v_mfma_f32_32x32x16_bf16 v[96:111], v[124:127], a[204:207], v[96:111]
  s_nop 7
  ds_read_b128 v[112:115], v5 offset:40960
  ds_read_b128 v[116:119], v6 offset:40960
  ds_read_b128 v[120:123], v7 offset:40960
  ds_read_b128 v[124:127], v8 offset:40960
  s_waitcnt lgkmcnt(3)
  v_mfma_f32_32x32x16_bf16 v[96:111], v[112:115], a[208:211], v[96:111]
  s_waitcnt lgkmcnt(2)
  v_mfma_f32_32x32x16_bf16 v[96:111], v[116:119], a[212:215], v[96:111]
  s_waitcnt lgkmcnt(1)
  v_mfma_f32_32x32x16_bf16 v[96:111], v[120:123], a[216:219], v[96:111]
  s_waitcnt lgkmcnt(0)
  v_mfma_f32_32x32x16_bf16 v[96:111], v[124:127], a[220:223], v[96:111]
  s_nop 7
  s_nop 3
  v_fma_f32 v96, v96, s20, v27
  v_fma_f32 v97, v97, s20, v27
  v_fma_f32 v98, v98, s20, v27
  v_fma_f32 v99, v99, s20, v27
  v_fma_f32 v100, v100, s20, v27
  v_fma_f32 v101, v101, s20, v27
  v_fma_f32 v102, v102, s20, v27
  v_fma_f32 v103, v103, s20, v27
  v_fma_f32 v104, v104, s20, v27
  v_fma_f32 v105, v105, s20, v27
  v_fma_f32 v106, v106, s20, v27
  v_fma_f32 v107, v107, s20, v27
  v_fma_f32 v108, v108, s20, v27
  v_fma_f32 v109, v109, s20, v27
  v_fma_f32 v110, v110, s20, v27
  v_fma_f32 v111, v111, s20, v27
  v_exp_f32 v96, v96
  v_exp_f32 v97, v97
  v_exp_f32 v98, v98
  v_exp_f32 v99, v99
  v_exp_f32 v100, v100
  v_exp_f32 v101, v101
  v_exp_f32 v102, v102
  v_exp_f32 v103, v103
  v_exp_f32 v104, v104
  v_exp_f32 v105, v105
  v_exp_f32 v106, v106
  v_exp_f32 v107, v107
  v_exp_f32 v108, v108
  v_exp_f32 v109, v109
  v_exp_f32 v110, v110
  v_exp_f32 v111, v111
  v_add_f32 v28, v28, v96
  v_add_f32 v28, v28, v97
  v_add_f32 v28, v28, v98
  v_add_f32 v28, v28, v99
  v_add_f32 v28, v28, v100
  v_add_f32 v28, v28, v101
  v_add_f32 v28, v28, v102
  v_add_f32 v28, v28, v103
  v_add_f32 v28, v28, v104
  v_add_f32 v28, v28, v105
  v_add_f32 v28, v28, v106
  v_add_f32 v28, v28, v107
  v_add_f32 v28, v28, v108
  v_add_f32 v28, v28, v109
  v_add_f32 v28, v28, v110
  v_add_f32 v28, v28, v111
  v_cvt_pk_bf16_f32 v248, v96, v97
  v_cvt_pk_bf16_f32 v249, v98, v99
  v_cvt_pk_bf16_f32 v250, v100, v101
  v_cvt_pk_bf16_f32 v251, v102, v103
  v_cvt_pk_bf16_f32 v252, v104, v105
  v_cvt_pk_bf16_f32 v253, v106, v107
  v_cvt_pk_bf16_f32 v254, v108, v109
  v_cvt_pk_bf16_f32 v255, v110, v111
  v_mfma_f32_32x32x16_bf16 v[128:143], a[160:163], v[248:251], v[128:143]
  v_mfma_f32_32x32x16_bf16 v[144:159], a[164:167], v[248:251], v[144:159]
  s_nop 7
  v_mfma_f32_32x32x16_bf16 v[128:143], a[176:179], v[252:255], v[128:143]
  v_mfma_f32_32x32x16_bf16 v[144:159], a[180:183], v[252:255], v[144:159]
  s_nop 7
  v_mov_b32 v29, v28
  s_nop 1
  v_permlane32_swap_b32 v28, v29
  v_add_f32 v40, v28, v29
  v_rcp_f32 v40, v40
  s_nop 7
  s_nop 7
  s_setpc_b64 s[32:33]
.section .rodata,"a"
.p2align 6
.amdhsa_kernel standalone__gqa_softmax__near_ridge_kernel
  .amdhsa_next_free_vgpr 512
  .amdhsa_next_free_sgpr 102
  .amdhsa_accum_offset 256
  .amdhsa_group_segment_fixed_size 0
  .amdhsa_kernarg_size 48
  .amdhsa_user_sgpr_count 2
  .amdhsa_user_sgpr_kernarg_segment_ptr 1
  .amdhsa_system_sgpr_workgroup_id_x 1
.end_amdhsa_kernel
```
